```python
import torch

def _softmax(x, axis=-1):
    return torch.softmax(x, dim=axis)
def _gelu(x):
    return torch.nn.functional.gelu(x, approximate="tanh")
def _silu(x):
    return torch.nn.functional.silu(x)
def _sigmoid(x):
    return torch.sigmoid(x)
def _layernorm(x, axis=-1, eps=1e-5):
    m = x.mean(dim=axis, keepdim=True)
    v = x.var(dim=axis, keepdim=True, unbiased=False)
    return (x - m) / torch.sqrt(v + eps)
def _scatter_add(tgt, idx, src, axis=0):
    return tgt.clone().index_add_(axis, idx, src)
def _segment_sum(src, seg, n):
    out = torch.zeros((n,) + src.shape[1:], dtype=src.dtype)
    return out.index_add_(0, seg, src)
def _pad(x, pw):
    flat = tuple(v for pair in reversed(pw) for v in pair)
    return torch.nn.functional.pad(x, flat)

kernel_name = 'recurrent_scan__spectral_gfnet__glu_gated_geglu__prompt'

def setup_inputs():

    _w = (lambda a: (lambda t: t.to(torch.bfloat16) if t.is_floating_point() else t)(torch.as_tensor(a)))
    def _A_setup():
        B, S, D = 1, 2048, 1024
        Df = D // 2 + 1
        return {
            "x": _w((lambda *s: torch.randn(*s, dtype=torch.bfloat16) * 0.2)(B, S, D)),
            "w_r": _w((lambda *s: torch.randn(*s, dtype=torch.bfloat16) * 1.6)(S, Df) * 0.02),
            "w_i": _w((lambda *s: torch.randn(*s, dtype=torch.bfloat16) * 1.6)(S, Df) * 0.02),
        }
    _A_in = _A_setup()

    def _B_setup():
        B, S, Dm, Df = 1, 2048, 1024, 3584
        return {
            "x": _w((lambda *s: torch.randn(*s, dtype=torch.bfloat16) * 0.2)(B, S, Dm)),
            "w_gate": _w((lambda *s: torch.randn(*s, dtype=torch.bfloat16) * 0.8)(Dm, Df) * (Dm ** -0.5)),
            "w_up": _w((lambda *s: torch.randn(*s, dtype=torch.bfloat16) * 0.8)(Dm, Df) * (Dm ** -0.5)),
            "w_down": _w((lambda *s: torch.randn(*s, dtype=torch.bfloat16) * 0.8)(Df, Dm) * (Df ** -0.5)),
        }
    _B_in = _B_setup()

    return {
        "A_x": _A_in["x"],
        "A_w_r": _A_in["w_r"],
        "A_w_i": _A_in["w_i"],
        "B_x": _B_in["x"],
        "B_w_gate": _B_in["w_gate"],
        "B_w_up": _B_in["w_up"],
        "B_w_down": _B_in["w_down"],
    }

def reference(A_x, A_w_r, A_w_i, B_x, B_w_gate, B_w_up, B_w_down):
    def _A_ref(x, w_r, w_i):
        B, S, D = x.shape
        X = (lambda x, axes=(-2,-1): torch.fft.rfft2(x.float(), dim=axes))(x, axes=(-2, -1))
        W = w_r + 1j * w_i
        X = X * W
        y = (lambda x, s, axes=(-2,-1): torch.fft.irfft2(x, s=s, dim=axes).to(torch.bfloat16))(X, (S, D), axes=(-2, -1))
        return y

    def _B_ref(x, w_gate, w_up, w_down):
        g = torch.einsum("bsd,df->bsf", x, w_gate)
        u = torch.einsum("bsd,df->bsf", x, w_up)
        h = _gelu(g) * u
        return torch.einsum("bsf,fd->bsd", h, w_down)

    x = A_x
    xn = _layernorm(x, axis=-1)
    s = _A_ref(xn, A_w_r, A_w_i)
    g = _silu(_B_ref(xn, B_w_gate, B_w_up, B_w_down))
    return x + s * g
```

```asm
; @launch kernel=k1_kernel grid=(628,1,1) block=(512,1,1) lds=73984
; @launch kernel=gemm1_kernel grid=(256,1,1) block=(512,1,1) lds=115200
; @launch kernel=gemm2_kernel grid=(256,1,1) block=(512,1,1) lds=163840
; @launch kernel=k2_kernel grid=(257,1,1) block=(256,1,1) lds=69632
; @launch kernel=k3_kernel grid=(256,1,1) block=(512,1,1) lds=73984
.amdgcn_target "amdgcn-amd-amdhsa--gfx950"
.text

.globl k1_kernel
.p2align 8
.type k1_kernel,@function
k1_kernel:
    s_cmp_ge_u32 s2, 628
    s_cbranch_scc1 k1_end
    s_cmp_lt_u32 s2, 84
    s_cbranch_scc1 k1_pf
    s_sub_u32 s2, s2, 84
    s_load_dwordx2 s[4:5], s[0:1], 0
    s_load_dwordx4 s[8:11], s[0:1], 8
    s_load_dwordx2 s[6:7], s[0:1], 72
    v_and_b32 v1, 63, v0
    v_lshrrev_b32 v2, 6, v0
    s_nop 0
    v_readfirstlane_b32 s22, v2
    s_waitcnt lgkmcnt(0)
    s_mov_b32 s16, s6
    s_mov_b32 s17, s7
    s_mov_b32 s18, 268435456
    s_mov_b32 s19, 0x00020000
    s_cmp_ge_u32 s2, 256
    s_cbranch_scc1 k1_wt
    s_mov_b32 s12, s4
    s_mov_b32 s13, s5
    s_mov_b32 s14, 4194304
    s_mov_b32 s15, 0x00020000
    s_getpc_b64 s[24:25]
    s_add_u32 s24, s24, twtab@rel32@lo+4
    s_addc_u32 s25, s25, twtab@rel32@hi+12
    s_mov_b32 s26, 16384
    s_mov_b32 s27, 0x00020000
    s_and_b32 s20, s2, 7
    s_lshl_b32 s20, s20, 5
    s_lshr_b32 s21, s2, 3
    s_add_u32 s20, s20, s21
    s_lshl_b32 s20, s20, 3
    s_add_u32 s21, s20, s22
    s_lshl_b32 s23, s21, 11
    v_lshlrev_b32 v3, 2, v1
    buffer_load_dword v16, v3, s[12:15], s23 offen offset:0
    buffer_load_dword v17, v3, s[12:15], s23 offen offset:256
    buffer_load_dword v18, v3, s[12:15], s23 offen offset:512
    buffer_load_dword v19, v3, s[12:15], s23 offen offset:768
    buffer_load_dword v20, v3, s[12:15], s23 offen offset:1024
    buffer_load_dword v21, v3, s[12:15], s23 offen offset:1280
    buffer_load_dword v22, v3, s[12:15], s23 offen offset:1536
    buffer_load_dword v23, v3, s[12:15], s23 offen offset:1792
    v_mul_u32_u24 v4, 4, v1
    v_and_b32 v4, 2047, v4
    v_lshlrev_b32 v4, 3, v4
    buffer_load_dwordx2 v[96:97], v4, s[24:27], 0 offen
    v_mul_u32_u24 v4, 8, v1
    v_and_b32 v4, 2047, v4
    v_lshlrev_b32 v4, 3, v4
    buffer_load_dwordx2 v[98:99], v4, s[24:27], 0 offen
    v_mul_u32_u24 v4, 12, v1
    v_and_b32 v4, 2047, v4
    v_lshlrev_b32 v4, 3, v4
    buffer_load_dwordx2 v[100:101], v4, s[24:27], 0 offen
    v_mul_u32_u24 v4, 16, v1
    v_and_b32 v4, 2047, v4
    v_lshlrev_b32 v4, 3, v4
    buffer_load_dwordx2 v[102:103], v4, s[24:27], 0 offen
    v_mul_u32_u24 v4, 20, v1
    v_and_b32 v4, 2047, v4
    v_lshlrev_b32 v4, 3, v4
    buffer_load_dwordx2 v[104:105], v4, s[24:27], 0 offen
    v_mul_u32_u24 v4, 24, v1
    v_and_b32 v4, 2047, v4
    v_lshlrev_b32 v4, 3, v4
    buffer_load_dwordx2 v[106:107], v4, s[24:27], 0 offen
    v_mul_u32_u24 v4, 28, v1
    v_and_b32 v4, 2047, v4
    v_lshlrev_b32 v4, 3, v4
    buffer_load_dwordx2 v[108:109], v4, s[24:27], 0 offen
    v_and_b32 v5, 7, v1
    v_mul_u32_u24 v4, 32, v5
    v_and_b32 v4, 2047, v4
    v_lshlrev_b32 v4, 3, v4
    buffer_load_dwordx2 v[112:113], v4, s[24:27], 0 offen
    v_mul_u32_u24 v4, 64, v5
    v_and_b32 v4, 2047, v4
    v_lshlrev_b32 v4, 3, v4
    buffer_load_dwordx2 v[114:115], v4, s[24:27], 0 offen
    v_mul_u32_u24 v4, 96, v5
    v_and_b32 v4, 2047, v4
    v_lshlrev_b32 v4, 3, v4
    buffer_load_dwordx2 v[116:117], v4, s[24:27], 0 offen
    v_mul_u32_u24 v4, 128, v5
    v_and_b32 v4, 2047, v4
    v_lshlrev_b32 v4, 3, v4
    buffer_load_dwordx2 v[118:119], v4, s[24:27], 0 offen
    v_mul_u32_u24 v4, 160, v5
    v_and_b32 v4, 2047, v4
    v_lshlrev_b32 v4, 3, v4
    buffer_load_dwordx2 v[120:121], v4, s[24:27], 0 offen
    v_mul_u32_u24 v4, 192, v5
    v_and_b32 v4, 2047, v4
    v_lshlrev_b32 v4, 3, v4
    buffer_load_dwordx2 v[122:123], v4, s[24:27], 0 offen
    v_mul_u32_u24 v4, 224, v5
    v_and_b32 v4, 2047, v4
    v_lshlrev_b32 v4, 3, v4
    buffer_load_dwordx2 v[124:125], v4, s[24:27], 0 offen
    s_waitcnt vmcnt(14)
    s_mov_b32 s30, 0xffff0000
    v_lshlrev_b32 v32, 16, v16
    v_and_b32 v33, s30, v16
    v_lshlrev_b32 v34, 16, v17
    v_and_b32 v35, s30, v17
    v_lshlrev_b32 v36, 16, v18
    v_and_b32 v37, s30, v18
    v_lshlrev_b32 v38, 16, v19
    v_and_b32 v39, s30, v19
    v_lshlrev_b32 v40, 16, v20
    v_and_b32 v41, s30, v20
    v_lshlrev_b32 v42, 16, v21
    v_and_b32 v43, s30, v21
    v_lshlrev_b32 v44, 16, v22
    v_and_b32 v45, s30, v22
    v_lshlrev_b32 v46, 16, v23
    v_and_b32 v47, s30, v23
    v_add_f32 v6, v32, v33
    v_add_f32 v7, v34, v35
    v_add_f32 v6, v6, v36
    v_add_f32 v7, v7, v37
    v_add_f32 v6, v6, v38
    v_add_f32 v7, v7, v39
    v_add_f32 v6, v6, v40
    v_add_f32 v7, v7, v41
    v_add_f32 v6, v6, v42
    v_add_f32 v7, v7, v43
    v_add_f32 v6, v6, v44
    v_add_f32 v7, v7, v45
    v_add_f32 v6, v6, v46
    v_add_f32 v7, v7, v47
    v_add_f32 v6, v6, v7
    s_nop 1
    v_add_f32_dpp v6, v6, v6 row_shr:1 row_mask:0xf bank_mask:0xf
    s_nop 1
    v_add_f32_dpp v6, v6, v6 row_shr:2 row_mask:0xf bank_mask:0xf
    s_nop 1
    v_add_f32_dpp v6, v6, v6 row_shr:4 row_mask:0xf bank_mask:0xf
    s_nop 1
    v_add_f32_dpp v6, v6, v6 row_shr:8 row_mask:0xf bank_mask:0xf
    s_nop 1
    v_add_f32_dpp v6, v6, v6 row_bcast:15 row_mask:0xa bank_mask:0xf
    s_nop 1
    v_add_f32_dpp v6, v6, v6 row_bcast:31 row_mask:0xc bank_mask:0xf
    s_nop 1
    v_readlane_b32 s31, v6, 63
    s_mov_b32 s32, 0x3a800000
    v_mov_b32 v8, s32
    v_mul_f32 v8, s31, v8
    v_sub_f32 v9, v32, v8
    v_mul_f32 v6, v9, v9
    v_sub_f32 v9, v33, v8
    v_mul_f32 v7, v9, v9
    v_sub_f32 v9, v34, v8
    v_fmac_f32 v6, v9, v9
    v_sub_f32 v10, v35, v8
    v_fmac_f32 v7, v10, v10
    v_sub_f32 v9, v36, v8
    v_fmac_f32 v6, v9, v9
    v_sub_f32 v10, v37, v8
    v_fmac_f32 v7, v10, v10
    v_sub_f32 v9, v38, v8
    v_fmac_f32 v6, v9, v9
    v_sub_f32 v10, v39, v8
    v_fmac_f32 v7, v10, v10
    v_sub_f32 v9, v40, v8
    v_fmac_f32 v6, v9, v9
    v_sub_f32 v10, v41, v8
    v_fmac_f32 v7, v10, v10
    v_sub_f32 v9, v42, v8
    v_fmac_f32 v6, v9, v9
    v_sub_f32 v10, v43, v8
    v_fmac_f32 v7, v10, v10
    v_sub_f32 v9, v44, v8
    v_fmac_f32 v6, v9, v9
    v_sub_f32 v10, v45, v8
    v_fmac_f32 v7, v10, v10
    v_sub_f32 v9, v46, v8
    v_fmac_f32 v6, v9, v9
    v_sub_f32 v10, v47, v8
    v_fmac_f32 v7, v10, v10
    v_add_f32 v6, v6, v7
    s_nop 1
    v_add_f32_dpp v6, v6, v6 row_shr:1 row_mask:0xf bank_mask:0xf
    s_nop 1
    v_add_f32_dpp v6, v6, v6 row_shr:2 row_mask:0xf bank_mask:0xf
    s_nop 1
    v_add_f32_dpp v6, v6, v6 row_shr:4 row_mask:0xf bank_mask:0xf
    s_nop 1
    v_add_f32_dpp v6, v6, v6 row_shr:8 row_mask:0xf bank_mask:0xf
    s_nop 1
    v_add_f32_dpp v6, v6, v6 row_bcast:15 row_mask:0xa bank_mask:0xf
    s_nop 1
    v_add_f32_dpp v6, v6, v6 row_bcast:31 row_mask:0xc bank_mask:0xf
    s_nop 1
    v_readlane_b32 s31, v6, 63
    v_mov_b32 v9, s32
    v_mul_f32 v9, s31, v9
    v_cvt_pk_bf16_f32 v8, v8, v8
    v_lshlrev_b32 v8, 16, v8
    v_cvt_pk_bf16_f32 v9, v9, v9
    v_lshlrev_b32 v9, 16, v9
    v_add_f32 v9, 0x3727c5ac, v9
    v_cvt_pk_bf16_f32 v9, v9, v9
    v_lshlrev_b32 v9, 16, v9
    v_sqrt_f32 v10, v9
    s_nop 0
    v_rcp_f32 v11, v10
    v_fma_f32 v12, -v10, v10, v9
    v_mul_f32 v11, 0.5, v11
    v_fma_f32 v10, v12, v11, v10
    v_cvt_pk_bf16_f32 v10, v10, v10
    v_lshlrev_b32 v10, 16, v10
    v_rcp_f32 v11, v10
    s_nop 0
    v_fma_f32 v12, -v10, v11, 1.0
    v_fma_f32 v11, v12, v11, v11
    v_sub_f32 v32, v32, v8
    v_sub_f32 v33, v33, v8
    v_cvt_pk_bf16_f32 v13, v32, v33
    v_lshlrev_b32 v32, 16, v13
    v_and_b32 v33, s30, v13
    v_mul_f32 v13, v32, v11
    v_mul_f32 v14, v33, v11
    v_fma_f32 v15, -v13, v10, v32
    v_fma_f32 v12, -v14, v10, v33
    v_fma_f32 v13, v15, v11, v13
    v_fma_f32 v14, v12, v11, v14
    v_cvt_pk_bf16_f32 v16, v13, v14
    v_lshlrev_b32 v32, 16, v16
    v_and_b32 v33, s30, v16
    v_sub_f32 v34, v34, v8
    v_sub_f32 v35, v35, v8
    v_cvt_pk_bf16_f32 v13, v34, v35
    v_lshlrev_b32 v34, 16, v13
    v_and_b32 v35, s30, v13
    v_mul_f32 v13, v34, v11
    v_mul_f32 v14, v35, v11
    v_fma_f32 v15, -v13, v10, v34
    v_fma_f32 v12, -v14, v10, v35
    v_fma_f32 v13, v15, v11, v13
    v_fma_f32 v14, v12, v11, v14
    v_cvt_pk_bf16_f32 v17, v13, v14
    v_lshlrev_b32 v34, 16, v17
    v_and_b32 v35, s30, v17
    v_sub_f32 v36, v36, v8
    v_sub_f32 v37, v37, v8
    v_cvt_pk_bf16_f32 v13, v36, v37
    v_lshlrev_b32 v36, 16, v13
    v_and_b32 v37, s30, v13
    v_mul_f32 v13, v36, v11
    v_mul_f32 v14, v37, v11
    v_fma_f32 v15, -v13, v10, v36
    v_fma_f32 v12, -v14, v10, v37
    v_fma_f32 v13, v15, v11, v13
    v_fma_f32 v14, v12, v11, v14
    v_cvt_pk_bf16_f32 v18, v13, v14
    v_lshlrev_b32 v36, 16, v18
    v_and_b32 v37, s30, v18
    v_sub_f32 v38, v38, v8
    v_sub_f32 v39, v39, v8
    v_cvt_pk_bf16_f32 v13, v38, v39
    v_lshlrev_b32 v38, 16, v13
    v_and_b32 v39, s30, v13
    v_mul_f32 v13, v38, v11
    v_mul_f32 v14, v39, v11
    v_fma_f32 v15, -v13, v10, v38
    v_fma_f32 v12, -v14, v10, v39
    v_fma_f32 v13, v15, v11, v13
    v_fma_f32 v14, v12, v11, v14
    v_cvt_pk_bf16_f32 v19, v13, v14
    v_lshlrev_b32 v38, 16, v19
    v_and_b32 v39, s30, v19
    v_sub_f32 v40, v40, v8
    v_sub_f32 v41, v41, v8
    v_cvt_pk_bf16_f32 v13, v40, v41
    v_lshlrev_b32 v40, 16, v13
    v_and_b32 v41, s30, v13
    v_mul_f32 v13, v40, v11
    v_mul_f32 v14, v41, v11
    v_fma_f32 v15, -v13, v10, v40
    v_fma_f32 v12, -v14, v10, v41
    v_fma_f32 v13, v15, v11, v13
    v_fma_f32 v14, v12, v11, v14
    v_cvt_pk_bf16_f32 v20, v13, v14
    v_lshlrev_b32 v40, 16, v20
    v_and_b32 v41, s30, v20
    v_sub_f32 v42, v42, v8
    v_sub_f32 v43, v43, v8
    v_cvt_pk_bf16_f32 v13, v42, v43
    v_lshlrev_b32 v42, 16, v13
    v_and_b32 v43, s30, v13
    v_mul_f32 v13, v42, v11
    v_mul_f32 v14, v43, v11
    v_fma_f32 v15, -v13, v10, v42
    v_fma_f32 v12, -v14, v10, v43
    v_fma_f32 v13, v15, v11, v13
    v_fma_f32 v14, v12, v11, v14
    v_cvt_pk_bf16_f32 v21, v13, v14
    v_lshlrev_b32 v42, 16, v21
    v_and_b32 v43, s30, v21
    v_sub_f32 v44, v44, v8
    v_sub_f32 v45, v45, v8
    v_cvt_pk_bf16_f32 v13, v44, v45
    v_lshlrev_b32 v44, 16, v13
    v_and_b32 v45, s30, v13
    v_mul_f32 v13, v44, v11
    v_mul_f32 v14, v45, v11
    v_fma_f32 v15, -v13, v10, v44
    v_fma_f32 v12, -v14, v10, v45
    v_fma_f32 v13, v15, v11, v13
    v_fma_f32 v14, v12, v11, v14
    v_cvt_pk_bf16_f32 v22, v13, v14
    v_lshlrev_b32 v44, 16, v22
    v_and_b32 v45, s30, v22
    v_sub_f32 v46, v46, v8
    v_sub_f32 v47, v47, v8
    v_cvt_pk_bf16_f32 v13, v46, v47
    v_lshlrev_b32 v46, 16, v13
    v_and_b32 v47, s30, v13
    v_mul_f32 v13, v46, v11
    v_mul_f32 v14, v47, v11
    v_fma_f32 v15, -v13, v10, v46
    v_fma_f32 v12, -v14, v10, v47
    v_fma_f32 v13, v15, v11, v13
    v_fma_f32 v14, v12, v11, v14
    v_cvt_pk_bf16_f32 v23, v13, v14
    v_lshlrev_b32 v46, 16, v23
    v_and_b32 v47, s30, v23
    v_lshrrev_b32 v4, 2, v1
    v_lshlrev_b32 v4, 9, v4
    v_and_b32 v5, 3, v1
    v_lshlrev_b32 v5, 2, v5
    v_add_u32 v4, v4, v5
    s_lshr_b32 s31, s21, 5
    s_lshl_b32 s31, s31, 16
    s_and_b32 s32, s21, 31
    s_lshl_b32 s32, s32, 4
    s_add_u32 s31, s31, s32
    buffer_store_dword v16, v4, s[16:19], s31 offen
    s_add_u32 s31, s31, 8192
    buffer_store_dword v17, v4, s[16:19], s31 offen
    s_add_u32 s31, s31, 8192
    buffer_store_dword v18, v4, s[16:19], s31 offen
    s_add_u32 s31, s31, 8192
    buffer_store_dword v19, v4, s[16:19], s31 offen
    s_add_u32 s31, s31, 8192
    buffer_store_dword v20, v4, s[16:19], s31 offen
    s_add_u32 s31, s31, 8192
    buffer_store_dword v21, v4, s[16:19], s31 offen
    s_add_u32 s31, s31, 8192
    buffer_store_dword v22, v4, s[16:19], s31 offen
    s_add_u32 s31, s31, 8192
    buffer_store_dword v23, v4, s[16:19], s31 offen
    v_pk_add_f32 v[48:49], v[32:33], v[40:41]
    v_pk_add_f32 v[40:41], v[32:33], v[40:41] neg_lo:[0,1] neg_hi:[0,1]
    v_pk_add_f32 v[50:51], v[34:35], v[42:43]
    v_pk_add_f32 v[42:43], v[34:35], v[42:43] neg_lo:[0,1] neg_hi:[0,1]
    v_add_f32 v52, v42, v43
    v_sub_f32 v53, v43, v42
    v_mul_f32 v52, 0x3f3504f3, v52
    v_mul_f32 v53, 0x3f3504f3, v53
    v_pk_add_f32 v[54:55], v[36:37], v[44:45]
    v_sub_f32 v56, v37, v45
    v_sub_f32 v57, v44, v36
    v_pk_add_f32 v[58:59], v[38:39], v[46:47]
    v_pk_add_f32 v[46:47], v[38:39], v[46:47] neg_lo:[0,1] neg_hi:[0,1]
    v_sub_f32 v60, v47, v46
    v_add_f32 v61, v46, v47
    v_mul_f32 v60, 0x3f3504f3, v60
    v_mul_f32 v61, 0xbf3504f3, v61
    v_pk_add_f32 v[62:63], v[48:49], v[54:55]
    v_pk_add_f32 v[54:55], v[48:49], v[54:55] neg_lo:[0,1] neg_hi:[0,1]
    v_pk_add_f32 v[64:65], v[50:51], v[58:59]
    v_sub_f32 v66, v51, v59
    v_sub_f32 v67, v58, v50
    v_pk_add_f32 v[68:69], v[62:63], v[64:65]
    v_pk_add_f32 v[64:65], v[62:63], v[64:65] neg_lo:[0,1] neg_hi:[0,1]
    v_pk_add_f32 v[70:71], v[54:55], v[66:67]
    v_pk_add_f32 v[66:67], v[54:55], v[66:67] neg_lo:[0,1] neg_hi:[0,1]
    v_pk_add_f32 v[72:73], v[40:41], v[56:57]
    v_pk_add_f32 v[56:57], v[40:41], v[56:57] neg_lo:[0,1] neg_hi:[0,1]
    v_pk_add_f32 v[74:75], v[52:53], v[60:61]
    v_sub_f32 v76, v53, v61
    v_sub_f32 v77, v60, v52
    v_pk_add_f32 v[78:79], v[72:73], v[74:75]
    v_pk_add_f32 v[74:75], v[72:73], v[74:75] neg_lo:[0,1] neg_hi:[0,1]
    v_pk_add_f32 v[80:81], v[56:57], v[76:77]
    v_pk_add_f32 v[76:77], v[56:57], v[76:77] neg_lo:[0,1] neg_hi:[0,1]
    s_waitcnt vmcnt(15)
    v_pk_mul_f32 v[82:83], v[78:79], v[96:97] op_sel:[0,0] op_sel_hi:[1,0]
    v_pk_fma_f32 v[82:83], v[78:79], v[96:97], v[82:83] op_sel:[1,1,0] op_sel_hi:[0,1,1] neg_lo:[1,0,0]
    v_pk_mul_f32 v[84:85], v[70:71], v[98:99] op_sel:[0,0] op_sel_hi:[1,0]
    v_pk_fma_f32 v[84:85], v[70:71], v[98:99], v[84:85] op_sel:[1,1,0] op_sel_hi:[0,1,1] neg_lo:[1,0,0]
    v_pk_mul_f32 v[86:87], v[80:81], v[100:101] op_sel:[0,0] op_sel_hi:[1,0]
    v_pk_fma_f32 v[86:87], v[80:81], v[100:101], v[86:87] op_sel:[1,1,0] op_sel_hi:[0,1,1] neg_lo:[1,0,0]
    v_pk_mul_f32 v[88:89], v[64:65], v[102:103] op_sel:[0,0] op_sel_hi:[1,0]
    v_pk_fma_f32 v[88:89], v[64:65], v[102:103], v[88:89] op_sel:[1,1,0] op_sel_hi:[0,1,1] neg_lo:[1,0,0]
    v_pk_mul_f32 v[90:91], v[74:75], v[104:105] op_sel:[0,0] op_sel_hi:[1,0]
    v_pk_fma_f32 v[90:91], v[74:75], v[104:105], v[90:91] op_sel:[1,1,0] op_sel_hi:[0,1,1] neg_lo:[1,0,0]
    v_pk_mul_f32 v[92:93], v[66:67], v[106:107] op_sel:[0,0] op_sel_hi:[1,0]
    v_pk_fma_f32 v[92:93], v[66:67], v[106:107], v[92:93] op_sel:[1,1,0] op_sel_hi:[0,1,1] neg_lo:[1,0,0]
    v_pk_mul_f32 v[94:95], v[76:77], v[108:109] op_sel:[0,0] op_sel_hi:[1,0]
    v_pk_fma_f32 v[94:95], v[76:77], v[108:109], v[94:95] op_sel:[1,1,0] op_sel_hi:[0,1,1] neg_lo:[1,0,0]
    s_mul_i32 s33, s22, 5120
    v_lshlrev_b32 v4, 3, v1
    v_add_u32 v4, s33, v4
    ds_write_b64 v4, v[68:69] offset:0
    ds_write_b64 v4, v[82:83] offset:576
    ds_write_b64 v4, v[84:85] offset:1152
    ds_write_b64 v4, v[86:87] offset:1728
    ds_write_b64 v4, v[88:89] offset:2304
    ds_write_b64 v4, v[90:91] offset:2880
    ds_write_b64 v4, v[92:93] offset:3456
    ds_write_b64 v4, v[94:95] offset:4032
    v_lshrrev_b32 v5, 3, v1
    v_mul_u32_u24 v5, 72, v5
    v_and_b32 v6, 7, v1
    v_add_u32 v5, v5, v6
    v_lshlrev_b32 v5, 3, v5
    v_add_u32 v5, s33, v5
    s_waitcnt lgkmcnt(0)
    ds_read_b64 v[32:33], v5 offset:0
    ds_read_b64 v[34:35], v5 offset:64
    ds_read_b64 v[42:43], v5 offset:128
    ds_read_b64 v[36:37], v5 offset:192
    ds_read_b64 v[44:45], v5 offset:256
    ds_read_b64 v[38:39], v5 offset:320
    ds_read_b64 v[46:47], v5 offset:384
    ds_read_b64 v[48:49], v5 offset:448
    s_waitcnt lgkmcnt(0)
    v_pk_add_f32 v[50:51], v[32:33], v[44:45]
    v_pk_add_f32 v[44:45], v[32:33], v[44:45] neg_lo:[0,1] neg_hi:[0,1]
    v_pk_add_f32 v[58:59], v[34:35], v[38:39]
    v_pk_add_f32 v[38:39], v[34:35], v[38:39] neg_lo:[0,1] neg_hi:[0,1]
    v_add_f32 v62, v38, v39
    v_sub_f32 v63, v39, v38
    v_mul_f32 v62, 0x3f3504f3, v62
    v_mul_f32 v63, 0x3f3504f3, v63
    v_pk_add_f32 v[54:55], v[42:43], v[46:47]
    v_sub_f32 v40, v43, v47
    v_sub_f32 v41, v46, v42
    v_pk_add_f32 v[52:53], v[36:37], v[48:49]
    v_pk_add_f32 v[48:49], v[36:37], v[48:49] neg_lo:[0,1] neg_hi:[0,1]
    v_sub_f32 v60, v49, v48
    v_add_f32 v61, v48, v49
    v_mul_f32 v60, 0x3f3504f3, v60
    v_mul_f32 v61, 0xbf3504f3, v61
    v_pk_add_f32 v[72:73], v[50:51], v[54:55]
    v_pk_add_f32 v[54:55], v[50:51], v[54:55] neg_lo:[0,1] neg_hi:[0,1]
    v_pk_add_f32 v[56:57], v[58:59], v[52:53]
    v_sub_f32 v78, v59, v53
    v_sub_f32 v79, v52, v58
    v_pk_add_f32 v[70:71], v[72:73], v[56:57]
    v_pk_add_f32 v[56:57], v[72:73], v[56:57] neg_lo:[0,1] neg_hi:[0,1]
    v_pk_add_f32 v[80:81], v[54:55], v[78:79]
    v_pk_add_f32 v[78:79], v[54:55], v[78:79] neg_lo:[0,1] neg_hi:[0,1]
    v_pk_add_f32 v[64:65], v[44:45], v[40:41]
    v_pk_add_f32 v[40:41], v[44:45], v[40:41] neg_lo:[0,1] neg_hi:[0,1]
    v_pk_add_f32 v[74:75], v[62:63], v[60:61]
    v_sub_f32 v66, v63, v61
    v_sub_f32 v67, v60, v62
    v_pk_add_f32 v[76:77], v[64:65], v[74:75]
    v_pk_add_f32 v[74:75], v[64:65], v[74:75] neg_lo:[0,1] neg_hi:[0,1]
    v_pk_add_f32 v[68:69], v[40:41], v[66:67]
    v_pk_add_f32 v[66:67], v[40:41], v[66:67] neg_lo:[0,1] neg_hi:[0,1]
    s_waitcnt vmcnt(8)
    v_pk_mul_f32 v[82:83], v[76:77], v[112:113] op_sel:[0,0] op_sel_hi:[1,0]
    v_pk_fma_f32 v[82:83], v[76:77], v[112:113], v[82:83] op_sel:[1,1,0] op_sel_hi:[0,1,1] neg_lo:[1,0,0]
    v_pk_mul_f32 v[84:85], v[80:81], v[114:115] op_sel:[0,0] op_sel_hi:[1,0]
    v_pk_fma_f32 v[84:85], v[80:81], v[114:115], v[84:85] op_sel:[1,1,0] op_sel_hi:[0,1,1] neg_lo:[1,0,0]
    v_pk_mul_f32 v[86:87], v[68:69], v[116:117] op_sel:[0,0] op_sel_hi:[1,0]
    v_pk_fma_f32 v[86:87], v[68:69], v[116:117], v[86:87] op_sel:[1,1,0] op_sel_hi:[0,1,1] neg_lo:[1,0,0]
    v_pk_mul_f32 v[88:89], v[56:57], v[118:119] op_sel:[0,0] op_sel_hi:[1,0]
    v_pk_fma_f32 v[88:89], v[56:57], v[118:119], v[88:89] op_sel:[1,1,0] op_sel_hi:[0,1,1] neg_lo:[1,0,0]
    v_pk_mul_f32 v[90:91], v[74:75], v[120:121] op_sel:[0,0] op_sel_hi:[1,0]
    v_pk_fma_f32 v[90:91], v[74:75], v[120:121], v[90:91] op_sel:[1,1,0] op_sel_hi:[0,1,1] neg_lo:[1,0,0]
    v_pk_mul_f32 v[92:93], v[78:79], v[122:123] op_sel:[0,0] op_sel_hi:[1,0]
    v_pk_fma_f32 v[92:93], v[78:79], v[122:123], v[92:93] op_sel:[1,1,0] op_sel_hi:[0,1,1] neg_lo:[1,0,0]
    v_pk_mul_f32 v[94:95], v[66:67], v[124:125] op_sel:[0,0] op_sel_hi:[1,0]
    v_pk_fma_f32 v[94:95], v[66:67], v[124:125], v[94:95] op_sel:[1,1,0] op_sel_hi:[0,1,1] neg_lo:[1,0,0]
    v_and_b32 v6, 7, v1
    v_mul_u32_u24 v6, 74, v6
    v_lshrrev_b32 v7, 3, v1
    v_add_u32 v6, v6, v7
    v_lshlrev_b32 v6, 3, v6
    v_add_u32 v6, s33, v6
    ds_write_b64 v6, v[70:71] offset:0
    ds_write_b64 v6, v[82:83] offset:64
    ds_write_b64 v6, v[84:85] offset:128
    ds_write_b64 v6, v[86:87] offset:192
    ds_write_b64 v6, v[88:89] offset:256
    ds_write_b64 v6, v[90:91] offset:320
    ds_write_b64 v6, v[92:93] offset:384
    ds_write_b64 v6, v[94:95] offset:448
    s_waitcnt lgkmcnt(0)
    ds_read_b64 v[32:33], v4 offset:0
    ds_read_b64 v[34:35], v4 offset:592
    ds_read_b64 v[38:39], v4 offset:1184
    ds_read_b64 v[42:43], v4 offset:1776
    ds_read_b64 v[46:47], v4 offset:2368
    ds_read_b64 v[36:37], v4 offset:2960
    ds_read_b64 v[48:49], v4 offset:3552
    ds_read_b64 v[50:51], v4 offset:4144
    s_waitcnt lgkmcnt(0)
    v_pk_add_f32 v[58:59], v[32:33], v[46:47]
    v_pk_add_f32 v[46:47], v[32:33], v[46:47] neg_lo:[0,1] neg_hi:[0,1]
    v_pk_add_f32 v[52:53], v[34:35], v[36:37]
    v_pk_add_f32 v[36:37], v[34:35], v[36:37] neg_lo:[0,1] neg_hi:[0,1]
    v_add_f32 v72, v36, v37
    v_sub_f32 v73, v37, v36
    v_mul_f32 v72, 0x3f3504f3, v72
    v_mul_f32 v73, 0x3f3504f3, v73
    v_pk_add_f32 v[54:55], v[38:39], v[48:49]
    v_sub_f32 v44, v39, v49
    v_sub_f32 v45, v48, v38
    v_pk_add_f32 v[62:63], v[42:43], v[50:51]
    v_pk_add_f32 v[50:51], v[42:43], v[50:51] neg_lo:[0,1] neg_hi:[0,1]
    v_sub_f32 v60, v51, v50
    v_add_f32 v61, v50, v51
    v_mul_f32 v60, 0x3f3504f3, v60
    v_mul_f32 v61, 0xbf3504f3, v61
    v_pk_add_f32 v[64:65], v[58:59], v[54:55]
    v_pk_add_f32 v[54:55], v[58:59], v[54:55] neg_lo:[0,1] neg_hi:[0,1]
    v_pk_add_f32 v[40:41], v[52:53], v[62:63]
    v_sub_f32 v76, v53, v63
    v_sub_f32 v77, v62, v52
    v_pk_add_f32 v[80:81], v[64:65], v[40:41]
    v_pk_add_f32 v[40:41], v[64:65], v[40:41] neg_lo:[0,1] neg_hi:[0,1]
    v_pk_add_f32 v[68:69], v[54:55], v[76:77]
    v_pk_add_f32 v[76:77], v[54:55], v[76:77] neg_lo:[0,1] neg_hi:[0,1]
    v_pk_add_f32 v[56:57], v[46:47], v[44:45]
    v_pk_add_f32 v[44:45], v[46:47], v[44:45] neg_lo:[0,1] neg_hi:[0,1]
    v_pk_add_f32 v[74:75], v[72:73], v[60:61]
    v_sub_f32 v78, v73, v61
    v_sub_f32 v79, v60, v72
    v_pk_add_f32 v[66:67], v[56:57], v[74:75]
    v_pk_add_f32 v[74:75], v[56:57], v[74:75] neg_lo:[0,1] neg_hi:[0,1]
    v_pk_add_f32 v[70:71], v[44:45], v[78:79]
    v_pk_add_f32 v[78:79], v[44:45], v[78:79] neg_lo:[0,1] neg_hi:[0,1]
    s_mul_i32 s34, s22, 4128
    s_add_u32 s34, s34, 40960
    v_lshlrev_b32 v7, 3, v1
    v_add_u32 v7, s34, v7
    ds_write_b64 v7, v[80:81] offset:0
    ds_write_b64 v7, v[66:67] offset:512
    ds_write_b64 v7, v[68:69] offset:1024
    ds_write_b64 v7, v[70:71] offset:1536
    ds_write_b64 v7, v[40:41] offset:2048
    ds_write_b64 v7, v[74:75] offset:2560
    ds_write_b64 v7, v[76:77] offset:3072
    ds_write_b64 v7, v[78:79] offset:3584
    s_waitcnt lgkmcnt(0)
    s_barrier
    v_lshrrev_b32 v4, 2, v0
    v_and_b32 v5, 3, v0
    v_mul_u32_u24 v6, 8256, v5
    v_lshlrev_b32 v7, 3, v4
    v_add_u32 v6, v6, v7
    v_add_u32 v6, 40960, v6
    ds_read_b64 v[48:49], v6 offset:0
    ds_read_b64 v[50:51], v6 offset:4128
    ds_read_b64 v[52:53], v6 offset:1024
    ds_read_b64 v[54:55], v6 offset:5152
    ds_read_b64 v[56:57], v6 offset:2048
    ds_read_b64 v[58:59], v6 offset:6176
    ds_read_b64 v[60:61], v6 offset:3072
    ds_read_b64 v[62:63], v6 offset:7200
    v_lshlrev_b32 v4, 14, v4
    v_lshlrev_b32 v5, 4, v5
    v_add_u32 v4, v4, v5
    s_lshl_b32 s35, s20, 3
    s_add_u32 s35, s35, 33554432
    s_waitcnt lgkmcnt(6)
    buffer_store_dwordx4 v[48:51], v4, s[16:19], s35 offen
    s_add_u32 s35, s35, 2097152
    s_waitcnt lgkmcnt(4)
    buffer_store_dwordx4 v[52:55], v4, s[16:19], s35 offen
    s_add_u32 s35, s35, 2097152
    s_waitcnt lgkmcnt(2)
    buffer_store_dwordx4 v[56:59], v4, s[16:19], s35 offen
    s_add_u32 s35, s35, 2097152
    s_waitcnt lgkmcnt(0)
    buffer_store_dwordx4 v[60:63], v4, s[16:19], s35 offen
    s_waitcnt vmcnt(0)
    s_endpgm
k1_wt:
    s_sub_u32 s20, s2, 256
    s_mul_i32 s21, s20, 7282
    s_lshr_b32 s21, s21, 16
    s_mul_i32 s23, s21, 9
    s_sub_u32 s20, s20, s23
    s_mov_b32 s12, s8
    s_mov_b32 s13, s9
    s_mov_b32 s14, 2101248
    s_mov_b32 s15, 0x00020000
    s_mov_b32 s24, s10
    s_mov_b32 s25, s11
    s_mov_b32 s26, 2101248
    s_mov_b32 s27, 0x00020000
    v_and_b32 v2, 63, v0
    v_lshrrev_b32 v3, 6, v0
    v_mul_u32_u24 v4, 1026, v3
    v_lshlrev_b32 v5, 1, v2
    v_add_u32 v4, v4, v5
    s_mul_i32 s30, s21, 65664
    s_lshl_b32 s31, s20, 7
    s_add_u32 s30, s30, s31
    buffer_load_ushort v16, v4, s[12:15], s30 offen
    buffer_load_ushort v24, v4, s[24:27], s30 offen
    s_add_u32 s30, s30, 8208
    buffer_load_ushort v17, v4, s[12:15], s30 offen
    buffer_load_ushort v25, v4, s[24:27], s30 offen
    s_add_u32 s30, s30, 8208
    buffer_load_ushort v18, v4, s[12:15], s30 offen
    buffer_load_ushort v26, v4, s[24:27], s30 offen
    s_add_u32 s30, s30, 8208
    buffer_load_ushort v19, v4, s[12:15], s30 offen
    buffer_load_ushort v27, v4, s[24:27], s30 offen
    s_add_u32 s30, s30, 8208
    buffer_load_ushort v20, v4, s[12:15], s30 offen
    buffer_load_ushort v28, v4, s[24:27], s30 offen
    s_add_u32 s30, s30, 8208
    buffer_load_ushort v21, v4, s[12:15], s30 offen
    buffer_load_ushort v29, v4, s[24:27], s30 offen
    s_add_u32 s30, s30, 8208
    buffer_load_ushort v22, v4, s[12:15], s30 offen
    buffer_load_ushort v30, v4, s[24:27], s30 offen
    s_add_u32 s30, s30, 8208
    buffer_load_ushort v23, v4, s[12:15], s30 offen
    buffer_load_ushort v31, v4, s[24:27], s30 offen
    v_mul_u32_u24 v6, 260, v3
    v_lshlrev_b32 v7, 2, v2
    v_add_u32 v6, v6, v7
    s_waitcnt vmcnt(14)
    v_lshlrev_b32 v24, 16, v24
    v_or_b32 v16, v16, v24
    ds_write_b32 v6, v16 offset:0
    s_waitcnt vmcnt(12)
    v_lshlrev_b32 v25, 16, v25
    v_or_b32 v17, v17, v25
    ds_write_b32 v6, v17 offset:2080
    s_waitcnt vmcnt(10)
    v_lshlrev_b32 v26, 16, v26
    v_or_b32 v18, v18, v26
    ds_write_b32 v6, v18 offset:4160
    s_waitcnt vmcnt(8)
    v_lshlrev_b32 v27, 16, v27
    v_or_b32 v19, v19, v27
    ds_write_b32 v6, v19 offset:6240
    s_waitcnt vmcnt(6)
    v_lshlrev_b32 v28, 16, v28
    v_or_b32 v20, v20, v28
    ds_write_b32 v6, v20 offset:8320
    s_waitcnt vmcnt(4)
    v_lshlrev_b32 v29, 16, v29
    v_or_b32 v21, v21, v29
    ds_write_b32 v6, v21 offset:10400
    s_waitcnt vmcnt(2)
    v_lshlrev_b32 v30, 16, v30
    v_or_b32 v22, v22, v30
    ds_write_b32 v6, v22 offset:12480
    s_waitcnt vmcnt(0)
    v_lshlrev_b32 v31, 16, v31
    v_or_b32 v23, v23, v31
    ds_write_b32 v6, v23 offset:14560
    s_waitcnt lgkmcnt(0)
    s_barrier
    v_mul_u32_u24 v6, 260, v2
    v_lshlrev_b32 v7, 2, v3
    v_add_u32 v6, v6, v7
    ds_read_b32 v16, v6 offset:0
    ds_read_b32 v17, v6 offset:32
    ds_read_b32 v18, v6 offset:64
    ds_read_b32 v19, v6 offset:96
    ds_read_b32 v20, v6 offset:128
    ds_read_b32 v21, v6 offset:160
    ds_read_b32 v22, v6 offset:192
    ds_read_b32 v23, v6 offset:224
    v_lshlrev_b32 v4, 13, v3
    v_lshlrev_b32 v5, 2, v2
    v_add_u32 v4, v4, v5
    s_lshl_b32 s30, s20, 19
    s_lshl_b32 s31, s21, 8
    s_add_u32 s30, s30, s31
    s_add_u32 s30, s30, 50331648
    s_lshl_b32 s31, s20, 6
    s_waitcnt lgkmcnt(7)
    v_add_u32 v8, 0, v3
    v_add_u32 v8, s31, v8
    v_cmp_ge_u32 vcc, 512, v8
    s_and_saveexec_b64 s[32:33], vcc
    buffer_store_dword v16, v4, s[16:19], s30 offen
    s_mov_b64 exec, s[32:33]
    s_add_u32 s30, s30, 65536
    s_waitcnt lgkmcnt(6)
    v_add_u32 v8, 8, v3
    v_add_u32 v8, s31, v8
    v_cmp_ge_u32 vcc, 512, v8
    s_and_saveexec_b64 s[32:33], vcc
    buffer_store_dword v17, v4, s[16:19], s30 offen
    s_mov_b64 exec, s[32:33]
    s_add_u32 s30, s30, 65536
    s_waitcnt lgkmcnt(5)
    v_add_u32 v8, 16, v3
    v_add_u32 v8, s31, v8
    v_cmp_ge_u32 vcc, 512, v8
    s_and_saveexec_b64 s[32:33], vcc
    buffer_store_dword v18, v4, s[16:19], s30 offen
    s_mov_b64 exec, s[32:33]
    s_add_u32 s30, s30, 65536
    s_waitcnt lgkmcnt(4)
    v_add_u32 v8, 24, v3
    v_add_u32 v8, s31, v8
    v_cmp_ge_u32 vcc, 512, v8
    s_and_saveexec_b64 s[32:33], vcc
    buffer_store_dword v19, v4, s[16:19], s30 offen
    s_mov_b64 exec, s[32:33]
    s_add_u32 s30, s30, 65536
    s_waitcnt lgkmcnt(3)
    v_add_u32 v8, 32, v3
    v_add_u32 v8, s31, v8
    v_cmp_ge_u32 vcc, 512, v8
    s_and_saveexec_b64 s[32:33], vcc
    buffer_store_dword v20, v4, s[16:19], s30 offen
    s_mov_b64 exec, s[32:33]
    s_add_u32 s30, s30, 65536
    s_waitcnt lgkmcnt(2)
    v_add_u32 v8, 40, v3
    v_add_u32 v8, s31, v8
    v_cmp_ge_u32 vcc, 512, v8
    s_and_saveexec_b64 s[32:33], vcc
    buffer_store_dword v21, v4, s[16:19], s30 offen
    s_mov_b64 exec, s[32:33]
    s_add_u32 s30, s30, 65536
    s_waitcnt lgkmcnt(1)
    v_add_u32 v8, 48, v3
    v_add_u32 v8, s31, v8
    v_cmp_ge_u32 vcc, 512, v8
    s_and_saveexec_b64 s[32:33], vcc
    buffer_store_dword v22, v4, s[16:19], s30 offen
    s_mov_b64 exec, s[32:33]
    s_add_u32 s30, s30, 65536
    s_waitcnt lgkmcnt(0)
    v_add_u32 v8, 56, v3
    v_add_u32 v8, s31, v8
    v_cmp_ge_u32 vcc, 512, v8
    s_and_saveexec_b64 s[32:33], vcc
    buffer_store_dword v23, v4, s[16:19], s30 offen
    s_mov_b64 exec, s[32:33]
    s_waitcnt vmcnt(0)
    s_endpgm
k1_pf:
    s_mov_b32 s20, s2
    s_mul_i32 s21, s20, 2341
    s_lshr_b32 s21, s21, 16
    s_mul_i32 s23, s21, 28
    s_sub_u32 s20, s20, s23
    s_lshl_b32 s23, s21, 3
    s_add_u32 s23, s23, 32
    s_load_dwordx2 s[12:13], s[0:1], s23
    s_waitcnt lgkmcnt(0)
    s_mov_b32 s14, 7340032
    s_mov_b32 s15, 0x00020000
    s_mul_i32 s24, s20, 262144
    v_lshlrev_b32 v2, 4, v0
    buffer_load_dwordx4 v[16:19], v2, s[12:15], s24 offen
    s_add_u32 s24, s24, 8192
    buffer_load_dwordx4 v[20:23], v2, s[12:15], s24 offen
    s_add_u32 s24, s24, 8192
    buffer_load_dwordx4 v[24:27], v2, s[12:15], s24 offen
    s_add_u32 s24, s24, 8192
    buffer_load_dwordx4 v[28:31], v2, s[12:15], s24 offen
    s_add_u32 s24, s24, 8192
    buffer_load_dwordx4 v[32:35], v2, s[12:15], s24 offen
    s_add_u32 s24, s24, 8192
    buffer_load_dwordx4 v[36:39], v2, s[12:15], s24 offen
    s_add_u32 s24, s24, 8192
    buffer_load_dwordx4 v[40:43], v2, s[12:15], s24 offen
    s_add_u32 s24, s24, 8192
    buffer_load_dwordx4 v[44:47], v2, s[12:15], s24 offen
    s_add_u32 s24, s24, 8192
    buffer_load_dwordx4 v[16:19], v2, s[12:15], s24 offen
    s_add_u32 s24, s24, 8192
    buffer_load_dwordx4 v[20:23], v2, s[12:15], s24 offen
    s_add_u32 s24, s24, 8192
    buffer_load_dwordx4 v[24:27], v2, s[12:15], s24 offen
    s_add_u32 s24, s24, 8192
    buffer_load_dwordx4 v[28:31], v2, s[12:15], s24 offen
    s_add_u32 s24, s24, 8192
    buffer_load_dwordx4 v[32:35], v2, s[12:15], s24 offen
    s_add_u32 s24, s24, 8192
    buffer_load_dwordx4 v[36:39], v2, s[12:15], s24 offen
    s_add_u32 s24, s24, 8192
    buffer_load_dwordx4 v[40:43], v2, s[12:15], s24 offen
    s_add_u32 s24, s24, 8192
    buffer_load_dwordx4 v[44:47], v2, s[12:15], s24 offen
    s_add_u32 s24, s24, 8192
    buffer_load_dwordx4 v[16:19], v2, s[12:15], s24 offen
    s_add_u32 s24, s24, 8192
    buffer_load_dwordx4 v[20:23], v2, s[12:15], s24 offen
    s_add_u32 s24, s24, 8192
    buffer_load_dwordx4 v[24:27], v2, s[12:15], s24 offen
    s_add_u32 s24, s24, 8192
    buffer_load_dwordx4 v[28:31], v2, s[12:15], s24 offen
    s_add_u32 s24, s24, 8192
    buffer_load_dwordx4 v[32:35], v2, s[12:15], s24 offen
    s_add_u32 s24, s24, 8192
    buffer_load_dwordx4 v[36:39], v2, s[12:15], s24 offen
    s_add_u32 s24, s24, 8192
    buffer_load_dwordx4 v[40:43], v2, s[12:15], s24 offen
    s_add_u32 s24, s24, 8192
    buffer_load_dwordx4 v[44:47], v2, s[12:15], s24 offen
    s_add_u32 s24, s24, 8192
    buffer_load_dwordx4 v[16:19], v2, s[12:15], s24 offen
    s_add_u32 s24, s24, 8192
    buffer_load_dwordx4 v[20:23], v2, s[12:15], s24 offen
    s_add_u32 s24, s24, 8192
    buffer_load_dwordx4 v[24:27], v2, s[12:15], s24 offen
    s_add_u32 s24, s24, 8192
    buffer_load_dwordx4 v[28:31], v2, s[12:15], s24 offen
    s_add_u32 s24, s24, 8192
    buffer_load_dwordx4 v[32:35], v2, s[12:15], s24 offen
    s_add_u32 s24, s24, 8192
    buffer_load_dwordx4 v[36:39], v2, s[12:15], s24 offen
    s_add_u32 s24, s24, 8192
    buffer_load_dwordx4 v[40:43], v2, s[12:15], s24 offen
    s_add_u32 s24, s24, 8192
    buffer_load_dwordx4 v[44:47], v2, s[12:15], s24 offen
    s_add_u32 s24, s24, 8192
    s_waitcnt vmcnt(0)
k1_end:
    s_endpgm

.globl gemm1_kernel
.p2align 8
.type gemm1_kernel,@function
gemm1_kernel:
    s_cmp_ge_u32 s2, 256
    s_cbranch_scc1 g1_end
    s_load_dwordx2 s[4:5], s[0:1], 32
    s_load_dwordx2 s[6:7], s[0:1], 40
    s_load_dwordx2 s[8:9], s[0:1], 72
    s_and_b32 s23, s2, 7
    s_lshr_b32 s31, s2, 3
    s_and_b32 s20, s23, 3
    s_lshl_b32 s20, s20, 3
    s_and_b32 s32, s31, 7
    s_add_u32 s20, s20, s32
    s_lshr_b32 s21, s23, 2
    s_lshl_b32 s21, s21, 2
    s_lshr_b32 s32, s31, 3
    s_add_u32 s21, s21, s32
    v_lshrrev_b32 v10, 6, v0
    v_and_b32 v1, 63, v0
    s_nop 0
    v_readfirstlane_b32 s22, v10
    s_waitcnt lgkmcnt(0)
    s_cmp_lt_u32 s22, 4
    s_cselect_b32 s12, s4, s6
    s_cselect_b32 s13, s5, s7
    s_mov_b32 s14, 7340032
    s_mov_b32 s15, 0x00020000
    s_mov_b32 s16, s8
    s_mov_b32 s17, s9
    s_mov_b32 s18, 268435456
    s_mov_b32 s19, 0x00020000
    s_and_b32 s23, s22, 3
    s_mul_i32 s23, s23, 224
    s_mul_i32 s31, s20, 224
    v_add_u32 v10, 0, v1
    v_add_u32 v10, s23, v10
    v_mul_u32_u24 v11, 4682, v10
    v_lshrrev_b32 v11, 16, v11
    v_mul_u32_u24 v12, 14, v11
    v_sub_u32 v12, v10, v12
    v_mul_u32_u24 v11, 7168, v11
    v_lshlrev_b32 v12, 4, v12
    v_add3_u32 v2, v11, v12, s31
    v_add_u32 v10, 64, v1
    v_add_u32 v10, s23, v10
    v_mul_u32_u24 v11, 4682, v10
    v_lshrrev_b32 v11, 16, v11
    v_mul_u32_u24 v12, 14, v11
    v_sub_u32 v12, v10, v12
    v_mul_u32_u24 v11, 7168, v11
    v_lshlrev_b32 v12, 4, v12
    v_add3_u32 v3, v11, v12, s31
    v_add_u32 v10, 128, v1
    v_add_u32 v10, s23, v10
    v_mul_u32_u24 v11, 4682, v10
    v_lshrrev_b32 v11, 16, v11
    v_mul_u32_u24 v12, 14, v11
    v_sub_u32 v12, v10, v12
    v_mul_u32_u24 v11, 7168, v11
    v_lshlrev_b32 v12, 4, v12
    v_add3_u32 v4, v11, v12, s31
    v_add_u32 v10, 192, v1
    v_add_u32 v10, s23, v10
    v_mul_u32_u24 v11, 4682, v10
    v_lshrrev_b32 v11, 16, v11
    v_mul_u32_u24 v12, 14, v11
    v_sub_u32 v12, v10, v12
    v_mul_u32_u24 v11, 7168, v11
    v_lshlrev_b32 v12, 4, v12
    v_add3_u32 v5, v11, v12, s31
    v_lshlrev_b32 v6, 4, v1
    v_lshrrev_b32 v10, 5, v1
    v_lshlrev_b32 v10, 3, v10
    v_bfe_u32 v11, v1, 2, 2
    v_add_u32 v10, v10, v11
    v_mul_u32_u24 v10, 224, v10
    v_bfe_u32 v11, v1, 4, 1
    v_mul_u32_u24 v11, 14464, v11
    v_and_b32 v12, 3, v1
    v_lshlrev_b32 v12, 3, v12
    v_add3_u32 v7, v10, v11, v12
    s_mov_b32 s24, 0
    s_lshl_b32 s25, s21, 3
    s_add_u32 s25, s25, s22
    s_lshl_b32 s25, s25, 16
    s_and_b32 s23, s22, 3
    s_mul_i32 s29, s23, 3584
    s_cmp_lt_u32 s22, 4
    s_cselect_b32 s23, 0, 14464
    s_add_u32 s29, s29, s23
    s_mov_b32 s26, 0
    s_mov_b32 s27, 28800
    s_mov_b32 s28, 57600
    s_add_u32 s23, s26, s29
    s_mov_b32 m0, s23
    s_nop 0
    buffer_load_dwordx4 v2, s[12:15], s24 offen lds
    s_add_u32 s23, s26, s29
    s_add_u32 m0, s23, 1024
    s_nop 0
    buffer_load_dwordx4 v3, s[12:15], s24 offen lds
    s_add_u32 s23, s26, s29
    s_add_u32 m0, s23, 2048
    s_nop 0
    buffer_load_dwordx4 v4, s[12:15], s24 offen lds
    s_add_u32 s23, s26, s29
    s_add_u32 m0, s23, 3072
    s_mov_b32 exec_hi, 0
    buffer_load_dwordx4 v5, s[12:15], s24 offen lds
    s_mov_b32 exec_hi, -1
    s_add_u32 s24, s24, 458752
    s_add_u32 s23, s27, s29
    s_mov_b32 m0, s23
    s_nop 0
    buffer_load_dwordx4 v2, s[12:15], s24 offen lds
    s_add_u32 s23, s27, s29
    s_add_u32 m0, s23, 1024
    s_nop 0
    buffer_load_dwordx4 v3, s[12:15], s24 offen lds
    s_add_u32 s23, s27, s29
    s_add_u32 m0, s23, 2048
    s_nop 0
    buffer_load_dwordx4 v4, s[12:15], s24 offen lds
    s_add_u32 s23, s27, s29
    s_add_u32 m0, s23, 3072
    s_mov_b32 exec_hi, 0
    buffer_load_dwordx4 v5, s[12:15], s24 offen lds
    s_mov_b32 exec_hi, -1
    s_add_u32 s24, s24, 458752
    buffer_load_dwordx4 v[32:35], v6, s[16:19], s25 offen offset:0
    buffer_load_dwordx4 v[36:39], v6, s[16:19], s25 offen offset:1024
    buffer_load_dwordx4 v[40:43], v6, s[16:19], s25 offen offset:2048
    buffer_load_dwordx4 v[44:47], v6, s[16:19], s25 offen offset:3072
    s_add_u32 s25, s25, 4096
    s_add_u32 s23, s28, s29
    s_mov_b32 m0, s23
    s_nop 0
    buffer_load_dwordx4 v2, s[12:15], s24 offen lds
    s_add_u32 s23, s28, s29
    s_add_u32 m0, s23, 1024
    s_nop 0
    buffer_load_dwordx4 v3, s[12:15], s24 offen lds
    s_add_u32 s23, s28, s29
    s_add_u32 m0, s23, 2048
    s_nop 0
    buffer_load_dwordx4 v4, s[12:15], s24 offen lds
    s_add_u32 s23, s28, s29
    s_add_u32 m0, s23, 3072
    s_mov_b32 exec_hi, 0
    buffer_load_dwordx4 v5, s[12:15], s24 offen lds
    s_mov_b32 exec_hi, -1
    s_add_u32 s24, s24, 458752
    s_mov_b32 s28, 86400
    v_mov_b32 v128, 0
    v_mov_b32 v129, 0
    v_mov_b32 v130, 0
    v_mov_b32 v131, 0
    v_mov_b32 v132, 0
    v_mov_b32 v133, 0
    v_mov_b32 v134, 0
    v_mov_b32 v135, 0
    v_mov_b32 v136, 0
    v_mov_b32 v137, 0
    v_mov_b32 v138, 0
    v_mov_b32 v139, 0
    v_mov_b32 v140, 0
    v_mov_b32 v141, 0
    v_mov_b32 v142, 0
    v_mov_b32 v143, 0
    v_mov_b32 v144, 0
    v_mov_b32 v145, 0
    v_mov_b32 v146, 0
    v_mov_b32 v147, 0
    v_mov_b32 v148, 0
    v_mov_b32 v149, 0
    v_mov_b32 v150, 0
    v_mov_b32 v151, 0
    v_mov_b32 v152, 0
    v_mov_b32 v153, 0
    v_mov_b32 v154, 0
    v_mov_b32 v155, 0
    v_mov_b32 v156, 0
    v_mov_b32 v157, 0
    v_mov_b32 v158, 0
    v_mov_b32 v159, 0
    v_mov_b32 v160, 0
    v_mov_b32 v161, 0
    v_mov_b32 v162, 0
    v_mov_b32 v163, 0
    v_mov_b32 v164, 0
    v_mov_b32 v165, 0
    v_mov_b32 v166, 0
    v_mov_b32 v167, 0
    v_mov_b32 v168, 0
    v_mov_b32 v169, 0
    v_mov_b32 v170, 0
    v_mov_b32 v171, 0
    v_mov_b32 v172, 0
    v_mov_b32 v173, 0
    v_mov_b32 v174, 0
    v_mov_b32 v175, 0
    v_mov_b32 v176, 0
    v_mov_b32 v177, 0
    v_mov_b32 v178, 0
    v_mov_b32 v179, 0
    v_mov_b32 v180, 0
    v_mov_b32 v181, 0
    v_mov_b32 v182, 0
    v_mov_b32 v183, 0
    v_mov_b32 v184, 0
    v_mov_b32 v185, 0
    v_mov_b32 v186, 0
    v_mov_b32 v187, 0
    v_mov_b32 v188, 0
    v_mov_b32 v189, 0
    v_mov_b32 v190, 0
    v_mov_b32 v191, 0
    v_mov_b32 v192, 0
    v_mov_b32 v193, 0
    v_mov_b32 v194, 0
    v_mov_b32 v195, 0
    v_mov_b32 v196, 0
    v_mov_b32 v197, 0
    v_mov_b32 v198, 0
    v_mov_b32 v199, 0
    v_mov_b32 v200, 0
    v_mov_b32 v201, 0
    v_mov_b32 v202, 0
    v_mov_b32 v203, 0
    v_mov_b32 v204, 0
    v_mov_b32 v205, 0
    v_mov_b32 v206, 0
    v_mov_b32 v207, 0
    v_mov_b32 v208, 0
    v_mov_b32 v209, 0
    v_mov_b32 v210, 0
    v_mov_b32 v211, 0
    v_mov_b32 v212, 0
    v_mov_b32 v213, 0
    v_mov_b32 v214, 0
    v_mov_b32 v215, 0
    v_mov_b32 v216, 0
    v_mov_b32 v217, 0
    v_mov_b32 v218, 0
    v_mov_b32 v219, 0
    v_mov_b32 v220, 0
    v_mov_b32 v221, 0
    v_mov_b32 v222, 0
    v_mov_b32 v223, 0
    v_mov_b32 v224, 0
    v_mov_b32 v225, 0
    v_mov_b32 v226, 0
    v_mov_b32 v227, 0
    v_mov_b32 v228, 0
    v_mov_b32 v229, 0
    v_mov_b32 v230, 0
    v_mov_b32 v231, 0
    v_mov_b32 v232, 0
    v_mov_b32 v233, 0
    v_mov_b32 v234, 0
    v_mov_b32 v235, 0
    v_mov_b32 v236, 0
    v_mov_b32 v237, 0
    v_mov_b32 v238, 0
    v_mov_b32 v239, 0
    v_mov_b32 v8, v7
    v_add_u32 v9, s27, v7
    s_waitcnt vmcnt(12)
    s_barrier
    ds_read_b64_tr_b16 v[64:65], v8 offset:0
    ds_read_b64_tr_b16 v[66:67], v8 offset:896
    ds_read_b64_tr_b16 v[68:69], v8 offset:32
    ds_read_b64_tr_b16 v[70:71], v8 offset:928
    ds_read_b64_tr_b16 v[72:73], v8 offset:64
    ds_read_b64_tr_b16 v[74:75], v8 offset:960
    ds_read_b64_tr_b16 v[76:77], v8 offset:96
    ds_read_b64_tr_b16 v[78:79], v8 offset:992
    ds_read_b64_tr_b16 v[80:81], v8 offset:128
    ds_read_b64_tr_b16 v[82:83], v8 offset:1024
    ds_read_b64_tr_b16 v[84:85], v8 offset:160
    ds_read_b64_tr_b16 v[86:87], v8 offset:1056
    ds_read_b64_tr_b16 v[88:89], v8 offset:192
    ds_read_b64_tr_b16 v[90:91], v8 offset:1088
    s_mov_b32 s30, 8
g1_loop:
    buffer_load_dwordx4 v[48:51], v6, s[16:19], s25 offen offset:0
    buffer_load_dwordx4 v[52:55], v6, s[16:19], s25 offen offset:1024
    buffer_load_dwordx4 v[56:59], v6, s[16:19], s25 offen offset:2048
    buffer_load_dwordx4 v[60:63], v6, s[16:19], s25 offen offset:3072
    s_add_u32 s25, s25, 4096
    s_waitcnt vmcnt(8)
    s_waitcnt lgkmcnt(12)
    v_mfma_f32_32x32x16_bf16 v[128:143], v[64:67], v[32:35], v[128:143]
    ds_read_b64_tr_b16 v[92:93], v8 offset:3584
    ds_read_b64_tr_b16 v[94:95], v8 offset:4480
    s_waitcnt lgkmcnt(12)
    v_mfma_f32_32x32x16_bf16 v[144:159], v[68:71], v[32:35], v[144:159]
    ds_read_b64_tr_b16 v[96:97], v8 offset:3616
    ds_read_b64_tr_b16 v[98:99], v8 offset:4512
    s_waitcnt lgkmcnt(12)
    v_mfma_f32_32x32x16_bf16 v[160:175], v[72:75], v[32:35], v[160:175]
    ds_read_b64_tr_b16 v[100:101], v8 offset:3648
    ds_read_b64_tr_b16 v[102:103], v8 offset:4544
    s_waitcnt lgkmcnt(12)
    v_mfma_f32_32x32x16_bf16 v[176:191], v[76:79], v[32:35], v[176:191]
    ds_read_b64_tr_b16 v[104:105], v8 offset:3680
    ds_read_b64_tr_b16 v[106:107], v8 offset:4576
    s_waitcnt lgkmcnt(12)
    v_mfma_f32_32x32x16_bf16 v[192:207], v[80:83], v[32:35], v[192:207]
    ds_read_b64_tr_b16 v[108:109], v8 offset:3712
    ds_read_b64_tr_b16 v[110:111], v8 offset:4608
    s_waitcnt lgkmcnt(12)
    v_mfma_f32_32x32x16_bf16 v[208:223], v[84:87], v[32:35], v[208:223]
    ds_read_b64_tr_b16 v[112:113], v8 offset:3744
    ds_read_b64_tr_b16 v[114:115], v8 offset:4640
    s_waitcnt lgkmcnt(12)
    v_mfma_f32_32x32x16_bf16 v[224:239], v[88:91], v[32:35], v[224:239]
    ds_read_b64_tr_b16 v[116:117], v8 offset:3776
    ds_read_b64_tr_b16 v[118:119], v8 offset:4672
    s_waitcnt lgkmcnt(12)
    v_mfma_f32_32x32x16_bf16 v[128:143], v[92:95], v[36:39], v[128:143]
    ds_read_b64_tr_b16 v[64:65], v8 offset:7168
    ds_read_b64_tr_b16 v[66:67], v8 offset:8064
    s_waitcnt lgkmcnt(12)
    v_mfma_f32_32x32x16_bf16 v[144:159], v[96:99], v[36:39], v[144:159]
    ds_read_b64_tr_b16 v[68:69], v8 offset:7200
    ds_read_b64_tr_b16 v[70:71], v8 offset:8096
    s_waitcnt lgkmcnt(12)
    v_mfma_f32_32x32x16_bf16 v[160:175], v[100:103], v[36:39], v[160:175]
    ds_read_b64_tr_b16 v[72:73], v8 offset:7232
    ds_read_b64_tr_b16 v[74:75], v8 offset:8128
    s_waitcnt lgkmcnt(12)
    v_mfma_f32_32x32x16_bf16 v[176:191], v[104:107], v[36:39], v[176:191]
    ds_read_b64_tr_b16 v[76:77], v8 offset:7264
    ds_read_b64_tr_b16 v[78:79], v8 offset:8160
    s_waitcnt lgkmcnt(12)
    v_mfma_f32_32x32x16_bf16 v[192:207], v[108:111], v[36:39], v[192:207]
    ds_read_b64_tr_b16 v[80:81], v8 offset:7296
    ds_read_b64_tr_b16 v[82:83], v8 offset:8192
    s_waitcnt lgkmcnt(12)
    v_mfma_f32_32x32x16_bf16 v[208:223], v[112:115], v[36:39], v[208:223]
    ds_read_b64_tr_b16 v[84:85], v8 offset:7328
    ds_read_b64_tr_b16 v[86:87], v8 offset:8224
    s_waitcnt lgkmcnt(12)
    v_mfma_f32_32x32x16_bf16 v[224:239], v[116:119], v[36:39], v[224:239]
    ds_read_b64_tr_b16 v[88:89], v8 offset:7360
    ds_read_b64_tr_b16 v[90:91], v8 offset:8256
    s_barrier
    s_add_u32 s23, s28, s29
    s_mov_b32 m0, s23
    s_nop 0
    buffer_load_dwordx4 v2, s[12:15], s24 offen lds
    s_add_u32 s23, s28, s29
    s_add_u32 m0, s23, 1024
    s_nop 0
    buffer_load_dwordx4 v3, s[12:15], s24 offen lds
    s_add_u32 s23, s28, s29
    s_add_u32 m0, s23, 2048
    s_nop 0
    buffer_load_dwordx4 v4, s[12:15], s24 offen lds
    s_add_u32 s23, s28, s29
    s_add_u32 m0, s23, 3072
    s_mov_b32 exec_hi, 0
    buffer_load_dwordx4 v5, s[12:15], s24 offen lds
    s_mov_b32 exec_hi, -1
    s_add_u32 s24, s24, 458752
    s_waitcnt lgkmcnt(12)
    v_mfma_f32_32x32x16_bf16 v[128:143], v[64:67], v[40:43], v[128:143]
    ds_read_b64_tr_b16 v[92:93], v8 offset:10752
    ds_read_b64_tr_b16 v[94:95], v8 offset:11648
    s_waitcnt lgkmcnt(12)
    v_mfma_f32_32x32x16_bf16 v[144:159], v[68:71], v[40:43], v[144:159]
    ds_read_b64_tr_b16 v[96:97], v8 offset:10784
    ds_read_b64_tr_b16 v[98:99], v8 offset:11680
    s_waitcnt lgkmcnt(12)
    v_mfma_f32_32x32x16_bf16 v[160:175], v[72:75], v[40:43], v[160:175]
    ds_read_b64_tr_b16 v[100:101], v8 offset:10816
    ds_read_b64_tr_b16 v[102:103], v8 offset:11712
    s_waitcnt lgkmcnt(12)
    v_mfma_f32_32x32x16_bf16 v[176:191], v[76:79], v[40:43], v[176:191]
    ds_read_b64_tr_b16 v[104:105], v8 offset:10848
    ds_read_b64_tr_b16 v[106:107], v8 offset:11744
    s_waitcnt lgkmcnt(12)
    v_mfma_f32_32x32x16_bf16 v[192:207], v[80:83], v[40:43], v[192:207]
    ds_read_b64_tr_b16 v[108:109], v8 offset:10880
    ds_read_b64_tr_b16 v[110:111], v8 offset:11776
    s_waitcnt lgkmcnt(12)
    v_mfma_f32_32x32x16_bf16 v[208:223], v[84:87], v[40:43], v[208:223]
    ds_read_b64_tr_b16 v[112:113], v8 offset:10912
    ds_read_b64_tr_b16 v[114:115], v8 offset:11808
    s_waitcnt lgkmcnt(12)
    v_mfma_f32_32x32x16_bf16 v[224:239], v[88:91], v[40:43], v[224:239]
    ds_read_b64_tr_b16 v[116:117], v8 offset:10944
    ds_read_b64_tr_b16 v[118:119], v8 offset:11840
    s_waitcnt lgkmcnt(12)
    v_mfma_f32_32x32x16_bf16 v[128:143], v[92:95], v[44:47], v[128:143]
    ds_read_b64_tr_b16 v[64:65], v9 offset:0
    ds_read_b64_tr_b16 v[66:67], v9 offset:896
    s_waitcnt lgkmcnt(12)
    v_mfma_f32_32x32x16_bf16 v[144:159], v[96:99], v[44:47], v[144:159]
    ds_read_b64_tr_b16 v[68:69], v9 offset:32
    ds_read_b64_tr_b16 v[70:71], v9 offset:928
    s_waitcnt lgkmcnt(12)
    v_mfma_f32_32x32x16_bf16 v[160:175], v[100:103], v[44:47], v[160:175]
    ds_read_b64_tr_b16 v[72:73], v9 offset:64
    ds_read_b64_tr_b16 v[74:75], v9 offset:960
    s_waitcnt lgkmcnt(12)
    v_mfma_f32_32x32x16_bf16 v[176:191], v[104:107], v[44:47], v[176:191]
    ds_read_b64_tr_b16 v[76:77], v9 offset:96
    ds_read_b64_tr_b16 v[78:79], v9 offset:992
    s_waitcnt lgkmcnt(12)
    v_mfma_f32_32x32x16_bf16 v[192:207], v[108:111], v[44:47], v[192:207]
    ds_read_b64_tr_b16 v[80:81], v9 offset:128
    ds_read_b64_tr_b16 v[82:83], v9 offset:1024
    s_waitcnt lgkmcnt(12)
    v_mfma_f32_32x32x16_bf16 v[208:223], v[112:115], v[44:47], v[208:223]
    ds_read_b64_tr_b16 v[84:85], v9 offset:160
    ds_read_b64_tr_b16 v[86:87], v9 offset:1056
    s_waitcnt lgkmcnt(12)
    v_mfma_f32_32x32x16_bf16 v[224:239], v[116:119], v[44:47], v[224:239]
    ds_read_b64_tr_b16 v[88:89], v9 offset:192
    ds_read_b64_tr_b16 v[90:91], v9 offset:1088
    v_mov_b32 v8, v9
    s_mov_b32 s26, s27
    s_add_u32 s27, s27, 28800
    s_cmp_ge_u32 s27, 115200
    s_cselect_b32 s23, 115200, 0
    s_sub_u32 s27, s27, s23
    s_add_u32 s28, s28, 28800
    s_cmp_ge_u32 s28, 115200
    s_cselect_b32 s23, 115200, 0
    s_sub_u32 s28, s28, s23
    v_add_u32 v9, s27, v7
    buffer_load_dwordx4 v[32:35], v6, s[16:19], s25 offen offset:0
    buffer_load_dwordx4 v[36:39], v6, s[16:19], s25 offen offset:1024
    buffer_load_dwordx4 v[40:43], v6, s[16:19], s25 offen offset:2048
    buffer_load_dwordx4 v[44:47], v6, s[16:19], s25 offen offset:3072
    s_add_u32 s25, s25, 4096
    s_waitcnt vmcnt(8)
    s_waitcnt lgkmcnt(12)
    v_mfma_f32_32x32x16_bf16 v[128:143], v[64:67], v[48:51], v[128:143]
    ds_read_b64_tr_b16 v[92:93], v8 offset:3584
    ds_read_b64_tr_b16 v[94:95], v8 offset:4480
    s_waitcnt lgkmcnt(12)
    v_mfma_f32_32x32x16_bf16 v[144:159], v[68:71], v[48:51], v[144:159]
    ds_read_b64_tr_b16 v[96:97], v8 offset:3616
    ds_read_b64_tr_b16 v[98:99], v8 offset:4512
    s_waitcnt lgkmcnt(12)
    v_mfma_f32_32x32x16_bf16 v[160:175], v[72:75], v[48:51], v[160:175]
    ds_read_b64_tr_b16 v[100:101], v8 offset:3648
    ds_read_b64_tr_b16 v[102:103], v8 offset:4544
    s_waitcnt lgkmcnt(12)
    v_mfma_f32_32x32x16_bf16 v[176:191], v[76:79], v[48:51], v[176:191]
    ds_read_b64_tr_b16 v[104:105], v8 offset:3680
    ds_read_b64_tr_b16 v[106:107], v8 offset:4576
    s_waitcnt lgkmcnt(12)
    v_mfma_f32_32x32x16_bf16 v[192:207], v[80:83], v[48:51], v[192:207]
    ds_read_b64_tr_b16 v[108:109], v8 offset:3712
    ds_read_b64_tr_b16 v[110:111], v8 offset:4608
    s_waitcnt lgkmcnt(12)
    v_mfma_f32_32x32x16_bf16 v[208:223], v[84:87], v[48:51], v[208:223]
    ds_read_b64_tr_b16 v[112:113], v8 offset:3744
    ds_read_b64_tr_b16 v[114:115], v8 offset:4640
    s_waitcnt lgkmcnt(12)
    v_mfma_f32_32x32x16_bf16 v[224:239], v[88:91], v[48:51], v[224:239]
    ds_read_b64_tr_b16 v[116:117], v8 offset:3776
    ds_read_b64_tr_b16 v[118:119], v8 offset:4672
    s_waitcnt lgkmcnt(12)
    v_mfma_f32_32x32x16_bf16 v[128:143], v[92:95], v[52:55], v[128:143]
    ds_read_b64_tr_b16 v[64:65], v8 offset:7168
    ds_read_b64_tr_b16 v[66:67], v8 offset:8064
    s_waitcnt lgkmcnt(12)
    v_mfma_f32_32x32x16_bf16 v[144:159], v[96:99], v[52:55], v[144:159]
    ds_read_b64_tr_b16 v[68:69], v8 offset:7200
    ds_read_b64_tr_b16 v[70:71], v8 offset:8096
    s_waitcnt lgkmcnt(12)
    v_mfma_f32_32x32x16_bf16 v[160:175], v[100:103], v[52:55], v[160:175]
    ds_read_b64_tr_b16 v[72:73], v8 offset:7232
    ds_read_b64_tr_b16 v[74:75], v8 offset:8128
    s_waitcnt lgkmcnt(12)
    v_mfma_f32_32x32x16_bf16 v[176:191], v[104:107], v[52:55], v[176:191]
    ds_read_b64_tr_b16 v[76:77], v8 offset:7264
    ds_read_b64_tr_b16 v[78:79], v8 offset:8160
    s_waitcnt lgkmcnt(12)
    v_mfma_f32_32x32x16_bf16 v[192:207], v[108:111], v[52:55], v[192:207]
    ds_read_b64_tr_b16 v[80:81], v8 offset:7296
    ds_read_b64_tr_b16 v[82:83], v8 offset:8192
    s_waitcnt lgkmcnt(12)
    v_mfma_f32_32x32x16_bf16 v[208:223], v[112:115], v[52:55], v[208:223]
    ds_read_b64_tr_b16 v[84:85], v8 offset:7328
    ds_read_b64_tr_b16 v[86:87], v8 offset:8224
    s_waitcnt lgkmcnt(12)
    v_mfma_f32_32x32x16_bf16 v[224:239], v[116:119], v[52:55], v[224:239]
    ds_read_b64_tr_b16 v[88:89], v8 offset:7360
    ds_read_b64_tr_b16 v[90:91], v8 offset:8256
    s_barrier
    s_add_u32 s23, s28, s29
    s_mov_b32 m0, s23
    s_nop 0
    buffer_load_dwordx4 v2, s[12:15], s24 offen lds
    s_add_u32 s23, s28, s29
    s_add_u32 m0, s23, 1024
    s_nop 0
    buffer_load_dwordx4 v3, s[12:15], s24 offen lds
    s_add_u32 s23, s28, s29
    s_add_u32 m0, s23, 2048
    s_nop 0
    buffer_load_dwordx4 v4, s[12:15], s24 offen lds
    s_add_u32 s23, s28, s29
    s_add_u32 m0, s23, 3072
    s_mov_b32 exec_hi, 0
    buffer_load_dwordx4 v5, s[12:15], s24 offen lds
    s_mov_b32 exec_hi, -1
    s_add_u32 s24, s24, 458752
    s_waitcnt lgkmcnt(12)
    v_mfma_f32_32x32x16_bf16 v[128:143], v[64:67], v[56:59], v[128:143]
    ds_read_b64_tr_b16 v[92:93], v8 offset:10752
    ds_read_b64_tr_b16 v[94:95], v8 offset:11648
    s_waitcnt lgkmcnt(12)
    v_mfma_f32_32x32x16_bf16 v[144:159], v[68:71], v[56:59], v[144:159]
    ds_read_b64_tr_b16 v[96:97], v8 offset:10784
    ds_read_b64_tr_b16 v[98:99], v8 offset:11680
    s_waitcnt lgkmcnt(12)
    v_mfma_f32_32x32x16_bf16 v[160:175], v[72:75], v[56:59], v[160:175]
    ds_read_b64_tr_b16 v[100:101], v8 offset:10816
    ds_read_b64_tr_b16 v[102:103], v8 offset:11712
    s_waitcnt lgkmcnt(12)
    v_mfma_f32_32x32x16_bf16 v[176:191], v[76:79], v[56:59], v[176:191]
    ds_read_b64_tr_b16 v[104:105], v8 offset:10848
    ds_read_b64_tr_b16 v[106:107], v8 offset:11744
    s_waitcnt lgkmcnt(12)
    v_mfma_f32_32x32x16_bf16 v[192:207], v[80:83], v[56:59], v[192:207]
    ds_read_b64_tr_b16 v[108:109], v8 offset:10880
    ds_read_b64_tr_b16 v[110:111], v8 offset:11776
    s_waitcnt lgkmcnt(12)
    v_mfma_f32_32x32x16_bf16 v[208:223], v[84:87], v[56:59], v[208:223]
    ds_read_b64_tr_b16 v[112:113], v8 offset:10912
    ds_read_b64_tr_b16 v[114:115], v8 offset:11808
    s_waitcnt lgkmcnt(12)
    v_mfma_f32_32x32x16_bf16 v[224:239], v[88:91], v[56:59], v[224:239]
    ds_read_b64_tr_b16 v[116:117], v8 offset:10944
    ds_read_b64_tr_b16 v[118:119], v8 offset:11840
    s_waitcnt lgkmcnt(12)
    v_mfma_f32_32x32x16_bf16 v[128:143], v[92:95], v[60:63], v[128:143]
    ds_read_b64_tr_b16 v[64:65], v9 offset:0
    ds_read_b64_tr_b16 v[66:67], v9 offset:896
    s_waitcnt lgkmcnt(12)
    v_mfma_f32_32x32x16_bf16 v[144:159], v[96:99], v[60:63], v[144:159]
    ds_read_b64_tr_b16 v[68:69], v9 offset:32
    ds_read_b64_tr_b16 v[70:71], v9 offset:928
    s_waitcnt lgkmcnt(12)
    v_mfma_f32_32x32x16_bf16 v[160:175], v[100:103], v[60:63], v[160:175]
    ds_read_b64_tr_b16 v[72:73], v9 offset:64
    ds_read_b64_tr_b16 v[74:75], v9 offset:960
    s_waitcnt lgkmcnt(12)
    v_mfma_f32_32x32x16_bf16 v[176:191], v[104:107], v[60:63], v[176:191]
    ds_read_b64_tr_b16 v[76:77], v9 offset:96
    ds_read_b64_tr_b16 v[78:79], v9 offset:992
    s_waitcnt lgkmcnt(12)
    v_mfma_f32_32x32x16_bf16 v[192:207], v[108:111], v[60:63], v[192:207]
    ds_read_b64_tr_b16 v[80:81], v9 offset:128
    ds_read_b64_tr_b16 v[82:83], v9 offset:1024
    s_waitcnt lgkmcnt(12)
    v_mfma_f32_32x32x16_bf16 v[208:223], v[112:115], v[60:63], v[208:223]
    ds_read_b64_tr_b16 v[84:85], v9 offset:160
    ds_read_b64_tr_b16 v[86:87], v9 offset:1056
    s_waitcnt lgkmcnt(12)
    v_mfma_f32_32x32x16_bf16 v[224:239], v[116:119], v[60:63], v[224:239]
    ds_read_b64_tr_b16 v[88:89], v9 offset:192
    ds_read_b64_tr_b16 v[90:91], v9 offset:1088
    v_mov_b32 v8, v9
    s_mov_b32 s26, s27
    s_add_u32 s27, s27, 28800
    s_cmp_ge_u32 s27, 115200
    s_cselect_b32 s23, 115200, 0
    s_sub_u32 s27, s27, s23
    s_add_u32 s28, s28, 28800
    s_cmp_ge_u32 s28, 115200
    s_cselect_b32 s23, 115200, 0
    s_sub_u32 s28, s28, s23
    v_add_u32 v9, s27, v7
    s_sub_u32 s30, s30, 1
    s_cmp_lg_u32 s30, 0
    s_cbranch_scc1 g1_loop
    s_waitcnt vmcnt(0) lgkmcnt(0)
    s_nop 15
    v_and_b32 v10, 31, v1
    v_lshlrev_b32 v10, 4, v10
    v_lshrrev_b32 v11, 5, v1
    v_lshlrev_b32 v11, 3, v11
    v_add_u32 v10, v10, v11
    s_lshl_b32 s23, s21, 3
    s_add_u32 s23, s23, s22
    s_mul_i32 s23, s23, 448
    s_mul_i32 s31, s20, 14
    s_add_u32 s23, s23, s31
    s_lshl_b32 s23, s23, 9
    s_add_u32 s24, s23, 4194304
    s_mov_b32 s32, 0xc0135761
    s_mov_b32 s33, 0xbdd2d3e8
    s_mov_b32 s34, 0xffff0000
    v_mov_b32 v240, s33
    v_mov_b32 v241, s32
    v_cvt_pk_bf16_f32 v16, v128, v129
    v_cvt_pk_bf16_f32 v18, v136, v137
    v_cvt_pk_bf16_f32 v17, v130, v131
    v_cvt_pk_bf16_f32 v19, v138, v139
    v_lshlrev_b32 v20, 16, v16
    v_and_b32 v21, s34, v16
    v_lshlrev_b32 v24, 16, v18
    v_and_b32 v25, s34, v18
    v_lshlrev_b32 v22, 16, v17
    v_and_b32 v23, s34, v17
    v_lshlrev_b32 v26, 16, v19
    v_and_b32 v27, s34, v19
    v_mul_f32 v28, v20, v20
    v_mul_f32 v29, v21, v21
    v_mul_f32 v30, v22, v22
    v_mul_f32 v31, v23, v23
    v_fma_f32 v28, v28, v240, v241
    v_fma_f32 v29, v29, v240, v241
    v_fma_f32 v30, v30, v240, v241
    v_fma_f32 v31, v31, v240, v241
    v_mul_f32 v28, v20, v28
    v_mul_f32 v29, v21, v29
    v_mul_f32 v30, v22, v30
    v_mul_f32 v31, v23, v31
    v_exp_f32 v28, v28
    v_exp_f32 v29, v29
    v_exp_f32 v30, v30
    v_exp_f32 v31, v31
    v_add_f32 v28, 1.0, v28
    v_add_f32 v29, 1.0, v29
    v_add_f32 v30, 1.0, v30
    v_add_f32 v31, 1.0, v31
    v_rcp_f32 v28, v28
    v_rcp_f32 v29, v29
    v_rcp_f32 v30, v30
    v_rcp_f32 v31, v31
    v_mul_f32 v28, v20, v28
    v_mul_f32 v29, v21, v29
    v_mul_f32 v30, v22, v30
    v_mul_f32 v31, v23, v31
    v_cvt_pk_bf16_f32 v16, v28, v29
    v_cvt_pk_bf16_f32 v17, v30, v31
    v_lshlrev_b32 v20, 16, v16
    v_and_b32 v21, s34, v16
    v_lshlrev_b32 v22, 16, v17
    v_and_b32 v23, s34, v17
    v_mul_f32 v28, v20, v24
    v_mul_f32 v29, v21, v25
    v_mul_f32 v30, v22, v26
    v_mul_f32 v31, v23, v27
    v_cvt_pk_bf16_f32 v242, v28, v29
    v_cvt_pk_bf16_f32 v243, v30, v31
    buffer_store_dwordx2 v[242:243], v10, s[16:19], s24 offen
    s_add_u32 s24, s24, 512
    v_cvt_pk_bf16_f32 v16, v132, v133
    v_cvt_pk_bf16_f32 v18, v140, v141
    v_cvt_pk_bf16_f32 v17, v134, v135
    v_cvt_pk_bf16_f32 v19, v142, v143
    v_lshlrev_b32 v20, 16, v16
    v_and_b32 v21, s34, v16
    v_lshlrev_b32 v24, 16, v18
    v_and_b32 v25, s34, v18
    v_lshlrev_b32 v22, 16, v17
    v_and_b32 v23, s34, v17
    v_lshlrev_b32 v26, 16, v19
    v_and_b32 v27, s34, v19
    v_mul_f32 v28, v20, v20
    v_mul_f32 v29, v21, v21
    v_mul_f32 v30, v22, v22
    v_mul_f32 v31, v23, v23
    v_fma_f32 v28, v28, v240, v241
    v_fma_f32 v29, v29, v240, v241
    v_fma_f32 v30, v30, v240, v241
    v_fma_f32 v31, v31, v240, v241
    v_mul_f32 v28, v20, v28
    v_mul_f32 v29, v21, v29
    v_mul_f32 v30, v22, v30
    v_mul_f32 v31, v23, v31
    v_exp_f32 v28, v28
    v_exp_f32 v29, v29
    v_exp_f32 v30, v30
    v_exp_f32 v31, v31
    v_add_f32 v28, 1.0, v28
    v_add_f32 v29, 1.0, v29
    v_add_f32 v30, 1.0, v30
    v_add_f32 v31, 1.0, v31
    v_rcp_f32 v28, v28
    v_rcp_f32 v29, v29
    v_rcp_f32 v30, v30
    v_rcp_f32 v31, v31
    v_mul_f32 v28, v20, v28
    v_mul_f32 v29, v21, v29
    v_mul_f32 v30, v22, v30
    v_mul_f32 v31, v23, v31
    v_cvt_pk_bf16_f32 v16, v28, v29
    v_cvt_pk_bf16_f32 v17, v30, v31
    v_lshlrev_b32 v20, 16, v16
    v_and_b32 v21, s34, v16
    v_lshlrev_b32 v22, 16, v17
    v_and_b32 v23, s34, v17
    v_mul_f32 v28, v20, v24
    v_mul_f32 v29, v21, v25
    v_mul_f32 v30, v22, v26
    v_mul_f32 v31, v23, v27
    v_cvt_pk_bf16_f32 v244, v28, v29
    v_cvt_pk_bf16_f32 v245, v30, v31
    buffer_store_dwordx2 v[244:245], v10, s[16:19], s24 offen
    s_add_u32 s24, s24, 512
    v_cvt_pk_bf16_f32 v16, v144, v145
    v_cvt_pk_bf16_f32 v18, v152, v153
    v_cvt_pk_bf16_f32 v17, v146, v147
    v_cvt_pk_bf16_f32 v19, v154, v155
    v_lshlrev_b32 v20, 16, v16
    v_and_b32 v21, s34, v16
    v_lshlrev_b32 v24, 16, v18
    v_and_b32 v25, s34, v18
    v_lshlrev_b32 v22, 16, v17
    v_and_b32 v23, s34, v17
    v_lshlrev_b32 v26, 16, v19
    v_and_b32 v27, s34, v19
    v_mul_f32 v28, v20, v20
    v_mul_f32 v29, v21, v21
    v_mul_f32 v30, v22, v22
    v_mul_f32 v31, v23, v23
    v_fma_f32 v28, v28, v240, v241
    v_fma_f32 v29, v29, v240, v241
    v_fma_f32 v30, v30, v240, v241
    v_fma_f32 v31, v31, v240, v241
    v_mul_f32 v28, v20, v28
    v_mul_f32 v29, v21, v29
    v_mul_f32 v30, v22, v30
    v_mul_f32 v31, v23, v31
    v_exp_f32 v28, v28
    v_exp_f32 v29, v29
    v_exp_f32 v30, v30
    v_exp_f32 v31, v31
    v_add_f32 v28, 1.0, v28
    v_add_f32 v29, 1.0, v29
    v_add_f32 v30, 1.0, v30
    v_add_f32 v31, 1.0, v31
    v_rcp_f32 v28, v28
    v_rcp_f32 v29, v29
    v_rcp_f32 v30, v30
    v_rcp_f32 v31, v31
    v_mul_f32 v28, v20, v28
    v_mul_f32 v29, v21, v29
    v_mul_f32 v30, v22, v30
    v_mul_f32 v31, v23, v31
    v_cvt_pk_bf16_f32 v16, v28, v29
    v_cvt_pk_bf16_f32 v17, v30, v31
    v_lshlrev_b32 v20, 16, v16
    v_and_b32 v21, s34, v16
    v_lshlrev_b32 v22, 16, v17
    v_and_b32 v23, s34, v17
    v_mul_f32 v28, v20, v24
    v_mul_f32 v29, v21, v25
    v_mul_f32 v30, v22, v26
    v_mul_f32 v31, v23, v27
    v_cvt_pk_bf16_f32 v242, v28, v29
    v_cvt_pk_bf16_f32 v243, v30, v31
    buffer_store_dwordx2 v[242:243], v10, s[16:19], s24 offen
    s_add_u32 s24, s24, 512
    v_cvt_pk_bf16_f32 v16, v148, v149
    v_cvt_pk_bf16_f32 v18, v156, v157
    v_cvt_pk_bf16_f32 v17, v150, v151
    v_cvt_pk_bf16_f32 v19, v158, v159
    v_lshlrev_b32 v20, 16, v16
    v_and_b32 v21, s34, v16
    v_lshlrev_b32 v24, 16, v18
    v_and_b32 v25, s34, v18
    v_lshlrev_b32 v22, 16, v17
    v_and_b32 v23, s34, v17
    v_lshlrev_b32 v26, 16, v19
    v_and_b32 v27, s34, v19
    v_mul_f32 v28, v20, v20
    v_mul_f32 v29, v21, v21
    v_mul_f32 v30, v22, v22
    v_mul_f32 v31, v23, v23
    v_fma_f32 v28, v28, v240, v241
    v_fma_f32 v29, v29, v240, v241
    v_fma_f32 v30, v30, v240, v241
    v_fma_f32 v31, v31, v240, v241
    v_mul_f32 v28, v20, v28
    v_mul_f32 v29, v21, v29
    v_mul_f32 v30, v22, v30
    v_mul_f32 v31, v23, v31
    v_exp_f32 v28, v28
    v_exp_f32 v29, v29
    v_exp_f32 v30, v30
    v_exp_f32 v31, v31
    v_add_f32 v28, 1.0, v28
    v_add_f32 v29, 1.0, v29
    v_add_f32 v30, 1.0, v30
    v_add_f32 v31, 1.0, v31
    v_rcp_f32 v28, v28
    v_rcp_f32 v29, v29
    v_rcp_f32 v30, v30
    v_rcp_f32 v31, v31
    v_mul_f32 v28, v20, v28
    v_mul_f32 v29, v21, v29
    v_mul_f32 v30, v22, v30
    v_mul_f32 v31, v23, v31
    v_cvt_pk_bf16_f32 v16, v28, v29
    v_cvt_pk_bf16_f32 v17, v30, v31
    v_lshlrev_b32 v20, 16, v16
    v_and_b32 v21, s34, v16
    v_lshlrev_b32 v22, 16, v17
    v_and_b32 v23, s34, v17
    v_mul_f32 v28, v20, v24
    v_mul_f32 v29, v21, v25
    v_mul_f32 v30, v22, v26
    v_mul_f32 v31, v23, v27
    v_cvt_pk_bf16_f32 v244, v28, v29
    v_cvt_pk_bf16_f32 v245, v30, v31
    buffer_store_dwordx2 v[244:245], v10, s[16:19], s24 offen
    s_add_u32 s24, s24, 512
    v_cvt_pk_bf16_f32 v16, v160, v161
    v_cvt_pk_bf16_f32 v18, v168, v169
    v_cvt_pk_bf16_f32 v17, v162, v163
    v_cvt_pk_bf16_f32 v19, v170, v171
    v_lshlrev_b32 v20, 16, v16
    v_and_b32 v21, s34, v16
    v_lshlrev_b32 v24, 16, v18
    v_and_b32 v25, s34, v18
    v_lshlrev_b32 v22, 16, v17
    v_and_b32 v23, s34, v17
    v_lshlrev_b32 v26, 16, v19
    v_and_b32 v27, s34, v19
    v_mul_f32 v28, v20, v20
    v_mul_f32 v29, v21, v21
    v_mul_f32 v30, v22, v22
    v_mul_f32 v31, v23, v23
    v_fma_f32 v28, v28, v240, v241
    v_fma_f32 v29, v29, v240, v241
    v_fma_f32 v30, v30, v240, v241
    v_fma_f32 v31, v31, v240, v241
    v_mul_f32 v28, v20, v28
    v_mul_f32 v29, v21, v29
    v_mul_f32 v30, v22, v30
    v_mul_f32 v31, v23, v31
    v_exp_f32 v28, v28
    v_exp_f32 v29, v29
    v_exp_f32 v30, v30
    v_exp_f32 v31, v31
    v_add_f32 v28, 1.0, v28
    v_add_f32 v29, 1.0, v29
    v_add_f32 v30, 1.0, v30
    v_add_f32 v31, 1.0, v31
    v_rcp_f32 v28, v28
    v_rcp_f32 v29, v29
    v_rcp_f32 v30, v30
    v_rcp_f32 v31, v31
    v_mul_f32 v28, v20, v28
    v_mul_f32 v29, v21, v29
    v_mul_f32 v30, v22, v30
    v_mul_f32 v31, v23, v31
    v_cvt_pk_bf16_f32 v16, v28, v29
    v_cvt_pk_bf16_f32 v17, v30, v31
    v_lshlrev_b32 v20, 16, v16
    v_and_b32 v21, s34, v16
    v_lshlrev_b32 v22, 16, v17
    v_and_b32 v23, s34, v17
    v_mul_f32 v28, v20, v24
    v_mul_f32 v29, v21, v25
    v_mul_f32 v30, v22, v26
    v_mul_f32 v31, v23, v27
    v_cvt_pk_bf16_f32 v242, v28, v29
    v_cvt_pk_bf16_f32 v243, v30, v31
    buffer_store_dwordx2 v[242:243], v10, s[16:19], s24 offen
    s_add_u32 s24, s24, 512
    v_cvt_pk_bf16_f32 v16, v164, v165
    v_cvt_pk_bf16_f32 v18, v172, v173
    v_cvt_pk_bf16_f32 v17, v166, v167
    v_cvt_pk_bf16_f32 v19, v174, v175
    v_lshlrev_b32 v20, 16, v16
    v_and_b32 v21, s34, v16
    v_lshlrev_b32 v24, 16, v18
    v_and_b32 v25, s34, v18
    v_lshlrev_b32 v22, 16, v17
    v_and_b32 v23, s34, v17
    v_lshlrev_b32 v26, 16, v19
    v_and_b32 v27, s34, v19
    v_mul_f32 v28, v20, v20
    v_mul_f32 v29, v21, v21
    v_mul_f32 v30, v22, v22
    v_mul_f32 v31, v23, v23
    v_fma_f32 v28, v28, v240, v241
    v_fma_f32 v29, v29, v240, v241
    v_fma_f32 v30, v30, v240, v241
    v_fma_f32 v31, v31, v240, v241
    v_mul_f32 v28, v20, v28
    v_mul_f32 v29, v21, v29
    v_mul_f32 v30, v22, v30
    v_mul_f32 v31, v23, v31
    v_exp_f32 v28, v28
    v_exp_f32 v29, v29
    v_exp_f32 v30, v30
    v_exp_f32 v31, v31
    v_add_f32 v28, 1.0, v28
    v_add_f32 v29, 1.0, v29
    v_add_f32 v30, 1.0, v30
    v_add_f32 v31, 1.0, v31
    v_rcp_f32 v28, v28
    v_rcp_f32 v29, v29
    v_rcp_f32 v30, v30
    v_rcp_f32 v31, v31
    v_mul_f32 v28, v20, v28
    v_mul_f32 v29, v21, v29
    v_mul_f32 v30, v22, v30
    v_mul_f32 v31, v23, v31
    v_cvt_pk_bf16_f32 v16, v28, v29
    v_cvt_pk_bf16_f32 v17, v30, v31
    v_lshlrev_b32 v20, 16, v16
    v_and_b32 v21, s34, v16
    v_lshlrev_b32 v22, 16, v17
    v_and_b32 v23, s34, v17
    v_mul_f32 v28, v20, v24
    v_mul_f32 v29, v21, v25
    v_mul_f32 v30, v22, v26
    v_mul_f32 v31, v23, v27
    v_cvt_pk_bf16_f32 v244, v28, v29
    v_cvt_pk_bf16_f32 v245, v30, v31
    buffer_store_dwordx2 v[244:245], v10, s[16:19], s24 offen
    s_add_u32 s24, s24, 512
    v_cvt_pk_bf16_f32 v16, v176, v177
    v_cvt_pk_bf16_f32 v18, v184, v185
    v_cvt_pk_bf16_f32 v17, v178, v179
    v_cvt_pk_bf16_f32 v19, v186, v187
    v_lshlrev_b32 v20, 16, v16
    v_and_b32 v21, s34, v16
    v_lshlrev_b32 v24, 16, v18
    v_and_b32 v25, s34, v18
    v_lshlrev_b32 v22, 16, v17
    v_and_b32 v23, s34, v17
    v_lshlrev_b32 v26, 16, v19
    v_and_b32 v27, s34, v19
    v_mul_f32 v28, v20, v20
    v_mul_f32 v29, v21, v21
    v_mul_f32 v30, v22, v22
    v_mul_f32 v31, v23, v23
    v_fma_f32 v28, v28, v240, v241
    v_fma_f32 v29, v29, v240, v241
    v_fma_f32 v30, v30, v240, v241
    v_fma_f32 v31, v31, v240, v241
    v_mul_f32 v28, v20, v28
    v_mul_f32 v29, v21, v29
    v_mul_f32 v30, v22, v30
    v_mul_f32 v31, v23, v31
    v_exp_f32 v28, v28
    v_exp_f32 v29, v29
    v_exp_f32 v30, v30
    v_exp_f32 v31, v31
    v_add_f32 v28, 1.0, v28
    v_add_f32 v29, 1.0, v29
    v_add_f32 v30, 1.0, v30
    v_add_f32 v31, 1.0, v31
    v_rcp_f32 v28, v28
    v_rcp_f32 v29, v29
    v_rcp_f32 v30, v30
    v_rcp_f32 v31, v31
    v_mul_f32 v28, v20, v28
    v_mul_f32 v29, v21, v29
    v_mul_f32 v30, v22, v30
    v_mul_f32 v31, v23, v31
    v_cvt_pk_bf16_f32 v16, v28, v29
    v_cvt_pk_bf16_f32 v17, v30, v31
    v_lshlrev_b32 v20, 16, v16
    v_and_b32 v21, s34, v16
    v_lshlrev_b32 v22, 16, v17
    v_and_b32 v23, s34, v17
    v_mul_f32 v28, v20, v24
    v_mul_f32 v29, v21, v25
    v_mul_f32 v30, v22, v26
    v_mul_f32 v31, v23, v27
    v_cvt_pk_bf16_f32 v242, v28, v29
    v_cvt_pk_bf16_f32 v243, v30, v31
    buffer_store_dwordx2 v[242:243], v10, s[16:19], s24 offen
    s_add_u32 s24, s24, 512
    v_cvt_pk_bf16_f32 v16, v180, v181
    v_cvt_pk_bf16_f32 v18, v188, v189
    v_cvt_pk_bf16_f32 v17, v182, v183
    v_cvt_pk_bf16_f32 v19, v190, v191
    v_lshlrev_b32 v20, 16, v16
    v_and_b32 v21, s34, v16
    v_lshlrev_b32 v24, 16, v18
    v_and_b32 v25, s34, v18
    v_lshlrev_b32 v22, 16, v17
    v_and_b32 v23, s34, v17
    v_lshlrev_b32 v26, 16, v19
    v_and_b32 v27, s34, v19
    v_mul_f32 v28, v20, v20
    v_mul_f32 v29, v21, v21
    v_mul_f32 v30, v22, v22
    v_mul_f32 v31, v23, v23
    v_fma_f32 v28, v28, v240, v241
    v_fma_f32 v29, v29, v240, v241
    v_fma_f32 v30, v30, v240, v241
    v_fma_f32 v31, v31, v240, v241
    v_mul_f32 v28, v20, v28
    v_mul_f32 v29, v21, v29
    v_mul_f32 v30, v22, v30
    v_mul_f32 v31, v23, v31
    v_exp_f32 v28, v28
    v_exp_f32 v29, v29
    v_exp_f32 v30, v30
    v_exp_f32 v31, v31
    v_add_f32 v28, 1.0, v28
    v_add_f32 v29, 1.0, v29
    v_add_f32 v30, 1.0, v30
    v_add_f32 v31, 1.0, v31
    v_rcp_f32 v28, v28
    v_rcp_f32 v29, v29
    v_rcp_f32 v30, v30
    v_rcp_f32 v31, v31
    v_mul_f32 v28, v20, v28
    v_mul_f32 v29, v21, v29
    v_mul_f32 v30, v22, v30
    v_mul_f32 v31, v23, v31
    v_cvt_pk_bf16_f32 v16, v28, v29
    v_cvt_pk_bf16_f32 v17, v30, v31
    v_lshlrev_b32 v20, 16, v16
    v_and_b32 v21, s34, v16
    v_lshlrev_b32 v22, 16, v17
    v_and_b32 v23, s34, v17
    v_mul_f32 v28, v20, v24
    v_mul_f32 v29, v21, v25
    v_mul_f32 v30, v22, v26
    v_mul_f32 v31, v23, v27
    v_cvt_pk_bf16_f32 v244, v28, v29
    v_cvt_pk_bf16_f32 v245, v30, v31
    buffer_store_dwordx2 v[244:245], v10, s[16:19], s24 offen
    s_add_u32 s24, s24, 512
    v_cvt_pk_bf16_f32 v16, v192, v193
    v_cvt_pk_bf16_f32 v18, v200, v201
    v_cvt_pk_bf16_f32 v17, v194, v195
    v_cvt_pk_bf16_f32 v19, v202, v203
    v_lshlrev_b32 v20, 16, v16
    v_and_b32 v21, s34, v16
    v_lshlrev_b32 v24, 16, v18
    v_and_b32 v25, s34, v18
    v_lshlrev_b32 v22, 16, v17
    v_and_b32 v23, s34, v17
    v_lshlrev_b32 v26, 16, v19
    v_and_b32 v27, s34, v19
    v_mul_f32 v28, v20, v20
    v_mul_f32 v29, v21, v21
    v_mul_f32 v30, v22, v22
    v_mul_f32 v31, v23, v23
    v_fma_f32 v28, v28, v240, v241
    v_fma_f32 v29, v29, v240, v241
    v_fma_f32 v30, v30, v240, v241
    v_fma_f32 v31, v31, v240, v241
    v_mul_f32 v28, v20, v28
    v_mul_f32 v29, v21, v29
    v_mul_f32 v30, v22, v30
    v_mul_f32 v31, v23, v31
    v_exp_f32 v28, v28
    v_exp_f32 v29, v29
    v_exp_f32 v30, v30
    v_exp_f32 v31, v31
    v_add_f32 v28, 1.0, v28
    v_add_f32 v29, 1.0, v29
    v_add_f32 v30, 1.0, v30
    v_add_f32 v31, 1.0, v31
    v_rcp_f32 v28, v28
    v_rcp_f32 v29, v29
    v_rcp_f32 v30, v30
    v_rcp_f32 v31, v31
    v_mul_f32 v28, v20, v28
    v_mul_f32 v29, v21, v29
    v_mul_f32 v30, v22, v30
    v_mul_f32 v31, v23, v31
    v_cvt_pk_bf16_f32 v16, v28, v29
    v_cvt_pk_bf16_f32 v17, v30, v31
    v_lshlrev_b32 v20, 16, v16
    v_and_b32 v21, s34, v16
    v_lshlrev_b32 v22, 16, v17
    v_and_b32 v23, s34, v17
    v_mul_f32 v28, v20, v24
    v_mul_f32 v29, v21, v25
    v_mul_f32 v30, v22, v26
    v_mul_f32 v31, v23, v27
    v_cvt_pk_bf16_f32 v242, v28, v29
    v_cvt_pk_bf16_f32 v243, v30, v31
    buffer_store_dwordx2 v[242:243], v10, s[16:19], s24 offen
    s_add_u32 s24, s24, 512
    v_cvt_pk_bf16_f32 v16, v196, v197
    v_cvt_pk_bf16_f32 v18, v204, v205
    v_cvt_pk_bf16_f32 v17, v198, v199
    v_cvt_pk_bf16_f32 v19, v206, v207
    v_lshlrev_b32 v20, 16, v16
    v_and_b32 v21, s34, v16
    v_lshlrev_b32 v24, 16, v18
    v_and_b32 v25, s34, v18
    v_lshlrev_b32 v22, 16, v17
    v_and_b32 v23, s34, v17
    v_lshlrev_b32 v26, 16, v19
    v_and_b32 v27, s34, v19
    v_mul_f32 v28, v20, v20
    v_mul_f32 v29, v21, v21
    v_mul_f32 v30, v22, v22
    v_mul_f32 v31, v23, v23
    v_fma_f32 v28, v28, v240, v241
    v_fma_f32 v29, v29, v240, v241
    v_fma_f32 v30, v30, v240, v241
    v_fma_f32 v31, v31, v240, v241
    v_mul_f32 v28, v20, v28
    v_mul_f32 v29, v21, v29
    v_mul_f32 v30, v22, v30
    v_mul_f32 v31, v23, v31
    v_exp_f32 v28, v28
    v_exp_f32 v29, v29
    v_exp_f32 v30, v30
    v_exp_f32 v31, v31
    v_add_f32 v28, 1.0, v28
    v_add_f32 v29, 1.0, v29
    v_add_f32 v30, 1.0, v30
    v_add_f32 v31, 1.0, v31
    v_rcp_f32 v28, v28
    v_rcp_f32 v29, v29
    v_rcp_f32 v30, v30
    v_rcp_f32 v31, v31
    v_mul_f32 v28, v20, v28
    v_mul_f32 v29, v21, v29
    v_mul_f32 v30, v22, v30
    v_mul_f32 v31, v23, v31
    v_cvt_pk_bf16_f32 v16, v28, v29
    v_cvt_pk_bf16_f32 v17, v30, v31
    v_lshlrev_b32 v20, 16, v16
    v_and_b32 v21, s34, v16
    v_lshlrev_b32 v22, 16, v17
    v_and_b32 v23, s34, v17
    v_mul_f32 v28, v20, v24
    v_mul_f32 v29, v21, v25
    v_mul_f32 v30, v22, v26
    v_mul_f32 v31, v23, v27
    v_cvt_pk_bf16_f32 v244, v28, v29
    v_cvt_pk_bf16_f32 v245, v30, v31
    buffer_store_dwordx2 v[244:245], v10, s[16:19], s24 offen
    s_add_u32 s24, s24, 512
    v_cvt_pk_bf16_f32 v16, v208, v209
    v_cvt_pk_bf16_f32 v18, v216, v217
    v_cvt_pk_bf16_f32 v17, v210, v211
    v_cvt_pk_bf16_f32 v19, v218, v219
    v_lshlrev_b32 v20, 16, v16
    v_and_b32 v21, s34, v16
    v_lshlrev_b32 v24, 16, v18
    v_and_b32 v25, s34, v18
    v_lshlrev_b32 v22, 16, v17
    v_and_b32 v23, s34, v17
    v_lshlrev_b32 v26, 16, v19
    v_and_b32 v27, s34, v19
    v_mul_f32 v28, v20, v20
    v_mul_f32 v29, v21, v21
    v_mul_f32 v30, v22, v22
    v_mul_f32 v31, v23, v23
    v_fma_f32 v28, v28, v240, v241
    v_fma_f32 v29, v29, v240, v241
    v_fma_f32 v30, v30, v240, v241
    v_fma_f32 v31, v31, v240, v241
    v_mul_f32 v28, v20, v28
    v_mul_f32 v29, v21, v29
    v_mul_f32 v30, v22, v30
    v_mul_f32 v31, v23, v31
    v_exp_f32 v28, v28
    v_exp_f32 v29, v29
    v_exp_f32 v30, v30
    v_exp_f32 v31, v31
    v_add_f32 v28, 1.0, v28
    v_add_f32 v29, 1.0, v29
    v_add_f32 v30, 1.0, v30
    v_add_f32 v31, 1.0, v31
    v_rcp_f32 v28, v28
    v_rcp_f32 v29, v29
    v_rcp_f32 v30, v30
    v_rcp_f32 v31, v31
    v_mul_f32 v28, v20, v28
    v_mul_f32 v29, v21, v29
    v_mul_f32 v30, v22, v30
    v_mul_f32 v31, v23, v31
    v_cvt_pk_bf16_f32 v16, v28, v29
    v_cvt_pk_bf16_f32 v17, v30, v31
    v_lshlrev_b32 v20, 16, v16
    v_and_b32 v21, s34, v16
    v_lshlrev_b32 v22, 16, v17
    v_and_b32 v23, s34, v17
    v_mul_f32 v28, v20, v24
    v_mul_f32 v29, v21, v25
    v_mul_f32 v30, v22, v26
    v_mul_f32 v31, v23, v27
    v_cvt_pk_bf16_f32 v242, v28, v29
    v_cvt_pk_bf16_f32 v243, v30, v31
    buffer_store_dwordx2 v[242:243], v10, s[16:19], s24 offen
    s_add_u32 s24, s24, 512
    v_cvt_pk_bf16_f32 v16, v212, v213
    v_cvt_pk_bf16_f32 v18, v220, v221
    v_cvt_pk_bf16_f32 v17, v214, v215
    v_cvt_pk_bf16_f32 v19, v222, v223
    v_lshlrev_b32 v20, 16, v16
    v_and_b32 v21, s34, v16
    v_lshlrev_b32 v24, 16, v18
    v_and_b32 v25, s34, v18
    v_lshlrev_b32 v22, 16, v17
    v_and_b32 v23, s34, v17
    v_lshlrev_b32 v26, 16, v19
    v_and_b32 v27, s34, v19
    v_mul_f32 v28, v20, v20
    v_mul_f32 v29, v21, v21
    v_mul_f32 v30, v22, v22
    v_mul_f32 v31, v23, v23
    v_fma_f32 v28, v28, v240, v241
    v_fma_f32 v29, v29, v240, v241
    v_fma_f32 v30, v30, v240, v241
    v_fma_f32 v31, v31, v240, v241
    v_mul_f32 v28, v20, v28
    v_mul_f32 v29, v21, v29
    v_mul_f32 v30, v22, v30
    v_mul_f32 v31, v23, v31
    v_exp_f32 v28, v28
    v_exp_f32 v29, v29
    v_exp_f32 v30, v30
    v_exp_f32 v31, v31
    v_add_f32 v28, 1.0, v28
    v_add_f32 v29, 1.0, v29
    v_add_f32 v30, 1.0, v30
    v_add_f32 v31, 1.0, v31
    v_rcp_f32 v28, v28
    v_rcp_f32 v29, v29
    v_rcp_f32 v30, v30
    v_rcp_f32 v31, v31
    v_mul_f32 v28, v20, v28
    v_mul_f32 v29, v21, v29
    v_mul_f32 v30, v22, v30
    v_mul_f32 v31, v23, v31
    v_cvt_pk_bf16_f32 v16, v28, v29
    v_cvt_pk_bf16_f32 v17, v30, v31
    v_lshlrev_b32 v20, 16, v16
    v_and_b32 v21, s34, v16
    v_lshlrev_b32 v22, 16, v17
    v_and_b32 v23, s34, v17
    v_mul_f32 v28, v20, v24
    v_mul_f32 v29, v21, v25
    v_mul_f32 v30, v22, v26
    v_mul_f32 v31, v23, v27
    v_cvt_pk_bf16_f32 v244, v28, v29
    v_cvt_pk_bf16_f32 v245, v30, v31
    buffer_store_dwordx2 v[244:245], v10, s[16:19], s24 offen
    s_add_u32 s24, s24, 512
    v_cvt_pk_bf16_f32 v16, v224, v225
    v_cvt_pk_bf16_f32 v18, v232, v233
    v_cvt_pk_bf16_f32 v17, v226, v227
    v_cvt_pk_bf16_f32 v19, v234, v235
    v_lshlrev_b32 v20, 16, v16
    v_and_b32 v21, s34, v16
    v_lshlrev_b32 v24, 16, v18
    v_and_b32 v25, s34, v18
    v_lshlrev_b32 v22, 16, v17
    v_and_b32 v23, s34, v17
    v_lshlrev_b32 v26, 16, v19
    v_and_b32 v27, s34, v19
    v_mul_f32 v28, v20, v20
    v_mul_f32 v29, v21, v21
    v_mul_f32 v30, v22, v22
    v_mul_f32 v31, v23, v23
    v_fma_f32 v28, v28, v240, v241
    v_fma_f32 v29, v29, v240, v241
    v_fma_f32 v30, v30, v240, v241
    v_fma_f32 v31, v31, v240, v241
    v_mul_f32 v28, v20, v28
    v_mul_f32 v29, v21, v29
    v_mul_f32 v30, v22, v30
    v_mul_f32 v31, v23, v31
    v_exp_f32 v28, v28
    v_exp_f32 v29, v29
    v_exp_f32 v30, v30
    v_exp_f32 v31, v31
    v_add_f32 v28, 1.0, v28
    v_add_f32 v29, 1.0, v29
    v_add_f32 v30, 1.0, v30
    v_add_f32 v31, 1.0, v31
    v_rcp_f32 v28, v28
    v_rcp_f32 v29, v29
    v_rcp_f32 v30, v30
    v_rcp_f32 v31, v31
    v_mul_f32 v28, v20, v28
    v_mul_f32 v29, v21, v29
    v_mul_f32 v30, v22, v30
    v_mul_f32 v31, v23, v31
    v_cvt_pk_bf16_f32 v16, v28, v29
    v_cvt_pk_bf16_f32 v17, v30, v31
    v_lshlrev_b32 v20, 16, v16
    v_and_b32 v21, s34, v16
    v_lshlrev_b32 v22, 16, v17
    v_and_b32 v23, s34, v17
    v_mul_f32 v28, v20, v24
    v_mul_f32 v29, v21, v25
    v_mul_f32 v30, v22, v26
    v_mul_f32 v31, v23, v27
    v_cvt_pk_bf16_f32 v242, v28, v29
    v_cvt_pk_bf16_f32 v243, v30, v31
    buffer_store_dwordx2 v[242:243], v10, s[16:19], s24 offen
    s_add_u32 s24, s24, 512
    v_cvt_pk_bf16_f32 v16, v228, v229
    v_cvt_pk_bf16_f32 v18, v236, v237
    v_cvt_pk_bf16_f32 v17, v230, v231
    v_cvt_pk_bf16_f32 v19, v238, v239
    v_lshlrev_b32 v20, 16, v16
    v_and_b32 v21, s34, v16
    v_lshlrev_b32 v24, 16, v18
    v_and_b32 v25, s34, v18
    v_lshlrev_b32 v22, 16, v17
    v_and_b32 v23, s34, v17
    v_lshlrev_b32 v26, 16, v19
    v_and_b32 v27, s34, v19
    v_mul_f32 v28, v20, v20
    v_mul_f32 v29, v21, v21
    v_mul_f32 v30, v22, v22
    v_mul_f32 v31, v23, v23
    v_fma_f32 v28, v28, v240, v241
    v_fma_f32 v29, v29, v240, v241
    v_fma_f32 v30, v30, v240, v241
    v_fma_f32 v31, v31, v240, v241
    v_mul_f32 v28, v20, v28
    v_mul_f32 v29, v21, v29
    v_mul_f32 v30, v22, v30
    v_mul_f32 v31, v23, v31
    v_exp_f32 v28, v28
    v_exp_f32 v29, v29
    v_exp_f32 v30, v30
    v_exp_f32 v31, v31
    v_add_f32 v28, 1.0, v28
    v_add_f32 v29, 1.0, v29
    v_add_f32 v30, 1.0, v30
    v_add_f32 v31, 1.0, v31
    v_rcp_f32 v28, v28
    v_rcp_f32 v29, v29
    v_rcp_f32 v30, v30
    v_rcp_f32 v31, v31
    v_mul_f32 v28, v20, v28
    v_mul_f32 v29, v21, v29
    v_mul_f32 v30, v22, v30
    v_mul_f32 v31, v23, v31
    v_cvt_pk_bf16_f32 v16, v28, v29
    v_cvt_pk_bf16_f32 v17, v30, v31
    v_lshlrev_b32 v20, 16, v16
    v_and_b32 v21, s34, v16
    v_lshlrev_b32 v22, 16, v17
    v_and_b32 v23, s34, v17
    v_mul_f32 v28, v20, v24
    v_mul_f32 v29, v21, v25
    v_mul_f32 v30, v22, v26
    v_mul_f32 v31, v23, v27
    v_cvt_pk_bf16_f32 v244, v28, v29
    v_cvt_pk_bf16_f32 v245, v30, v31
    buffer_store_dwordx2 v[244:245], v10, s[16:19], s24 offen
    s_add_u32 s24, s24, 512
    s_waitcnt vmcnt(0)
g1_end:
    s_endpgm

.globl gemm2_kernel
.p2align 8
.type gemm2_kernel,@function
gemm2_kernel:
    s_cmp_ge_u32 s2, 256
    s_cbranch_scc1 g2_end
    s_load_dwordx2 s[4:5], s[0:1], 48
    s_load_dwordx2 s[8:9], s[0:1], 72
    s_and_b32 s23, s2, 7
    s_lshr_b32 s31, s2, 3
    s_and_b32 s20, s23, 1
    s_lshl_b32 s20, s20, 2
    s_and_b32 s32, s31, 3
    s_add_u32 s20, s20, s32
    s_lshr_b32 s21, s23, 1
    s_lshl_b32 s21, s21, 3
    s_lshr_b32 s32, s31, 2
    s_add_u32 s21, s21, s32
    v_lshrrev_b32 v10, 6, v0
    v_and_b32 v1, 63, v0
    s_nop 0
    v_readfirstlane_b32 s22, v10
    s_waitcnt lgkmcnt(0)
    s_mov_b32 s12, s4
    s_mov_b32 s13, s5
    s_mov_b32 s14, 7340032
    s_mov_b32 s15, 0x00020000
    s_mov_b32 s16, s8
    s_mov_b32 s17, s9
    s_mov_b32 s18, 268435456
    s_mov_b32 s19, 0x00020000
    v_lshrrev_b32 v2, 4, v1
    v_lshlrev_b32 v3, 2, v2
    v_and_b32 v4, 15, v1
    v_xor_b32 v4, v3, v4
    v_lshlrev_b32 v4, 4, v4
    v_lshlrev_b32 v2, 11, v2
    s_lshl_b32 s23, s20, 8
    v_add3_u32 v12, v2, v4, s23
    v_add_u32 v13, 8192, v12
    v_add_u32 v14, 16384, v12
    v_add_u32 v15, 24576, v12
    v_bfe_u32 v2, v1, 2, 2
    v_bfe_u32 v3, v1, 4, 1
    v_lshlrev_b32 v3, 1, v3
    v_bfe_u32 v4, v1, 1, 1
    v_add_u32 v3, v3, v4
    v_and_b32 v4, 1, v1
    v_lshlrev_b32 v4, 3, v4
    v_lshrrev_b32 v5, 5, v1
    v_lshlrev_b32 v5, 11, v5
    s_mul_i32 s23, s22, 20480
    v_add3_u32 v4, v4, v5, s23
    v_lshlrev_b32 v6, 4, v2
    v_add_u32 v6, v6, v3
    v_xor_b32 v7, 0, v2
    v_lshlrev_b32 v7, 2, v7
    v_add_u32 v7, v7, v6
    v_lshlrev_b32 v7, 4, v7
    v_add_u32 v8, v7, v4
    v_xor_b32 v7, 1, v2
    v_lshlrev_b32 v7, 2, v7
    v_add_u32 v7, v7, v6
    v_lshlrev_b32 v7, 4, v7
    v_add_u32 v9, v7, v4
    v_xor_b32 v7, 2, v2
    v_lshlrev_b32 v7, 2, v7
    v_add_u32 v7, v7, v6
    v_lshlrev_b32 v7, 4, v7
    v_add_u32 v10, v7, v4
    v_xor_b32 v7, 3, v2
    v_lshlrev_b32 v7, 2, v7
    v_add_u32 v7, v7, v6
    v_lshlrev_b32 v7, 4, v7
    v_add_u32 v11, v7, v4
    v_lshlrev_b32 v6, 4, v1
    s_mul_i32 s24, s22, 917504
    s_lshl_b32 s25, s21, 1
    s_mul_i32 s25, s25, 229376
    s_mul_i32 s23, s22, 28672
    s_add_u32 s25, s25, s23
    s_add_u32 s25, s25, 4194304
    s_add_u32 s26, s25, 229376
    s_mul_i32 s27, s22, 20480
    s_mov_b32 s28, 0
    buffer_load_dwordx4 v[24:27], v6, s[16:19], s25 offen
    buffer_load_dwordx4 v[28:31], v6, s[16:19], s26 offen
    s_add_u32 m0, s27, 0
    s_nop 0
    buffer_load_dwordx4 v12, s[12:15], s24 offen lds
    s_add_u32 m0, s27, 1024
    s_nop 0
    buffer_load_dwordx4 v13, s[12:15], s24 offen lds
    s_add_u32 m0, s27, 2048
    s_nop 0
    buffer_load_dwordx4 v14, s[12:15], s24 offen lds
    s_add_u32 m0, s27, 3072
    s_nop 0
    buffer_load_dwordx4 v15, s[12:15], s24 offen lds
    s_add_u32 s24, s24, 32768
    s_add_u32 s25, s25, 1024
    s_add_u32 s26, s26, 1024
    buffer_load_dwordx4 v[32:35], v6, s[16:19], s25 offen
    buffer_load_dwordx4 v[36:39], v6, s[16:19], s26 offen
    s_add_u32 m0, s27, 4096
    s_nop 0
    buffer_load_dwordx4 v12, s[12:15], s24 offen lds
    s_add_u32 m0, s27, 5120
    s_nop 0
    buffer_load_dwordx4 v13, s[12:15], s24 offen lds
    s_add_u32 m0, s27, 6144
    s_nop 0
    buffer_load_dwordx4 v14, s[12:15], s24 offen lds
    s_add_u32 m0, s27, 7168
    s_nop 0
    buffer_load_dwordx4 v15, s[12:15], s24 offen lds
    s_add_u32 s24, s24, 32768
    s_add_u32 s25, s25, 1024
    s_add_u32 s26, s26, 1024
    buffer_load_dwordx4 v[40:43], v6, s[16:19], s25 offen
    buffer_load_dwordx4 v[44:47], v6, s[16:19], s26 offen
    s_add_u32 m0, s27, 8192
    s_nop 0
    buffer_load_dwordx4 v12, s[12:15], s24 offen lds
    s_add_u32 m0, s27, 9216
    s_nop 0
    buffer_load_dwordx4 v13, s[12:15], s24 offen lds
    s_add_u32 m0, s27, 10240
    s_nop 0
    buffer_load_dwordx4 v14, s[12:15], s24 offen lds
    s_add_u32 m0, s27, 11264
    s_nop 0
    buffer_load_dwordx4 v15, s[12:15], s24 offen lds
    s_add_u32 s24, s24, 32768
    s_add_u32 s25, s25, 1024
    s_add_u32 s26, s26, 1024
    buffer_load_dwordx4 v[48:51], v6, s[16:19], s25 offen
    buffer_load_dwordx4 v[52:55], v6, s[16:19], s26 offen
    s_add_u32 m0, s27, 12288
    s_nop 0
    buffer_load_dwordx4 v12, s[12:15], s24 offen lds
    s_add_u32 m0, s27, 13312
    s_nop 0
    buffer_load_dwordx4 v13, s[12:15], s24 offen lds
    s_add_u32 m0, s27, 14336
    s_nop 0
    buffer_load_dwordx4 v14, s[12:15], s24 offen lds
    s_add_u32 m0, s27, 15360
    s_nop 0
    buffer_load_dwordx4 v15, s[12:15], s24 offen lds
    s_add_u32 s24, s24, 32768
    s_add_u32 s25, s25, 1024
    s_add_u32 s26, s26, 1024
    v_mov_b32 v128, 0
    v_mov_b32 v129, 0
    v_mov_b32 v130, 0
    v_mov_b32 v131, 0
    v_mov_b32 v132, 0
    v_mov_b32 v133, 0
    v_mov_b32 v134, 0
    v_mov_b32 v135, 0
    v_mov_b32 v136, 0
    v_mov_b32 v137, 0
    v_mov_b32 v138, 0
    v_mov_b32 v139, 0
    v_mov_b32 v140, 0
    v_mov_b32 v141, 0
    v_mov_b32 v142, 0
    v_mov_b32 v143, 0
    v_mov_b32 v144, 0
    v_mov_b32 v145, 0
    v_mov_b32 v146, 0
    v_mov_b32 v147, 0
    v_mov_b32 v148, 0
    v_mov_b32 v149, 0
    v_mov_b32 v150, 0
    v_mov_b32 v151, 0
    v_mov_b32 v152, 0
    v_mov_b32 v153, 0
    v_mov_b32 v154, 0
    v_mov_b32 v155, 0
    v_mov_b32 v156, 0
    v_mov_b32 v157, 0
    v_mov_b32 v158, 0
    v_mov_b32 v159, 0
    v_mov_b32 v160, 0
    v_mov_b32 v161, 0
    v_mov_b32 v162, 0
    v_mov_b32 v163, 0
    v_mov_b32 v164, 0
    v_mov_b32 v165, 0
    v_mov_b32 v166, 0
    v_mov_b32 v167, 0
    v_mov_b32 v168, 0
    v_mov_b32 v169, 0
    v_mov_b32 v170, 0
    v_mov_b32 v171, 0
    v_mov_b32 v172, 0
    v_mov_b32 v173, 0
    v_mov_b32 v174, 0
    v_mov_b32 v175, 0
    v_mov_b32 v176, 0
    v_mov_b32 v177, 0
    v_mov_b32 v178, 0
    v_mov_b32 v179, 0
    v_mov_b32 v180, 0
    v_mov_b32 v181, 0
    v_mov_b32 v182, 0
    v_mov_b32 v183, 0
    v_mov_b32 v184, 0
    v_mov_b32 v185, 0
    v_mov_b32 v186, 0
    v_mov_b32 v187, 0
    v_mov_b32 v188, 0
    v_mov_b32 v189, 0
    v_mov_b32 v190, 0
    v_mov_b32 v191, 0
    v_mov_b32 v192, 0
    v_mov_b32 v193, 0
    v_mov_b32 v194, 0
    v_mov_b32 v195, 0
    v_mov_b32 v196, 0
    v_mov_b32 v197, 0
    v_mov_b32 v198, 0
    v_mov_b32 v199, 0
    v_mov_b32 v200, 0
    v_mov_b32 v201, 0
    v_mov_b32 v202, 0
    v_mov_b32 v203, 0
    v_mov_b32 v204, 0
    v_mov_b32 v205, 0
    v_mov_b32 v206, 0
    v_mov_b32 v207, 0
    v_mov_b32 v208, 0
    v_mov_b32 v209, 0
    v_mov_b32 v210, 0
    v_mov_b32 v211, 0
    v_mov_b32 v212, 0
    v_mov_b32 v213, 0
    v_mov_b32 v214, 0
    v_mov_b32 v215, 0
    v_mov_b32 v216, 0
    v_mov_b32 v217, 0
    v_mov_b32 v218, 0
    v_mov_b32 v219, 0
    v_mov_b32 v220, 0
    v_mov_b32 v221, 0
    v_mov_b32 v222, 0
    v_mov_b32 v223, 0
    v_mov_b32 v224, 0
    v_mov_b32 v225, 0
    v_mov_b32 v226, 0
    v_mov_b32 v227, 0
    v_mov_b32 v228, 0
    v_mov_b32 v229, 0
    v_mov_b32 v230, 0
    v_mov_b32 v231, 0
    v_mov_b32 v232, 0
    v_mov_b32 v233, 0
    v_mov_b32 v234, 0
    v_mov_b32 v235, 0
    v_mov_b32 v236, 0
    v_mov_b32 v237, 0
    v_mov_b32 v238, 0
    v_mov_b32 v239, 0
    v_mov_b32 v240, 0
    v_mov_b32 v241, 0
    v_mov_b32 v242, 0
    v_mov_b32 v243, 0
    v_mov_b32 v244, 0
    v_mov_b32 v245, 0
    v_mov_b32 v246, 0
    v_mov_b32 v247, 0
    v_mov_b32 v248, 0
    v_mov_b32 v249, 0
    v_mov_b32 v250, 0
    v_mov_b32 v251, 0
    v_mov_b32 v252, 0
    v_mov_b32 v253, 0
    v_mov_b32 v254, 0
    v_mov_b32 v255, 0
    s_waitcnt vmcnt(18)
    ds_read_b64_tr_b16 v[64:65], v8 offset:0
    ds_read_b64_tr_b16 v[66:67], v8 offset:1024
    ds_read_b64_tr_b16 v[68:69], v9 offset:0
    ds_read_b64_tr_b16 v[70:71], v9 offset:1024
    ds_read_b64_tr_b16 v[72:73], v10 offset:0
    ds_read_b64_tr_b16 v[74:75], v10 offset:1024
    ds_read_b64_tr_b16 v[76:77], v11 offset:0
    ds_read_b64_tr_b16 v[78:79], v11 offset:1024
    s_mov_b32 s30, 2
g2_loop:
    buffer_load_dwordx4 v[56:59], v6, s[16:19], s25 offen
    buffer_load_dwordx4 v[60:63], v6, s[16:19], s26 offen
    s_add_u32 m0, s27, 16384
    s_nop 0
    buffer_load_dwordx4 v12, s[12:15], s24 offen lds
    s_add_u32 m0, s27, 17408
    s_nop 0
    buffer_load_dwordx4 v13, s[12:15], s24 offen lds
    s_add_u32 m0, s27, 18432
    s_nop 0
    buffer_load_dwordx4 v14, s[12:15], s24 offen lds
    s_add_u32 m0, s27, 19456
    s_nop 0
    buffer_load_dwordx4 v15, s[12:15], s24 offen lds
    s_add_u32 s24, s24, 32768
    s_add_u32 s25, s25, 1024
    s_add_u32 s26, s26, 1024
    s_waitcnt vmcnt(18)
    ds_read_b64_tr_b16 v[80:81], v8 offset:4096
    ds_read_b64_tr_b16 v[82:83], v8 offset:5120
    ds_read_b64_tr_b16 v[84:85], v9 offset:4096
    ds_read_b64_tr_b16 v[86:87], v9 offset:5120
    ds_read_b64_tr_b16 v[88:89], v10 offset:4096
    ds_read_b64_tr_b16 v[90:91], v10 offset:5120
    ds_read_b64_tr_b16 v[92:93], v11 offset:4096
    ds_read_b64_tr_b16 v[94:95], v11 offset:5120
    s_waitcnt lgkmcnt(14)
    v_mfma_f32_32x32x16_bf16 v[128:143], v[64:67], v[24:27], v[128:143]
    v_mfma_f32_32x32x16_bf16 v[144:159], v[64:67], v[28:31], v[144:159]
    s_waitcnt lgkmcnt(12)
    v_mfma_f32_32x32x16_bf16 v[160:175], v[68:71], v[24:27], v[160:175]
    v_mfma_f32_32x32x16_bf16 v[176:191], v[68:71], v[28:31], v[176:191]
    s_waitcnt lgkmcnt(10)
    v_mfma_f32_32x32x16_bf16 v[192:207], v[72:75], v[24:27], v[192:207]
    v_mfma_f32_32x32x16_bf16 v[208:223], v[72:75], v[28:31], v[208:223]
    s_waitcnt lgkmcnt(8)
    v_mfma_f32_32x32x16_bf16 v[224:239], v[76:79], v[24:27], v[224:239]
    v_mfma_f32_32x32x16_bf16 v[240:255], v[76:79], v[28:31], v[240:255]
    buffer_load_dwordx4 v[24:27], v6, s[16:19], s25 offen
    buffer_load_dwordx4 v[28:31], v6, s[16:19], s26 offen
    s_add_u32 m0, s27, 0
    s_nop 0
    buffer_load_dwordx4 v12, s[12:15], s24 offen lds
    s_add_u32 m0, s27, 1024
    s_nop 0
    buffer_load_dwordx4 v13, s[12:15], s24 offen lds
    s_add_u32 m0, s27, 2048
    s_nop 0
    buffer_load_dwordx4 v14, s[12:15], s24 offen lds
    s_add_u32 m0, s27, 3072
    s_nop 0
    buffer_load_dwordx4 v15, s[12:15], s24 offen lds
    s_add_u32 s24, s24, 32768
    s_add_u32 s25, s25, 1024
    s_add_u32 s26, s26, 1024
    s_waitcnt vmcnt(18)
    ds_read_b64_tr_b16 v[64:65], v8 offset:8192
    ds_read_b64_tr_b16 v[66:67], v8 offset:9216
    ds_read_b64_tr_b16 v[68:69], v9 offset:8192
    ds_read_b64_tr_b16 v[70:71], v9 offset:9216
    ds_read_b64_tr_b16 v[72:73], v10 offset:8192
    ds_read_b64_tr_b16 v[74:75], v10 offset:9216
    ds_read_b64_tr_b16 v[76:77], v11 offset:8192
    ds_read_b64_tr_b16 v[78:79], v11 offset:9216
    s_waitcnt lgkmcnt(14)
    v_mfma_f32_32x32x16_bf16 v[128:143], v[80:83], v[32:35], v[128:143]
    v_mfma_f32_32x32x16_bf16 v[144:159], v[80:83], v[36:39], v[144:159]
    s_waitcnt lgkmcnt(12)
    v_mfma_f32_32x32x16_bf16 v[160:175], v[84:87], v[32:35], v[160:175]
    v_mfma_f32_32x32x16_bf16 v[176:191], v[84:87], v[36:39], v[176:191]
    s_waitcnt lgkmcnt(10)
    v_mfma_f32_32x32x16_bf16 v[192:207], v[88:91], v[32:35], v[192:207]
    v_mfma_f32_32x32x16_bf16 v[208:223], v[88:91], v[36:39], v[208:223]
    s_waitcnt lgkmcnt(8)
    v_mfma_f32_32x32x16_bf16 v[224:239], v[92:95], v[32:35], v[224:239]
    v_mfma_f32_32x32x16_bf16 v[240:255], v[92:95], v[36:39], v[240:255]
    buffer_load_dwordx4 v[32:35], v6, s[16:19], s25 offen
    buffer_load_dwordx4 v[36:39], v6, s[16:19], s26 offen
    s_add_u32 m0, s27, 4096
    s_nop 0
    buffer_load_dwordx4 v12, s[12:15], s24 offen lds
    s_add_u32 m0, s27, 5120
    s_nop 0
    buffer_load_dwordx4 v13, s[12:15], s24 offen lds
    s_add_u32 m0, s27, 6144
    s_nop 0
    buffer_load_dwordx4 v14, s[12:15], s24 offen lds
    s_add_u32 m0, s27, 7168
    s_nop 0
    buffer_load_dwordx4 v15, s[12:15], s24 offen lds
    s_add_u32 s24, s24, 32768
    s_add_u32 s25, s25, 1024
    s_add_u32 s26, s26, 1024
    s_waitcnt vmcnt(18)
    ds_read_b64_tr_b16 v[80:81], v8 offset:12288
    ds_read_b64_tr_b16 v[82:83], v8 offset:13312
    ds_read_b64_tr_b16 v[84:85], v9 offset:12288
    ds_read_b64_tr_b16 v[86:87], v9 offset:13312
    ds_read_b64_tr_b16 v[88:89], v10 offset:12288
    ds_read_b64_tr_b16 v[90:91], v10 offset:13312
    ds_read_b64_tr_b16 v[92:93], v11 offset:12288
    ds_read_b64_tr_b16 v[94:95], v11 offset:13312
    s_waitcnt lgkmcnt(14)
    v_mfma_f32_32x32x16_bf16 v[128:143], v[64:67], v[40:43], v[128:143]
    v_mfma_f32_32x32x16_bf16 v[144:159], v[64:67], v[44:47], v[144:159]
    s_waitcnt lgkmcnt(12)
    v_mfma_f32_32x32x16_bf16 v[160:175], v[68:71], v[40:43], v[160:175]
    v_mfma_f32_32x32x16_bf16 v[176:191], v[68:71], v[44:47], v[176:191]
    s_waitcnt lgkmcnt(10)
    v_mfma_f32_32x32x16_bf16 v[192:207], v[72:75], v[40:43], v[192:207]
    v_mfma_f32_32x32x16_bf16 v[208:223], v[72:75], v[44:47], v[208:223]
    s_waitcnt lgkmcnt(8)
    v_mfma_f32_32x32x16_bf16 v[224:239], v[76:79], v[40:43], v[224:239]
    v_mfma_f32_32x32x16_bf16 v[240:255], v[76:79], v[44:47], v[240:255]
    buffer_load_dwordx4 v[40:43], v6, s[16:19], s25 offen
    buffer_load_dwordx4 v[44:47], v6, s[16:19], s26 offen
    s_add_u32 m0, s27, 8192
    s_nop 0
    buffer_load_dwordx4 v12, s[12:15], s24 offen lds
    s_add_u32 m0, s27, 9216
    s_nop 0
    buffer_load_dwordx4 v13, s[12:15], s24 offen lds
    s_add_u32 m0, s27, 10240
    s_nop 0
    buffer_load_dwordx4 v14, s[12:15], s24 offen lds
    s_add_u32 m0, s27, 11264
    s_nop 0
    buffer_load_dwordx4 v15, s[12:15], s24 offen lds
    s_add_u32 s24, s24, 32768
    s_add_u32 s25, s25, 1024
    s_add_u32 s26, s26, 1024
    s_waitcnt vmcnt(18)
    ds_read_b64_tr_b16 v[64:65], v8 offset:16384
    ds_read_b64_tr_b16 v[66:67], v8 offset:17408
    ds_read_b64_tr_b16 v[68:69], v9 offset:16384
    ds_read_b64_tr_b16 v[70:71], v9 offset:17408
    ds_read_b64_tr_b16 v[72:73], v10 offset:16384
    ds_read_b64_tr_b16 v[74:75], v10 offset:17408
    ds_read_b64_tr_b16 v[76:77], v11 offset:16384
    ds_read_b64_tr_b16 v[78:79], v11 offset:17408
    s_waitcnt lgkmcnt(14)
    v_mfma_f32_32x32x16_bf16 v[128:143], v[80:83], v[48:51], v[128:143]
    v_mfma_f32_32x32x16_bf16 v[144:159], v[80:83], v[52:55], v[144:159]
    s_waitcnt lgkmcnt(12)
    v_mfma_f32_32x32x16_bf16 v[160:175], v[84:87], v[48:51], v[160:175]
    v_mfma_f32_32x32x16_bf16 v[176:191], v[84:87], v[52:55], v[176:191]
    s_waitcnt lgkmcnt(10)
    v_mfma_f32_32x32x16_bf16 v[192:207], v[88:91], v[48:51], v[192:207]
    v_mfma_f32_32x32x16_bf16 v[208:223], v[88:91], v[52:55], v[208:223]
    s_waitcnt lgkmcnt(8)
    v_mfma_f32_32x32x16_bf16 v[224:239], v[92:95], v[48:51], v[224:239]
    v_mfma_f32_32x32x16_bf16 v[240:255], v[92:95], v[52:55], v[240:255]
    buffer_load_dwordx4 v[48:51], v6, s[16:19], s25 offen
    buffer_load_dwordx4 v[52:55], v6, s[16:19], s26 offen
    s_add_u32 m0, s27, 12288
    s_nop 0
    buffer_load_dwordx4 v12, s[12:15], s24 offen lds
    s_add_u32 m0, s27, 13312
    s_nop 0
    buffer_load_dwordx4 v13, s[12:15], s24 offen lds
    s_add_u32 m0, s27, 14336
    s_nop 0
    buffer_load_dwordx4 v14, s[12:15], s24 offen lds
    s_add_u32 m0, s27, 15360
    s_nop 0
    buffer_load_dwordx4 v15, s[12:15], s24 offen lds
    s_add_u32 s24, s24, 32768
    s_add_u32 s25, s25, 1024
    s_add_u32 s26, s26, 1024
    s_waitcnt vmcnt(18)
    ds_read_b64_tr_b16 v[80:81], v8 offset:0
    ds_read_b64_tr_b16 v[82:83], v8 offset:1024
    ds_read_b64_tr_b16 v[84:85], v9 offset:0
    ds_read_b64_tr_b16 v[86:87], v9 offset:1024
    ds_read_b64_tr_b16 v[88:89], v10 offset:0
    ds_read_b64_tr_b16 v[90:91], v10 offset:1024
    ds_read_b64_tr_b16 v[92:93], v11 offset:0
    ds_read_b64_tr_b16 v[94:95], v11 offset:1024
    s_waitcnt lgkmcnt(14)
    v_mfma_f32_32x32x16_bf16 v[128:143], v[64:67], v[56:59], v[128:143]
    v_mfma_f32_32x32x16_bf16 v[144:159], v[64:67], v[60:63], v[144:159]
    s_waitcnt lgkmcnt(12)
    v_mfma_f32_32x32x16_bf16 v[160:175], v[68:71], v[56:59], v[160:175]
    v_mfma_f32_32x32x16_bf16 v[176:191], v[68:71], v[60:63], v[176:191]
    s_waitcnt lgkmcnt(10)
    v_mfma_f32_32x32x16_bf16 v[192:207], v[72:75], v[56:59], v[192:207]
    v_mfma_f32_32x32x16_bf16 v[208:223], v[72:75], v[60:63], v[208:223]
    s_waitcnt lgkmcnt(8)
    v_mfma_f32_32x32x16_bf16 v[224:239], v[76:79], v[56:59], v[224:239]
    v_mfma_f32_32x32x16_bf16 v[240:255], v[76:79], v[60:63], v[240:255]
    buffer_load_dwordx4 v[56:59], v6, s[16:19], s25 offen
    buffer_load_dwordx4 v[60:63], v6, s[16:19], s26 offen
    s_add_u32 m0, s27, 16384
    s_nop 0
    buffer_load_dwordx4 v12, s[12:15], s24 offen lds
    s_add_u32 m0, s27, 17408
    s_nop 0
    buffer_load_dwordx4 v13, s[12:15], s24 offen lds
    s_add_u32 m0, s27, 18432
    s_nop 0
    buffer_load_dwordx4 v14, s[12:15], s24 offen lds
    s_add_u32 m0, s27, 19456
    s_nop 0
    buffer_load_dwordx4 v15, s[12:15], s24 offen lds
    s_add_u32 s24, s24, 32768
    s_add_u32 s25, s25, 1024
    s_add_u32 s26, s26, 1024
    s_waitcnt vmcnt(18)
    ds_read_b64_tr_b16 v[64:65], v8 offset:4096
    ds_read_b64_tr_b16 v[66:67], v8 offset:5120
    ds_read_b64_tr_b16 v[68:69], v9 offset:4096
    ds_read_b64_tr_b16 v[70:71], v9 offset:5120
    ds_read_b64_tr_b16 v[72:73], v10 offset:4096
    ds_read_b64_tr_b16 v[74:75], v10 offset:5120
    ds_read_b64_tr_b16 v[76:77], v11 offset:4096
    ds_read_b64_tr_b16 v[78:79], v11 offset:5120
    s_waitcnt lgkmcnt(14)
    v_mfma_f32_32x32x16_bf16 v[128:143], v[80:83], v[24:27], v[128:143]
    v_mfma_f32_32x32x16_bf16 v[144:159], v[80:83], v[28:31], v[144:159]
    s_waitcnt lgkmcnt(12)
    v_mfma_f32_32x32x16_bf16 v[160:175], v[84:87], v[24:27], v[160:175]
    v_mfma_f32_32x32x16_bf16 v[176:191], v[84:87], v[28:31], v[176:191]
    s_waitcnt lgkmcnt(10)
    v_mfma_f32_32x32x16_bf16 v[192:207], v[88:91], v[24:27], v[192:207]
    v_mfma_f32_32x32x16_bf16 v[208:223], v[88:91], v[28:31], v[208:223]
    s_waitcnt lgkmcnt(8)
    v_mfma_f32_32x32x16_bf16 v[224:239], v[92:95], v[24:27], v[224:239]
    v_mfma_f32_32x32x16_bf16 v[240:255], v[92:95], v[28:31], v[240:255]
    buffer_load_dwordx4 v[24:27], v6, s[16:19], s25 offen
    buffer_load_dwordx4 v[28:31], v6, s[16:19], s26 offen
    s_add_u32 m0, s27, 0
    s_nop 0
    buffer_load_dwordx4 v12, s[12:15], s24 offen lds
    s_add_u32 m0, s27, 1024
    s_nop 0
    buffer_load_dwordx4 v13, s[12:15], s24 offen lds
    s_add_u32 m0, s27, 2048
    s_nop 0
    buffer_load_dwordx4 v14, s[12:15], s24 offen lds
    s_add_u32 m0, s27, 3072
    s_nop 0
    buffer_load_dwordx4 v15, s[12:15], s24 offen lds
    s_add_u32 s24, s24, 32768
    s_add_u32 s25, s25, 1024
    s_add_u32 s26, s26, 1024
    s_waitcnt vmcnt(18)
    ds_read_b64_tr_b16 v[80:81], v8 offset:8192
    ds_read_b64_tr_b16 v[82:83], v8 offset:9216
    ds_read_b64_tr_b16 v[84:85], v9 offset:8192
    ds_read_b64_tr_b16 v[86:87], v9 offset:9216
    ds_read_b64_tr_b16 v[88:89], v10 offset:8192
    ds_read_b64_tr_b16 v[90:91], v10 offset:9216
    ds_read_b64_tr_b16 v[92:93], v11 offset:8192
    ds_read_b64_tr_b16 v[94:95], v11 offset:9216
    s_waitcnt lgkmcnt(14)
    v_mfma_f32_32x32x16_bf16 v[128:143], v[64:67], v[32:35], v[128:143]
    v_mfma_f32_32x32x16_bf16 v[144:159], v[64:67], v[36:39], v[144:159]
    s_waitcnt lgkmcnt(12)
    v_mfma_f32_32x32x16_bf16 v[160:175], v[68:71], v[32:35], v[160:175]
    v_mfma_f32_32x32x16_bf16 v[176:191], v[68:71], v[36:39], v[176:191]
    s_waitcnt lgkmcnt(10)
    v_mfma_f32_32x32x16_bf16 v[192:207], v[72:75], v[32:35], v[192:207]
    v_mfma_f32_32x32x16_bf16 v[208:223], v[72:75], v[36:39], v[208:223]
    s_waitcnt lgkmcnt(8)
    v_mfma_f32_32x32x16_bf16 v[224:239], v[76:79], v[32:35], v[224:239]
    v_mfma_f32_32x32x16_bf16 v[240:255], v[76:79], v[36:39], v[240:255]
    buffer_load_dwordx4 v[32:35], v6, s[16:19], s25 offen
    buffer_load_dwordx4 v[36:39], v6, s[16:19], s26 offen
    s_add_u32 m0, s27, 4096
    s_nop 0
    buffer_load_dwordx4 v12, s[12:15], s24 offen lds
    s_add_u32 m0, s27, 5120
    s_nop 0
    buffer_load_dwordx4 v13, s[12:15], s24 offen lds
    s_add_u32 m0, s27, 6144
    s_nop 0
    buffer_load_dwordx4 v14, s[12:15], s24 offen lds
    s_add_u32 m0, s27, 7168
    s_nop 0
    buffer_load_dwordx4 v15, s[12:15], s24 offen lds
    s_add_u32 s24, s24, 32768
    s_add_u32 s25, s25, 1024
    s_add_u32 s26, s26, 1024
    s_waitcnt vmcnt(18)
    ds_read_b64_tr_b16 v[64:65], v8 offset:12288
    ds_read_b64_tr_b16 v[66:67], v8 offset:13312
    ds_read_b64_tr_b16 v[68:69], v9 offset:12288
    ds_read_b64_tr_b16 v[70:71], v9 offset:13312
    ds_read_b64_tr_b16 v[72:73], v10 offset:12288
    ds_read_b64_tr_b16 v[74:75], v10 offset:13312
    ds_read_b64_tr_b16 v[76:77], v11 offset:12288
    ds_read_b64_tr_b16 v[78:79], v11 offset:13312
    s_waitcnt lgkmcnt(14)
    v_mfma_f32_32x32x16_bf16 v[128:143], v[80:83], v[40:43], v[128:143]
    v_mfma_f32_32x32x16_bf16 v[144:159], v[80:83], v[44:47], v[144:159]
    s_waitcnt lgkmcnt(12)
    v_mfma_f32_32x32x16_bf16 v[160:175], v[84:87], v[40:43], v[160:175]
    v_mfma_f32_32x32x16_bf16 v[176:191], v[84:87], v[44:47], v[176:191]
    s_waitcnt lgkmcnt(10)
    v_mfma_f32_32x32x16_bf16 v[192:207], v[88:91], v[40:43], v[192:207]
    v_mfma_f32_32x32x16_bf16 v[208:223], v[88:91], v[44:47], v[208:223]
    s_waitcnt lgkmcnt(8)
    v_mfma_f32_32x32x16_bf16 v[224:239], v[92:95], v[40:43], v[224:239]
    v_mfma_f32_32x32x16_bf16 v[240:255], v[92:95], v[44:47], v[240:255]
    buffer_load_dwordx4 v[40:43], v6, s[16:19], s25 offen
    buffer_load_dwordx4 v[44:47], v6, s[16:19], s26 offen
    s_add_u32 m0, s27, 8192
    s_nop 0
    buffer_load_dwordx4 v12, s[12:15], s24 offen lds
    s_add_u32 m0, s27, 9216
    s_nop 0
    buffer_load_dwordx4 v13, s[12:15], s24 offen lds
    s_add_u32 m0, s27, 10240
    s_nop 0
    buffer_load_dwordx4 v14, s[12:15], s24 offen lds
    s_add_u32 m0, s27, 11264
    s_nop 0
    buffer_load_dwordx4 v15, s[12:15], s24 offen lds
    s_add_u32 s24, s24, 32768
    s_add_u32 s25, s25, 1024
    s_add_u32 s26, s26, 1024
    s_waitcnt vmcnt(18)
    ds_read_b64_tr_b16 v[80:81], v8 offset:16384
    ds_read_b64_tr_b16 v[82:83], v8 offset:17408
    ds_read_b64_tr_b16 v[84:85], v9 offset:16384
    ds_read_b64_tr_b16 v[86:87], v9 offset:17408
    ds_read_b64_tr_b16 v[88:89], v10 offset:16384
    ds_read_b64_tr_b16 v[90:91], v10 offset:17408
    ds_read_b64_tr_b16 v[92:93], v11 offset:16384
    ds_read_b64_tr_b16 v[94:95], v11 offset:17408
    s_waitcnt lgkmcnt(14)
    v_mfma_f32_32x32x16_bf16 v[128:143], v[64:67], v[48:51], v[128:143]
    v_mfma_f32_32x32x16_bf16 v[144:159], v[64:67], v[52:55], v[144:159]
    s_waitcnt lgkmcnt(12)
    v_mfma_f32_32x32x16_bf16 v[160:175], v[68:71], v[48:51], v[160:175]
    v_mfma_f32_32x32x16_bf16 v[176:191], v[68:71], v[52:55], v[176:191]
    s_waitcnt lgkmcnt(10)
    v_mfma_f32_32x32x16_bf16 v[192:207], v[72:75], v[48:51], v[192:207]
    v_mfma_f32_32x32x16_bf16 v[208:223], v[72:75], v[52:55], v[208:223]
    s_waitcnt lgkmcnt(8)
    v_mfma_f32_32x32x16_bf16 v[224:239], v[76:79], v[48:51], v[224:239]
    v_mfma_f32_32x32x16_bf16 v[240:255], v[76:79], v[52:55], v[240:255]
    buffer_load_dwordx4 v[48:51], v6, s[16:19], s25 offen
    buffer_load_dwordx4 v[52:55], v6, s[16:19], s26 offen
    s_add_u32 m0, s27, 12288
    s_nop 0
    buffer_load_dwordx4 v12, s[12:15], s24 offen lds
    s_add_u32 m0, s27, 13312
    s_nop 0
    buffer_load_dwordx4 v13, s[12:15], s24 offen lds
    s_add_u32 m0, s27, 14336
    s_nop 0
    buffer_load_dwordx4 v14, s[12:15], s24 offen lds
    s_add_u32 m0, s27, 15360
    s_nop 0
    buffer_load_dwordx4 v15, s[12:15], s24 offen lds
    s_add_u32 s24, s24, 32768
    s_add_u32 s25, s25, 1024
    s_add_u32 s26, s26, 1024
    s_waitcnt vmcnt(18)
    ds_read_b64_tr_b16 v[64:65], v8 offset:0
    ds_read_b64_tr_b16 v[66:67], v8 offset:1024
    ds_read_b64_tr_b16 v[68:69], v9 offset:0
    ds_read_b64_tr_b16 v[70:71], v9 offset:1024
    ds_read_b64_tr_b16 v[72:73], v10 offset:0
    ds_read_b64_tr_b16 v[74:75], v10 offset:1024
    ds_read_b64_tr_b16 v[76:77], v11 offset:0
    ds_read_b64_tr_b16 v[78:79], v11 offset:1024
    s_waitcnt lgkmcnt(14)
    v_mfma_f32_32x32x16_bf16 v[128:143], v[80:83], v[56:59], v[128:143]
    v_mfma_f32_32x32x16_bf16 v[144:159], v[80:83], v[60:63], v[144:159]
    s_waitcnt lgkmcnt(12)
    v_mfma_f32_32x32x16_bf16 v[160:175], v[84:87], v[56:59], v[160:175]
    v_mfma_f32_32x32x16_bf16 v[176:191], v[84:87], v[60:63], v[176:191]
    s_waitcnt lgkmcnt(10)
    v_mfma_f32_32x32x16_bf16 v[192:207], v[88:91], v[56:59], v[192:207]
    v_mfma_f32_32x32x16_bf16 v[208:223], v[88:91], v[60:63], v[208:223]
    s_waitcnt lgkmcnt(8)
    v_mfma_f32_32x32x16_bf16 v[224:239], v[92:95], v[56:59], v[224:239]
    v_mfma_f32_32x32x16_bf16 v[240:255], v[92:95], v[60:63], v[240:255]
    s_sub_u32 s30, s30, 1
    s_cmp_lg_u32 s30, 0
    s_cbranch_scc1 g2_loop
    buffer_load_dwordx4 v[56:59], v6, s[16:19], s25 offen
    buffer_load_dwordx4 v[60:63], v6, s[16:19], s26 offen
    s_add_u32 m0, s27, 16384
    s_nop 0
    buffer_load_dwordx4 v12, s[12:15], s24 offen lds
    s_add_u32 m0, s27, 17408
    s_nop 0
    buffer_load_dwordx4 v13, s[12:15], s24 offen lds
    s_add_u32 m0, s27, 18432
    s_nop 0
    buffer_load_dwordx4 v14, s[12:15], s24 offen lds
    s_add_u32 m0, s27, 19456
    s_nop 0
    buffer_load_dwordx4 v15, s[12:15], s24 offen lds
    s_add_u32 s24, s24, 32768
    s_add_u32 s25, s25, 1024
    s_add_u32 s26, s26, 1024
    s_waitcnt vmcnt(18)
    ds_read_b64_tr_b16 v[80:81], v8 offset:4096
    ds_read_b64_tr_b16 v[82:83], v8 offset:5120
    ds_read_b64_tr_b16 v[84:85], v9 offset:4096
    ds_read_b64_tr_b16 v[86:87], v9 offset:5120
    ds_read_b64_tr_b16 v[88:89], v10 offset:4096
    ds_read_b64_tr_b16 v[90:91], v10 offset:5120
    ds_read_b64_tr_b16 v[92:93], v11 offset:4096
    ds_read_b64_tr_b16 v[94:95], v11 offset:5120
    s_waitcnt lgkmcnt(14)
    v_mfma_f32_32x32x16_bf16 v[128:143], v[64:67], v[24:27], v[128:143]
    v_mfma_f32_32x32x16_bf16 v[144:159], v[64:67], v[28:31], v[144:159]
    s_waitcnt lgkmcnt(12)
    v_mfma_f32_32x32x16_bf16 v[160:175], v[68:71], v[24:27], v[160:175]
    v_mfma_f32_32x32x16_bf16 v[176:191], v[68:71], v[28:31], v[176:191]
    s_waitcnt lgkmcnt(10)
    v_mfma_f32_32x32x16_bf16 v[192:207], v[72:75], v[24:27], v[192:207]
    v_mfma_f32_32x32x16_bf16 v[208:223], v[72:75], v[28:31], v[208:223]
    s_waitcnt lgkmcnt(8)
    v_mfma_f32_32x32x16_bf16 v[224:239], v[76:79], v[24:27], v[224:239]
    v_mfma_f32_32x32x16_bf16 v[240:255], v[76:79], v[28:31], v[240:255]
    buffer_load_dwordx4 v[24:27], v6, s[16:19], s25 offen
    buffer_load_dwordx4 v[28:31], v6, s[16:19], s26 offen
    s_add_u32 m0, s27, 0
    s_nop 0
    buffer_load_dwordx4 v12, s[12:15], s24 offen lds
    s_add_u32 m0, s27, 1024
    s_nop 0
    buffer_load_dwordx4 v13, s[12:15], s24 offen lds
    s_add_u32 m0, s27, 2048
    s_nop 0
    buffer_load_dwordx4 v14, s[12:15], s24 offen lds
    s_add_u32 m0, s27, 3072
    s_nop 0
    buffer_load_dwordx4 v15, s[12:15], s24 offen lds
    s_add_u32 s24, s24, 32768
    s_add_u32 s25, s25, 1024
    s_add_u32 s26, s26, 1024
    s_waitcnt vmcnt(18)
    ds_read_b64_tr_b16 v[64:65], v8 offset:8192
    ds_read_b64_tr_b16 v[66:67], v8 offset:9216
    ds_read_b64_tr_b16 v[68:69], v9 offset:8192
    ds_read_b64_tr_b16 v[70:71], v9 offset:9216
    ds_read_b64_tr_b16 v[72:73], v10 offset:8192
    ds_read_b64_tr_b16 v[74:75], v10 offset:9216
    ds_read_b64_tr_b16 v[76:77], v11 offset:8192
    ds_read_b64_tr_b16 v[78:79], v11 offset:9216
    s_waitcnt lgkmcnt(14)
    v_mfma_f32_32x32x16_bf16 v[128:143], v[80:83], v[32:35], v[128:143]
    v_mfma_f32_32x32x16_bf16 v[144:159], v[80:83], v[36:39], v[144:159]
    s_waitcnt lgkmcnt(12)
    v_mfma_f32_32x32x16_bf16 v[160:175], v[84:87], v[32:35], v[160:175]
    v_mfma_f32_32x32x16_bf16 v[176:191], v[84:87], v[36:39], v[176:191]
    s_waitcnt lgkmcnt(10)
    v_mfma_f32_32x32x16_bf16 v[192:207], v[88:91], v[32:35], v[192:207]
    v_mfma_f32_32x32x16_bf16 v[208:223], v[88:91], v[36:39], v[208:223]
    s_waitcnt lgkmcnt(8)
    v_mfma_f32_32x32x16_bf16 v[224:239], v[92:95], v[32:35], v[224:239]
    v_mfma_f32_32x32x16_bf16 v[240:255], v[92:95], v[36:39], v[240:255]
    buffer_load_dwordx4 v[32:35], v6, s[16:19], s25 offen
    buffer_load_dwordx4 v[36:39], v6, s[16:19], s26 offen
    s_add_u32 m0, s27, 4096
    s_nop 0
    buffer_load_dwordx4 v12, s[12:15], s24 offen lds
    s_add_u32 m0, s27, 5120
    s_nop 0
    buffer_load_dwordx4 v13, s[12:15], s24 offen lds
    s_add_u32 m0, s27, 6144
    s_nop 0
    buffer_load_dwordx4 v14, s[12:15], s24 offen lds
    s_add_u32 m0, s27, 7168
    s_nop 0
    buffer_load_dwordx4 v15, s[12:15], s24 offen lds
    s_add_u32 s24, s24, 32768
    s_add_u32 s25, s25, 1024
    s_add_u32 s26, s26, 1024
    s_waitcnt vmcnt(18)
    ds_read_b64_tr_b16 v[80:81], v8 offset:12288
    ds_read_b64_tr_b16 v[82:83], v8 offset:13312
    ds_read_b64_tr_b16 v[84:85], v9 offset:12288
    ds_read_b64_tr_b16 v[86:87], v9 offset:13312
    ds_read_b64_tr_b16 v[88:89], v10 offset:12288
    ds_read_b64_tr_b16 v[90:91], v10 offset:13312
    ds_read_b64_tr_b16 v[92:93], v11 offset:12288
    ds_read_b64_tr_b16 v[94:95], v11 offset:13312
    s_waitcnt lgkmcnt(14)
    v_mfma_f32_32x32x16_bf16 v[128:143], v[64:67], v[40:43], v[128:143]
    v_mfma_f32_32x32x16_bf16 v[144:159], v[64:67], v[44:47], v[144:159]
    s_waitcnt lgkmcnt(12)
    v_mfma_f32_32x32x16_bf16 v[160:175], v[68:71], v[40:43], v[160:175]
    v_mfma_f32_32x32x16_bf16 v[176:191], v[68:71], v[44:47], v[176:191]
    s_waitcnt lgkmcnt(10)
    v_mfma_f32_32x32x16_bf16 v[192:207], v[72:75], v[40:43], v[192:207]
    v_mfma_f32_32x32x16_bf16 v[208:223], v[72:75], v[44:47], v[208:223]
    s_waitcnt lgkmcnt(8)
    v_mfma_f32_32x32x16_bf16 v[224:239], v[76:79], v[40:43], v[224:239]
    v_mfma_f32_32x32x16_bf16 v[240:255], v[76:79], v[44:47], v[240:255]
    buffer_load_dwordx4 v[40:43], v6, s[16:19], s25 offen
    buffer_load_dwordx4 v[44:47], v6, s[16:19], s26 offen
    s_add_u32 m0, s27, 8192
    s_nop 0
    buffer_load_dwordx4 v12, s[12:15], s24 offen lds
    s_add_u32 m0, s27, 9216
    s_nop 0
    buffer_load_dwordx4 v13, s[12:15], s24 offen lds
    s_add_u32 m0, s27, 10240
    s_nop 0
    buffer_load_dwordx4 v14, s[12:15], s24 offen lds
    s_add_u32 m0, s27, 11264
    s_nop 0
    buffer_load_dwordx4 v15, s[12:15], s24 offen lds
    s_add_u32 s24, s24, 32768
    s_add_u32 s25, s25, 1024
    s_add_u32 s26, s26, 1024
    s_waitcnt vmcnt(18)
    ds_read_b64_tr_b16 v[64:65], v8 offset:16384
    ds_read_b64_tr_b16 v[66:67], v8 offset:17408
    ds_read_b64_tr_b16 v[68:69], v9 offset:16384
    ds_read_b64_tr_b16 v[70:71], v9 offset:17408
    ds_read_b64_tr_b16 v[72:73], v10 offset:16384
    ds_read_b64_tr_b16 v[74:75], v10 offset:17408
    ds_read_b64_tr_b16 v[76:77], v11 offset:16384
    ds_read_b64_tr_b16 v[78:79], v11 offset:17408
    s_waitcnt lgkmcnt(14)
    v_mfma_f32_32x32x16_bf16 v[128:143], v[80:83], v[48:51], v[128:143]
    v_mfma_f32_32x32x16_bf16 v[144:159], v[80:83], v[52:55], v[144:159]
    s_waitcnt lgkmcnt(12)
    v_mfma_f32_32x32x16_bf16 v[160:175], v[84:87], v[48:51], v[160:175]
    v_mfma_f32_32x32x16_bf16 v[176:191], v[84:87], v[52:55], v[176:191]
    s_waitcnt lgkmcnt(10)
    v_mfma_f32_32x32x16_bf16 v[192:207], v[88:91], v[48:51], v[192:207]
    v_mfma_f32_32x32x16_bf16 v[208:223], v[88:91], v[52:55], v[208:223]
    s_waitcnt lgkmcnt(8)
    v_mfma_f32_32x32x16_bf16 v[224:239], v[92:95], v[48:51], v[224:239]
    v_mfma_f32_32x32x16_bf16 v[240:255], v[92:95], v[52:55], v[240:255]
    s_waitcnt vmcnt(12)
    ds_read_b64_tr_b16 v[80:81], v8 offset:0
    ds_read_b64_tr_b16 v[82:83], v8 offset:1024
    ds_read_b64_tr_b16 v[84:85], v9 offset:0
    ds_read_b64_tr_b16 v[86:87], v9 offset:1024
    ds_read_b64_tr_b16 v[88:89], v10 offset:0
    ds_read_b64_tr_b16 v[90:91], v10 offset:1024
    ds_read_b64_tr_b16 v[92:93], v11 offset:0
    ds_read_b64_tr_b16 v[94:95], v11 offset:1024
    s_waitcnt lgkmcnt(14)
    v_mfma_f32_32x32x16_bf16 v[128:143], v[64:67], v[56:59], v[128:143]
    v_mfma_f32_32x32x16_bf16 v[144:159], v[64:67], v[60:63], v[144:159]
    s_waitcnt lgkmcnt(12)
    v_mfma_f32_32x32x16_bf16 v[160:175], v[68:71], v[56:59], v[160:175]
    v_mfma_f32_32x32x16_bf16 v[176:191], v[68:71], v[60:63], v[176:191]
    s_waitcnt lgkmcnt(10)
    v_mfma_f32_32x32x16_bf16 v[192:207], v[72:75], v[56:59], v[192:207]
    v_mfma_f32_32x32x16_bf16 v[208:223], v[72:75], v[60:63], v[208:223]
    s_waitcnt lgkmcnt(8)
    v_mfma_f32_32x32x16_bf16 v[224:239], v[76:79], v[56:59], v[224:239]
    v_mfma_f32_32x32x16_bf16 v[240:255], v[76:79], v[60:63], v[240:255]
    s_waitcnt vmcnt(6)
    ds_read_b64_tr_b16 v[64:65], v8 offset:4096
    ds_read_b64_tr_b16 v[66:67], v8 offset:5120
    ds_read_b64_tr_b16 v[68:69], v9 offset:4096
    ds_read_b64_tr_b16 v[70:71], v9 offset:5120
    ds_read_b64_tr_b16 v[72:73], v10 offset:4096
    ds_read_b64_tr_b16 v[74:75], v10 offset:5120
    ds_read_b64_tr_b16 v[76:77], v11 offset:4096
    ds_read_b64_tr_b16 v[78:79], v11 offset:5120
    s_waitcnt lgkmcnt(14)
    v_mfma_f32_32x32x16_bf16 v[128:143], v[80:83], v[24:27], v[128:143]
    v_mfma_f32_32x32x16_bf16 v[144:159], v[80:83], v[28:31], v[144:159]
    s_waitcnt lgkmcnt(12)
    v_mfma_f32_32x32x16_bf16 v[160:175], v[84:87], v[24:27], v[160:175]
    v_mfma_f32_32x32x16_bf16 v[176:191], v[84:87], v[28:31], v[176:191]
    s_waitcnt lgkmcnt(10)
    v_mfma_f32_32x32x16_bf16 v[192:207], v[88:91], v[24:27], v[192:207]
    v_mfma_f32_32x32x16_bf16 v[208:223], v[88:91], v[28:31], v[208:223]
    s_waitcnt lgkmcnt(8)
    v_mfma_f32_32x32x16_bf16 v[224:239], v[92:95], v[24:27], v[224:239]
    v_mfma_f32_32x32x16_bf16 v[240:255], v[92:95], v[28:31], v[240:255]
    s_waitcnt vmcnt(0)
    ds_read_b64_tr_b16 v[80:81], v8 offset:8192
    ds_read_b64_tr_b16 v[82:83], v8 offset:9216
    ds_read_b64_tr_b16 v[84:85], v9 offset:8192
    ds_read_b64_tr_b16 v[86:87], v9 offset:9216
    ds_read_b64_tr_b16 v[88:89], v10 offset:8192
    ds_read_b64_tr_b16 v[90:91], v10 offset:9216
    ds_read_b64_tr_b16 v[92:93], v11 offset:8192
    ds_read_b64_tr_b16 v[94:95], v11 offset:9216
    s_waitcnt lgkmcnt(14)
    v_mfma_f32_32x32x16_bf16 v[128:143], v[64:67], v[32:35], v[128:143]
    v_mfma_f32_32x32x16_bf16 v[144:159], v[64:67], v[36:39], v[144:159]
    s_waitcnt lgkmcnt(12)
    v_mfma_f32_32x32x16_bf16 v[160:175], v[68:71], v[32:35], v[160:175]
    v_mfma_f32_32x32x16_bf16 v[176:191], v[68:71], v[36:39], v[176:191]
    s_waitcnt lgkmcnt(10)
    v_mfma_f32_32x32x16_bf16 v[192:207], v[72:75], v[32:35], v[192:207]
    v_mfma_f32_32x32x16_bf16 v[208:223], v[72:75], v[36:39], v[208:223]
    s_waitcnt lgkmcnt(8)
    v_mfma_f32_32x32x16_bf16 v[224:239], v[76:79], v[32:35], v[224:239]
    v_mfma_f32_32x32x16_bf16 v[240:255], v[76:79], v[36:39], v[240:255]
    ds_read_b64_tr_b16 v[64:65], v8 offset:12288
    ds_read_b64_tr_b16 v[66:67], v8 offset:13312
    ds_read_b64_tr_b16 v[68:69], v9 offset:12288
    ds_read_b64_tr_b16 v[70:71], v9 offset:13312
    ds_read_b64_tr_b16 v[72:73], v10 offset:12288
    ds_read_b64_tr_b16 v[74:75], v10 offset:13312
    ds_read_b64_tr_b16 v[76:77], v11 offset:12288
    ds_read_b64_tr_b16 v[78:79], v11 offset:13312
    s_waitcnt lgkmcnt(14)
    v_mfma_f32_32x32x16_bf16 v[128:143], v[80:83], v[40:43], v[128:143]
    v_mfma_f32_32x32x16_bf16 v[144:159], v[80:83], v[44:47], v[144:159]
    s_waitcnt lgkmcnt(12)
    v_mfma_f32_32x32x16_bf16 v[160:175], v[84:87], v[40:43], v[160:175]
    v_mfma_f32_32x32x16_bf16 v[176:191], v[84:87], v[44:47], v[176:191]
    s_waitcnt lgkmcnt(10)
    v_mfma_f32_32x32x16_bf16 v[192:207], v[88:91], v[40:43], v[192:207]
    v_mfma_f32_32x32x16_bf16 v[208:223], v[88:91], v[44:47], v[208:223]
    s_waitcnt lgkmcnt(8)
    v_mfma_f32_32x32x16_bf16 v[224:239], v[92:95], v[40:43], v[224:239]
    v_mfma_f32_32x32x16_bf16 v[240:255], v[92:95], v[44:47], v[240:255]
    s_waitcnt vmcnt(0) lgkmcnt(0)
    s_nop 15
    s_barrier
    v_lshlrev_b32 v2, 4, v1
    s_lshl_b32 s23, s22, 12
    v_add_u32 v2, s23, v2
    v_lshlrev_b32 v3, 4, v1
    s_and_b32 s23, s22, 3
    s_lshl_b32 s23, s23, 15
    v_add_u32 v3, s23, v3
    v_add_u32 v5, 0x10000, v2
    ds_write_b128 v2, v[128:131] offset:0
    ds_write_b128 v2, v[132:135] offset:1024
    ds_write_b128 v2, v[136:139] offset:2048
    ds_write_b128 v2, v[140:143] offset:3072
    ds_write_b128 v2, v[144:147] offset:32768
    ds_write_b128 v2, v[148:151] offset:33792
    ds_write_b128 v2, v[152:155] offset:34816
    ds_write_b128 v2, v[156:159] offset:35840
    ds_write_b128 v5, v[160:163] offset:0
    ds_write_b128 v5, v[164:167] offset:1024
    ds_write_b128 v5, v[168:171] offset:2048
    ds_write_b128 v5, v[172:175] offset:3072
    ds_write_b128 v5, v[176:179] offset:32768
    ds_write_b128 v5, v[180:183] offset:33792
    ds_write_b128 v5, v[184:187] offset:34816
    ds_write_b128 v5, v[188:191] offset:35840
    s_waitcnt lgkmcnt(0)
    s_barrier
    s_cmp_lt_u32 s22, 4
    s_cbranch_scc0 g2_skip1
    ds_read_b128 v[64:67], v3 offset:0
    ds_read_b128 v[68:71], v3 offset:1024
    ds_read_b128 v[72:75], v3 offset:2048
    ds_read_b128 v[76:79], v3 offset:3072
    ds_read_b128 v[80:83], v3 offset:4096
    ds_read_b128 v[84:87], v3 offset:5120
    ds_read_b128 v[88:91], v3 offset:6144
    ds_read_b128 v[92:95], v3 offset:7168
    s_waitcnt lgkmcnt(0)
    v_add_f32 v64, v64, v80
    v_add_f32 v65, v65, v81
    v_add_f32 v66, v66, v82
    v_add_f32 v67, v67, v83
    v_add_f32 v68, v68, v84
    v_add_f32 v69, v69, v85
    v_add_f32 v70, v70, v86
    v_add_f32 v71, v71, v87
    v_add_f32 v72, v72, v88
    v_add_f32 v73, v73, v89
    v_add_f32 v74, v74, v90
    v_add_f32 v75, v75, v91
    v_add_f32 v76, v76, v92
    v_add_f32 v77, v77, v93
    v_add_f32 v78, v78, v94
    v_add_f32 v79, v79, v95
    ds_read_b128 v[96:99], v3 offset:8192
    ds_read_b128 v[100:103], v3 offset:9216
    ds_read_b128 v[104:107], v3 offset:10240
    ds_read_b128 v[108:111], v3 offset:11264
    s_waitcnt lgkmcnt(0)
    v_add_f32 v64, v64, v96
    v_add_f32 v65, v65, v97
    v_add_f32 v66, v66, v98
    v_add_f32 v67, v67, v99
    v_add_f32 v68, v68, v100
    v_add_f32 v69, v69, v101
    v_add_f32 v70, v70, v102
    v_add_f32 v71, v71, v103
    v_add_f32 v72, v72, v104
    v_add_f32 v73, v73, v105
    v_add_f32 v74, v74, v106
    v_add_f32 v75, v75, v107
    v_add_f32 v76, v76, v108
    v_add_f32 v77, v77, v109
    v_add_f32 v78, v78, v110
    v_add_f32 v79, v79, v111
    ds_read_b128 v[112:115], v3 offset:12288
    ds_read_b128 v[116:119], v3 offset:13312
    ds_read_b128 v[120:123], v3 offset:14336
    ds_read_b128 v[124:127], v3 offset:15360
    s_waitcnt lgkmcnt(0)
    v_add_f32 v64, v64, v112
    v_add_f32 v65, v65, v113
    v_add_f32 v66, v66, v114
    v_add_f32 v67, v67, v115
    v_add_f32 v68, v68, v116
    v_add_f32 v69, v69, v117
    v_add_f32 v70, v70, v118
    v_add_f32 v71, v71, v119
    v_add_f32 v72, v72, v120
    v_add_f32 v73, v73, v121
    v_add_f32 v74, v74, v122
    v_add_f32 v75, v75, v123
    v_add_f32 v76, v76, v124
    v_add_f32 v77, v77, v125
    v_add_f32 v78, v78, v126
    v_add_f32 v79, v79, v127
    ds_read_b128 v[80:83], v3 offset:16384
    ds_read_b128 v[84:87], v3 offset:17408
    ds_read_b128 v[88:91], v3 offset:18432
    ds_read_b128 v[92:95], v3 offset:19456
    s_waitcnt lgkmcnt(0)
    v_add_f32 v64, v64, v80
    v_add_f32 v65, v65, v81
    v_add_f32 v66, v66, v82
    v_add_f32 v67, v67, v83
    v_add_f32 v68, v68, v84
    v_add_f32 v69, v69, v85
    v_add_f32 v70, v70, v86
    v_add_f32 v71, v71, v87
    v_add_f32 v72, v72, v88
    v_add_f32 v73, v73, v89
    v_add_f32 v74, v74, v90
    v_add_f32 v75, v75, v91
    v_add_f32 v76, v76, v92
    v_add_f32 v77, v77, v93
    v_add_f32 v78, v78, v94
    v_add_f32 v79, v79, v95
    ds_read_b128 v[96:99], v3 offset:20480
    ds_read_b128 v[100:103], v3 offset:21504
    ds_read_b128 v[104:107], v3 offset:22528
    ds_read_b128 v[108:111], v3 offset:23552
    s_waitcnt lgkmcnt(0)
    v_add_f32 v64, v64, v96
    v_add_f32 v65, v65, v97
    v_add_f32 v66, v66, v98
    v_add_f32 v67, v67, v99
    v_add_f32 v68, v68, v100
    v_add_f32 v69, v69, v101
    v_add_f32 v70, v70, v102
    v_add_f32 v71, v71, v103
    v_add_f32 v72, v72, v104
    v_add_f32 v73, v73, v105
    v_add_f32 v74, v74, v106
    v_add_f32 v75, v75, v107
    v_add_f32 v76, v76, v108
    v_add_f32 v77, v77, v109
    v_add_f32 v78, v78, v110
    v_add_f32 v79, v79, v111
    ds_read_b128 v[112:115], v3 offset:24576
    ds_read_b128 v[116:119], v3 offset:25600
    ds_read_b128 v[120:123], v3 offset:26624
    ds_read_b128 v[124:127], v3 offset:27648
    s_waitcnt lgkmcnt(0)
    v_add_f32 v64, v64, v112
    v_add_f32 v65, v65, v113
    v_add_f32 v66, v66, v114
    v_add_f32 v67, v67, v115
    v_add_f32 v68, v68, v116
    v_add_f32 v69, v69, v117
    v_add_f32 v70, v70, v118
    v_add_f32 v71, v71, v119
    v_add_f32 v72, v72, v120
    v_add_f32 v73, v73, v121
    v_add_f32 v74, v74, v122
    v_add_f32 v75, v75, v123
    v_add_f32 v76, v76, v124
    v_add_f32 v77, v77, v125
    v_add_f32 v78, v78, v126
    v_add_f32 v79, v79, v127
    ds_read_b128 v[80:83], v3 offset:28672
    ds_read_b128 v[84:87], v3 offset:29696
    ds_read_b128 v[88:91], v3 offset:30720
    ds_read_b128 v[92:95], v3 offset:31744
    s_waitcnt lgkmcnt(0)
    v_add_f32 v64, v64, v80
    v_add_f32 v65, v65, v81
    v_add_f32 v66, v66, v82
    v_add_f32 v67, v67, v83
    v_add_f32 v68, v68, v84
    v_add_f32 v69, v69, v85
    v_add_f32 v70, v70, v86
    v_add_f32 v71, v71, v87
    v_add_f32 v72, v72, v88
    v_add_f32 v73, v73, v89
    v_add_f32 v74, v74, v90
    v_add_f32 v75, v75, v91
    v_add_f32 v76, v76, v92
    v_add_f32 v77, v77, v93
    v_add_f32 v78, v78, v94
    v_add_f32 v79, v79, v95
    s_waitcnt lgkmcnt(0)
g2_skip1:
    s_barrier
    ds_write_b128 v2, v[192:195] offset:0
    ds_write_b128 v2, v[196:199] offset:1024
    ds_write_b128 v2, v[200:203] offset:2048
    ds_write_b128 v2, v[204:207] offset:3072
    ds_write_b128 v2, v[208:211] offset:32768
    ds_write_b128 v2, v[212:215] offset:33792
    ds_write_b128 v2, v[216:219] offset:34816
    ds_write_b128 v2, v[220:223] offset:35840
    ds_write_b128 v5, v[224:227] offset:0
    ds_write_b128 v5, v[228:231] offset:1024
    ds_write_b128 v5, v[232:235] offset:2048
    ds_write_b128 v5, v[236:239] offset:3072
    ds_write_b128 v5, v[240:243] offset:32768
    ds_write_b128 v5, v[244:247] offset:33792
    ds_write_b128 v5, v[248:251] offset:34816
    ds_write_b128 v5, v[252:255] offset:35840
    s_waitcnt lgkmcnt(0)
    s_barrier
    s_cmp_lt_u32 s22, 4
    s_cbranch_scc1 g2_skip2
    ds_read_b128 v[64:67], v3 offset:0
    ds_read_b128 v[68:71], v3 offset:1024
    ds_read_b128 v[72:75], v3 offset:2048
    ds_read_b128 v[76:79], v3 offset:3072
    ds_read_b128 v[80:83], v3 offset:4096
    ds_read_b128 v[84:87], v3 offset:5120
    ds_read_b128 v[88:91], v3 offset:6144
    ds_read_b128 v[92:95], v3 offset:7168
    s_waitcnt lgkmcnt(0)
    v_add_f32 v64, v64, v80
    v_add_f32 v65, v65, v81
    v_add_f32 v66, v66, v82
    v_add_f32 v67, v67, v83
    v_add_f32 v68, v68, v84
    v_add_f32 v69, v69, v85
    v_add_f32 v70, v70, v86
    v_add_f32 v71, v71, v87
    v_add_f32 v72, v72, v88
    v_add_f32 v73, v73, v89
    v_add_f32 v74, v74, v90
    v_add_f32 v75, v75, v91
    v_add_f32 v76, v76, v92
    v_add_f32 v77, v77, v93
    v_add_f32 v78, v78, v94
    v_add_f32 v79, v79, v95
    ds_read_b128 v[96:99], v3 offset:8192
    ds_read_b128 v[100:103], v3 offset:9216
    ds_read_b128 v[104:107], v3 offset:10240
    ds_read_b128 v[108:111], v3 offset:11264
    s_waitcnt lgkmcnt(0)
    v_add_f32 v64, v64, v96
    v_add_f32 v65, v65, v97
    v_add_f32 v66, v66, v98
    v_add_f32 v67, v67, v99
    v_add_f32 v68, v68, v100
    v_add_f32 v69, v69, v101
    v_add_f32 v70, v70, v102
    v_add_f32 v71, v71, v103
    v_add_f32 v72, v72, v104
    v_add_f32 v73, v73, v105
    v_add_f32 v74, v74, v106
    v_add_f32 v75, v75, v107
    v_add_f32 v76, v76, v108
    v_add_f32 v77, v77, v109
    v_add_f32 v78, v78, v110
    v_add_f32 v79, v79, v111
    ds_read_b128 v[112:115], v3 offset:12288
    ds_read_b128 v[116:119], v3 offset:13312
    ds_read_b128 v[120:123], v3 offset:14336
    ds_read_b128 v[124:127], v3 offset:15360
    s_waitcnt lgkmcnt(0)
    v_add_f32 v64, v64, v112
    v_add_f32 v65, v65, v113
    v_add_f32 v66, v66, v114
    v_add_f32 v67, v67, v115
    v_add_f32 v68, v68, v116
    v_add_f32 v69, v69, v117
    v_add_f32 v70, v70, v118
    v_add_f32 v71, v71, v119
    v_add_f32 v72, v72, v120
    v_add_f32 v73, v73, v121
    v_add_f32 v74, v74, v122
    v_add_f32 v75, v75, v123
    v_add_f32 v76, v76, v124
    v_add_f32 v77, v77, v125
    v_add_f32 v78, v78, v126
    v_add_f32 v79, v79, v127
    ds_read_b128 v[80:83], v3 offset:16384
    ds_read_b128 v[84:87], v3 offset:17408
    ds_read_b128 v[88:91], v3 offset:18432
    ds_read_b128 v[92:95], v3 offset:19456
    s_waitcnt lgkmcnt(0)
    v_add_f32 v64, v64, v80
    v_add_f32 v65, v65, v81
    v_add_f32 v66, v66, v82
    v_add_f32 v67, v67, v83
    v_add_f32 v68, v68, v84
    v_add_f32 v69, v69, v85
    v_add_f32 v70, v70, v86
    v_add_f32 v71, v71, v87
    v_add_f32 v72, v72, v88
    v_add_f32 v73, v73, v89
    v_add_f32 v74, v74, v90
    v_add_f32 v75, v75, v91
    v_add_f32 v76, v76, v92
    v_add_f32 v77, v77, v93
    v_add_f32 v78, v78, v94
    v_add_f32 v79, v79, v95
    ds_read_b128 v[96:99], v3 offset:20480
    ds_read_b128 v[100:103], v3 offset:21504
    ds_read_b128 v[104:107], v3 offset:22528
    ds_read_b128 v[108:111], v3 offset:23552
    s_waitcnt lgkmcnt(0)
    v_add_f32 v64, v64, v96
    v_add_f32 v65, v65, v97
    v_add_f32 v66, v66, v98
    v_add_f32 v67, v67, v99
    v_add_f32 v68, v68, v100
    v_add_f32 v69, v69, v101
    v_add_f32 v70, v70, v102
    v_add_f32 v71, v71, v103
    v_add_f32 v72, v72, v104
    v_add_f32 v73, v73, v105
    v_add_f32 v74, v74, v106
    v_add_f32 v75, v75, v107
    v_add_f32 v76, v76, v108
    v_add_f32 v77, v77, v109
    v_add_f32 v78, v78, v110
    v_add_f32 v79, v79, v111
    ds_read_b128 v[112:115], v3 offset:24576
    ds_read_b128 v[116:119], v3 offset:25600
    ds_read_b128 v[120:123], v3 offset:26624
    ds_read_b128 v[124:127], v3 offset:27648
    s_waitcnt lgkmcnt(0)
    v_add_f32 v64, v64, v112
    v_add_f32 v65, v65, v113
    v_add_f32 v66, v66, v114
    v_add_f32 v67, v67, v115
    v_add_f32 v68, v68, v116
    v_add_f32 v69, v69, v117
    v_add_f32 v70, v70, v118
    v_add_f32 v71, v71, v119
    v_add_f32 v72, v72, v120
    v_add_f32 v73, v73, v121
    v_add_f32 v74, v74, v122
    v_add_f32 v75, v75, v123
    v_add_f32 v76, v76, v124
    v_add_f32 v77, v77, v125
    v_add_f32 v78, v78, v126
    v_add_f32 v79, v79, v127
    ds_read_b128 v[80:83], v3 offset:28672
    ds_read_b128 v[84:87], v3 offset:29696
    ds_read_b128 v[88:91], v3 offset:30720
    ds_read_b128 v[92:95], v3 offset:31744
    s_waitcnt lgkmcnt(0)
    v_add_f32 v64, v64, v80
    v_add_f32 v65, v65, v81
    v_add_f32 v66, v66, v82
    v_add_f32 v67, v67, v83
    v_add_f32 v68, v68, v84
    v_add_f32 v69, v69, v85
    v_add_f32 v70, v70, v86
    v_add_f32 v71, v71, v87
    v_add_f32 v72, v72, v88
    v_add_f32 v73, v73, v89
    v_add_f32 v74, v74, v90
    v_add_f32 v75, v75, v91
    v_add_f32 v76, v76, v92
    v_add_f32 v77, v77, v93
    v_add_f32 v78, v78, v94
    v_add_f32 v79, v79, v95
    s_waitcnt lgkmcnt(0)
g2_skip2:
    s_lshr_b32 s23, s22, 1
    s_and_b32 s31, s22, 1
    s_lshl_b32 s23, s23, 5
    s_lshl_b32 s32, s20, 7
    s_add_u32 s23, s23, s32
    s_lshl_b32 s31, s31, 5
    s_lshl_b32 s32, s21, 6
    s_add_u32 s31, s31, s32
    s_lshl_b32 s31, s31, 11
    s_lshl_b32 s23, s23, 1
    s_add_u32 s31, s31, s23
    s_add_u32 s31, s31, 20971520
    v_and_b32 v2, 31, v1
    v_lshlrev_b32 v2, 11, v2
    v_lshrrev_b32 v3, 5, v1
    v_lshlrev_b32 v3, 3, v3
    v_add_u32 v2, v2, v3
    s_mov_b32 s33, 0xbfb8aa3b
    s_mov_b32 s34, 0xffff0000
    v_cvt_pk_bf16_f32 v80, v64, v65
    v_cvt_pk_bf16_f32 v81, v66, v67
    v_lshlrev_b32 v82, 16, v80
    v_and_b32 v83, s34, v80
    v_lshlrev_b32 v84, 16, v81
    v_and_b32 v85, s34, v81
    v_mul_f32 v86, s33, v82
    v_mul_f32 v87, s33, v83
    v_mul_f32 v88, s33, v84
    v_mul_f32 v89, s33, v85
    v_exp_f32 v86, v86
    v_exp_f32 v87, v87
    v_exp_f32 v88, v88
    v_exp_f32 v89, v89
    v_add_f32 v86, 1.0, v86
    v_add_f32 v87, 1.0, v87
    v_add_f32 v88, 1.0, v88
    v_add_f32 v89, 1.0, v89
    v_rcp_f32 v86, v86
    v_rcp_f32 v87, v87
    v_rcp_f32 v88, v88
    v_rcp_f32 v89, v89
    v_mul_f32 v86, v82, v86
    v_mul_f32 v87, v83, v87
    v_mul_f32 v88, v84, v88
    v_mul_f32 v89, v85, v89
    v_cvt_pk_bf16_f32 v90, v86, v87
    v_cvt_pk_bf16_f32 v91, v88, v89
    buffer_store_dwordx2 v[90:91], v2, s[16:19], s31 offen offset:0
    v_cvt_pk_bf16_f32 v80, v68, v69
    v_cvt_pk_bf16_f32 v81, v70, v71
    v_lshlrev_b32 v82, 16, v80
    v_and_b32 v83, s34, v80
    v_lshlrev_b32 v84, 16, v81
    v_and_b32 v85, s34, v81
    v_mul_f32 v86, s33, v82
    v_mul_f32 v87, s33, v83
    v_mul_f32 v88, s33, v84
    v_mul_f32 v89, s33, v85
    v_exp_f32 v86, v86
    v_exp_f32 v87, v87
    v_exp_f32 v88, v88
    v_exp_f32 v89, v89
    v_add_f32 v86, 1.0, v86
    v_add_f32 v87, 1.0, v87
    v_add_f32 v88, 1.0, v88
    v_add_f32 v89, 1.0, v89
    v_rcp_f32 v86, v86
    v_rcp_f32 v87, v87
    v_rcp_f32 v88, v88
    v_rcp_f32 v89, v89
    v_mul_f32 v86, v82, v86
    v_mul_f32 v87, v83, v87
    v_mul_f32 v88, v84, v88
    v_mul_f32 v89, v85, v89
    v_cvt_pk_bf16_f32 v90, v86, v87
    v_cvt_pk_bf16_f32 v91, v88, v89
    buffer_store_dwordx2 v[90:91], v2, s[16:19], s31 offen offset:16
    v_cvt_pk_bf16_f32 v80, v72, v73
    v_cvt_pk_bf16_f32 v81, v74, v75
    v_lshlrev_b32 v82, 16, v80
    v_and_b32 v83, s34, v80
    v_lshlrev_b32 v84, 16, v81
    v_and_b32 v85, s34, v81
    v_mul_f32 v86, s33, v82
    v_mul_f32 v87, s33, v83
    v_mul_f32 v88, s33, v84
    v_mul_f32 v89, s33, v85
    v_exp_f32 v86, v86
    v_exp_f32 v87, v87
    v_exp_f32 v88, v88
    v_exp_f32 v89, v89
    v_add_f32 v86, 1.0, v86
    v_add_f32 v87, 1.0, v87
    v_add_f32 v88, 1.0, v88
    v_add_f32 v89, 1.0, v89
    v_rcp_f32 v86, v86
    v_rcp_f32 v87, v87
    v_rcp_f32 v88, v88
    v_rcp_f32 v89, v89
    v_mul_f32 v86, v82, v86
    v_mul_f32 v87, v83, v87
    v_mul_f32 v88, v84, v88
    v_mul_f32 v89, v85, v89
    v_cvt_pk_bf16_f32 v90, v86, v87
    v_cvt_pk_bf16_f32 v91, v88, v89
    buffer_store_dwordx2 v[90:91], v2, s[16:19], s31 offen offset:32
    v_cvt_pk_bf16_f32 v80, v76, v77
    v_cvt_pk_bf16_f32 v81, v78, v79
    v_lshlrev_b32 v82, 16, v80
    v_and_b32 v83, s34, v80
    v_lshlrev_b32 v84, 16, v81
    v_and_b32 v85, s34, v81
    v_mul_f32 v86, s33, v82
    v_mul_f32 v87, s33, v83
    v_mul_f32 v88, s33, v84
    v_mul_f32 v89, s33, v85
    v_exp_f32 v86, v86
    v_exp_f32 v87, v87
    v_exp_f32 v88, v88
    v_exp_f32 v89, v89
    v_add_f32 v86, 1.0, v86
    v_add_f32 v87, 1.0, v87
    v_add_f32 v88, 1.0, v88
    v_add_f32 v89, 1.0, v89
    v_rcp_f32 v86, v86
    v_rcp_f32 v87, v87
    v_rcp_f32 v88, v88
    v_rcp_f32 v89, v89
    v_mul_f32 v86, v82, v86
    v_mul_f32 v87, v83, v87
    v_mul_f32 v88, v84, v88
    v_mul_f32 v89, v85, v89
    v_cvt_pk_bf16_f32 v90, v86, v87
    v_cvt_pk_bf16_f32 v91, v88, v89
    buffer_store_dwordx2 v[90:91], v2, s[16:19], s31 offen offset:48
    s_waitcnt vmcnt(0)
g2_end:
    s_endpgm

.globl k2_kernel
.p2align 8
.type k2_kernel,@function
k2_kernel:
    s_cmp_ge_u32 s2, 257
    s_cbranch_scc1 k2_end
    s_load_dwordx2 s[6:7], s[0:1], 72
    v_lshrrev_b32 v2, 6, v0
    s_nop 0
    v_readfirstlane_b32 s22, v2
    s_getpc_b64 s[24:25]
    s_add_u32 s24, s24, twtab@rel32@lo+4
    s_addc_u32 s25, s25, twtab@rel32@hi+12
    s_mov_b32 s26, 16384
    s_mov_b32 s27, 0x00020000
    s_waitcnt lgkmcnt(0)
    s_mov_b32 s16, s6
    s_mov_b32 s17, s7
    s_mov_b32 s18, 268435456
    s_mov_b32 s19, 0x00020000
    s_sub_u32 s20, 512, s2
    s_and_b32 s21, s20, 511
    s_lshr_b32 s23, s22, 1
    s_cmp_eq_u32 s23, 0
    s_cselect_b32 s28, s2, s21
    s_lshl_b32 s28, s28, 14
    s_add_u32 s28, s28, 33554432
    v_and_b32 v3, 127, v0
    v_lshlrev_b32 v4, 3, v3
    buffer_load_dwordx2 v[152:153], v4, s[16:19], s28 offen offset:0
    buffer_load_dwordx2 v[154:155], v4, s[16:19], s28 offen offset:1024
    buffer_load_dwordx2 v[156:157], v4, s[16:19], s28 offen offset:2048
    buffer_load_dwordx2 v[158:159], v4, s[16:19], s28 offen offset:3072
    s_add_u32 s28, s28, 4096
    buffer_load_dwordx2 v[160:161], v4, s[16:19], s28 offen offset:0
    buffer_load_dwordx2 v[162:163], v4, s[16:19], s28 offen offset:1024
    buffer_load_dwordx2 v[164:165], v4, s[16:19], s28 offen offset:2048
    buffer_load_dwordx2 v[166:167], v4, s[16:19], s28 offen offset:3072
    s_add_u32 s28, s28, 4096
    buffer_load_dwordx2 v[168:169], v4, s[16:19], s28 offen offset:0
    buffer_load_dwordx2 v[170:171], v4, s[16:19], s28 offen offset:1024
    buffer_load_dwordx2 v[172:173], v4, s[16:19], s28 offen offset:2048
    buffer_load_dwordx2 v[174:175], v4, s[16:19], s28 offen offset:3072
    s_add_u32 s28, s28, 4096
    buffer_load_dwordx2 v[176:177], v4, s[16:19], s28 offen offset:0
    buffer_load_dwordx2 v[178:179], v4, s[16:19], s28 offen offset:1024
    buffer_load_dwordx2 v[180:181], v4, s[16:19], s28 offen offset:2048
    buffer_load_dwordx2 v[182:183], v4, s[16:19], s28 offen offset:3072
    v_mul_u32_u24 v5, 1, v3
    v_and_b32 v5, 2047, v5
    v_lshlrev_b32 v5, 3, v5
    buffer_load_dwordx2 v[16:17], v5, s[24:27], 0 offen
    v_mul_u32_u24 v5, 2, v3
    v_and_b32 v5, 2047, v5
    v_lshlrev_b32 v5, 3, v5
    buffer_load_dwordx2 v[18:19], v5, s[24:27], 0 offen
    v_mul_u32_u24 v5, 3, v3
    v_and_b32 v5, 2047, v5
    v_lshlrev_b32 v5, 3, v5
    buffer_load_dwordx2 v[20:21], v5, s[24:27], 0 offen
    v_mul_u32_u24 v5, 4, v3
    v_and_b32 v5, 2047, v5
    v_lshlrev_b32 v5, 3, v5
    buffer_load_dwordx2 v[22:23], v5, s[24:27], 0 offen
    v_mul_u32_u24 v5, 5, v3
    v_and_b32 v5, 2047, v5
    v_lshlrev_b32 v5, 3, v5
    buffer_load_dwordx2 v[24:25], v5, s[24:27], 0 offen
    v_mul_u32_u24 v5, 6, v3
    v_and_b32 v5, 2047, v5
    v_lshlrev_b32 v5, 3, v5
    buffer_load_dwordx2 v[26:27], v5, s[24:27], 0 offen
    v_mul_u32_u24 v5, 7, v3
    v_and_b32 v5, 2047, v5
    v_lshlrev_b32 v5, 3, v5
    buffer_load_dwordx2 v[28:29], v5, s[24:27], 0 offen
    v_mul_u32_u24 v5, 8, v3
    v_and_b32 v5, 2047, v5
    v_lshlrev_b32 v5, 3, v5
    buffer_load_dwordx2 v[30:31], v5, s[24:27], 0 offen
    v_mul_u32_u24 v5, 9, v3
    v_and_b32 v5, 2047, v5
    v_lshlrev_b32 v5, 3, v5
    buffer_load_dwordx2 v[32:33], v5, s[24:27], 0 offen
    v_mul_u32_u24 v5, 10, v3
    v_and_b32 v5, 2047, v5
    v_lshlrev_b32 v5, 3, v5
    buffer_load_dwordx2 v[34:35], v5, s[24:27], 0 offen
    v_mul_u32_u24 v5, 11, v3
    v_and_b32 v5, 2047, v5
    v_lshlrev_b32 v5, 3, v5
    buffer_load_dwordx2 v[36:37], v5, s[24:27], 0 offen
    v_mul_u32_u24 v5, 12, v3
    v_and_b32 v5, 2047, v5
    v_lshlrev_b32 v5, 3, v5
    buffer_load_dwordx2 v[38:39], v5, s[24:27], 0 offen
    v_mul_u32_u24 v5, 13, v3
    v_and_b32 v5, 2047, v5
    v_lshlrev_b32 v5, 3, v5
    buffer_load_dwordx2 v[40:41], v5, s[24:27], 0 offen
    v_mul_u32_u24 v5, 14, v3
    v_and_b32 v5, 2047, v5
    v_lshlrev_b32 v5, 3, v5
    buffer_load_dwordx2 v[42:43], v5, s[24:27], 0 offen
    v_mul_u32_u24 v5, 15, v3
    v_and_b32 v5, 2047, v5
    v_lshlrev_b32 v5, 3, v5
    buffer_load_dwordx2 v[44:45], v5, s[24:27], 0 offen
    v_and_b32 v6, 7, v0
    v_mul_u32_u24 v5, 16, v6
    v_and_b32 v5, 2047, v5
    v_lshlrev_b32 v5, 3, v5
    buffer_load_dwordx2 v[46:47], v5, s[24:27], 0 offen
    v_mul_u32_u24 v5, 32, v6
    v_and_b32 v5, 2047, v5
    v_lshlrev_b32 v5, 3, v5
    buffer_load_dwordx2 v[48:49], v5, s[24:27], 0 offen
    v_mul_u32_u24 v5, 48, v6
    v_and_b32 v5, 2047, v5
    v_lshlrev_b32 v5, 3, v5
    buffer_load_dwordx2 v[50:51], v5, s[24:27], 0 offen
    v_mul_u32_u24 v5, 64, v6
    v_and_b32 v5, 2047, v5
    v_lshlrev_b32 v5, 3, v5
    buffer_load_dwordx2 v[52:53], v5, s[24:27], 0 offen
    v_mul_u32_u24 v5, 80, v6
    v_and_b32 v5, 2047, v5
    v_lshlrev_b32 v5, 3, v5
    buffer_load_dwordx2 v[54:55], v5, s[24:27], 0 offen
    v_mul_u32_u24 v5, 96, v6
    v_and_b32 v5, 2047, v5
    v_lshlrev_b32 v5, 3, v5
    buffer_load_dwordx2 v[56:57], v5, s[24:27], 0 offen
    v_mul_u32_u24 v5, 112, v6
    v_and_b32 v5, 2047, v5
    v_lshlrev_b32 v5, 3, v5
    buffer_load_dwordx2 v[58:59], v5, s[24:27], 0 offen
    v_mul_u32_u24 v5, 128, v6
    v_and_b32 v5, 2047, v5
    v_lshlrev_b32 v5, 3, v5
    buffer_load_dwordx2 v[60:61], v5, s[24:27], 0 offen
    v_mul_u32_u24 v5, 144, v6
    v_and_b32 v5, 2047, v5
    v_lshlrev_b32 v5, 3, v5
    buffer_load_dwordx2 v[62:63], v5, s[24:27], 0 offen
    v_mul_u32_u24 v5, 160, v6
    v_and_b32 v5, 2047, v5
    v_lshlrev_b32 v5, 3, v5
    buffer_load_dwordx2 v[64:65], v5, s[24:27], 0 offen
    v_mul_u32_u24 v5, 176, v6
    v_and_b32 v5, 2047, v5
    v_lshlrev_b32 v5, 3, v5
    buffer_load_dwordx2 v[66:67], v5, s[24:27], 0 offen
    v_mul_u32_u24 v5, 192, v6
    v_and_b32 v5, 2047, v5
    v_lshlrev_b32 v5, 3, v5
    buffer_load_dwordx2 v[68:69], v5, s[24:27], 0 offen
    v_mul_u32_u24 v5, 208, v6
    v_and_b32 v5, 2047, v5
    v_lshlrev_b32 v5, 3, v5
    buffer_load_dwordx2 v[70:71], v5, s[24:27], 0 offen
    v_mul_u32_u24 v5, 224, v6
    v_and_b32 v5, 2047, v5
    v_lshlrev_b32 v5, 3, v5
    buffer_load_dwordx2 v[72:73], v5, s[24:27], 0 offen
    v_mul_u32_u24 v5, 240, v6
    v_and_b32 v5, 2047, v5
    v_lshlrev_b32 v5, 3, v5
    buffer_load_dwordx2 v[74:75], v5, s[24:27], 0 offen
    v_mul_u32_u24 v5, 1, v0
    v_and_b32 v5, 2047, v5
    v_lshlrev_b32 v5, 3, v5
    buffer_load_dwordx2 v[76:77], v5, s[24:27], 0 offen
    v_mul_u32_u24 v5, 2, v0
    v_and_b32 v5, 2047, v5
    v_lshlrev_b32 v5, 3, v5
    buffer_load_dwordx2 v[78:79], v5, s[24:27], 0 offen
    v_mul_u32_u24 v5, 3, v0
    v_and_b32 v5, 2047, v5
    v_lshlrev_b32 v5, 3, v5
    buffer_load_dwordx2 v[80:81], v5, s[24:27], 0 offen
    v_mul_u32_u24 v5, 4, v0
    v_and_b32 v5, 2047, v5
    v_lshlrev_b32 v5, 3, v5
    buffer_load_dwordx2 v[82:83], v5, s[24:27], 0 offen
    v_mul_u32_u24 v5, 5, v0
    v_and_b32 v5, 2047, v5
    v_lshlrev_b32 v5, 3, v5
    buffer_load_dwordx2 v[84:85], v5, s[24:27], 0 offen
    v_mul_u32_u24 v5, 6, v0
    v_and_b32 v5, 2047, v5
    v_lshlrev_b32 v5, 3, v5
    buffer_load_dwordx2 v[86:87], v5, s[24:27], 0 offen
    v_mul_u32_u24 v5, 7, v0
    v_and_b32 v5, 2047, v5
    v_lshlrev_b32 v5, 3, v5
    buffer_load_dwordx2 v[88:89], v5, s[24:27], 0 offen
    v_and_b32 v7, 15, v0
    v_mul_u32_u24 v5, 8, v7
    v_and_b32 v5, 2047, v5
    v_lshlrev_b32 v5, 3, v5
    buffer_load_dwordx2 v[90:91], v5, s[24:27], 0 offen
    v_mul_u32_u24 v5, 16, v7
    v_and_b32 v5, 2047, v5
    v_lshlrev_b32 v5, 3, v5
    buffer_load_dwordx2 v[92:93], v5, s[24:27], 0 offen
    v_mul_u32_u24 v5, 24, v7
    v_and_b32 v5, 2047, v5
    v_lshlrev_b32 v5, 3, v5
    buffer_load_dwordx2 v[94:95], v5, s[24:27], 0 offen
    v_mul_u32_u24 v5, 32, v7
    v_and_b32 v5, 2047, v5
    v_lshlrev_b32 v5, 3, v5
    buffer_load_dwordx2 v[96:97], v5, s[24:27], 0 offen
    v_mul_u32_u24 v5, 40, v7
    v_and_b32 v5, 2047, v5
    v_lshlrev_b32 v5, 3, v5
    buffer_load_dwordx2 v[98:99], v5, s[24:27], 0 offen
    v_mul_u32_u24 v5, 48, v7
    v_and_b32 v5, 2047, v5
    v_lshlrev_b32 v5, 3, v5
    buffer_load_dwordx2 v[100:101], v5, s[24:27], 0 offen
    v_mul_u32_u24 v5, 56, v7
    v_and_b32 v5, 2047, v5
    v_lshlrev_b32 v5, 3, v5
    buffer_load_dwordx2 v[102:103], v5, s[24:27], 0 offen
    v_mul_u32_u24 v5, 64, v7
    v_and_b32 v5, 2047, v5
    v_lshlrev_b32 v5, 3, v5
    buffer_load_dwordx2 v[104:105], v5, s[24:27], 0 offen
    v_mul_u32_u24 v5, 72, v7
    v_and_b32 v5, 2047, v5
    v_lshlrev_b32 v5, 3, v5
    buffer_load_dwordx2 v[106:107], v5, s[24:27], 0 offen
    v_mul_u32_u24 v5, 80, v7
    v_and_b32 v5, 2047, v5
    v_lshlrev_b32 v5, 3, v5
    buffer_load_dwordx2 v[108:109], v5, s[24:27], 0 offen
    v_mul_u32_u24 v5, 88, v7
    v_and_b32 v5, 2047, v5
    v_lshlrev_b32 v5, 3, v5
    buffer_load_dwordx2 v[110:111], v5, s[24:27], 0 offen
    v_mul_u32_u24 v5, 96, v7
    v_and_b32 v5, 2047, v5
    v_lshlrev_b32 v5, 3, v5
    buffer_load_dwordx2 v[112:113], v5, s[24:27], 0 offen
    v_mul_u32_u24 v5, 104, v7
    v_and_b32 v5, 2047, v5
    v_lshlrev_b32 v5, 3, v5
    buffer_load_dwordx2 v[114:115], v5, s[24:27], 0 offen
    v_mul_u32_u24 v5, 112, v7
    v_and_b32 v5, 2047, v5
    v_lshlrev_b32 v5, 3, v5
    buffer_load_dwordx2 v[116:117], v5, s[24:27], 0 offen
    v_mul_u32_u24 v5, 120, v7
    v_and_b32 v5, 2047, v5
    v_lshlrev_b32 v5, 3, v5
    buffer_load_dwordx2 v[118:119], v5, s[24:27], 0 offen
    v_lshlrev_b32 v8, 2, v0
    s_lshl_b32 s29, s2, 13
    s_add_u32 s29, s29, 50331648
    s_lshl_b32 s30, s20, 13
    s_add_u32 s30, s30, 50331648
    buffer_load_dword v120, v8, s[16:19], s29 offen offset:0
    buffer_load_dword v121, v8, s[16:19], s29 offen offset:1024
    buffer_load_dword v122, v8, s[16:19], s29 offen offset:2048
    buffer_load_dword v123, v8, s[16:19], s29 offen offset:3072
    s_add_u32 s29, s29, 4096
    buffer_load_dword v124, v8, s[16:19], s29 offen offset:0
    buffer_load_dword v125, v8, s[16:19], s29 offen offset:1024
    buffer_load_dword v126, v8, s[16:19], s29 offen offset:2048
    buffer_load_dword v127, v8, s[16:19], s29 offen offset:3072
    v_sub_u32 v9, 2048, v0
    v_and_b32 v9, 2047, v9
    v_lshlrev_b32 v9, 2, v9
    buffer_load_dword v128, v9, s[16:19], s30 offen
    v_sub_u32 v9, 1792, v0
    v_and_b32 v9, 2047, v9
    v_lshlrev_b32 v9, 2, v9
    buffer_load_dword v129, v9, s[16:19], s30 offen
    v_sub_u32 v9, 1536, v0
    v_and_b32 v9, 2047, v9
    v_lshlrev_b32 v9, 2, v9
    buffer_load_dword v130, v9, s[16:19], s30 offen
    v_sub_u32 v9, 1280, v0
    v_and_b32 v9, 2047, v9
    v_lshlrev_b32 v9, 2, v9
    buffer_load_dword v131, v9, s[16:19], s30 offen
    v_sub_u32 v9, 1024, v0
    v_and_b32 v9, 2047, v9
    v_lshlrev_b32 v9, 2, v9
    buffer_load_dword v132, v9, s[16:19], s30 offen
    v_sub_u32 v9, 768, v0
    v_and_b32 v9, 2047, v9
    v_lshlrev_b32 v9, 2, v9
    buffer_load_dword v133, v9, s[16:19], s30 offen
    v_sub_u32 v9, 512, v0
    v_and_b32 v9, 2047, v9
    v_lshlrev_b32 v9, 2, v9
    buffer_load_dword v134, v9, s[16:19], s30 offen
    v_sub_u32 v9, 256, v0
    v_and_b32 v9, 2047, v9
    v_lshlrev_b32 v9, 2, v9
    buffer_load_dword v135, v9, s[16:19], s30 offen
    s_lshl_b32 s31, s2, 4
    v_mov_b32 v9, s31
    buffer_load_dwordx2 v[10:11], v9, s[24:27], 0 offen
    s_cmp_eq_u32 s23, 0
    s_cselect_b32 s31, 1.0, -1.0
    v_mov_b32 v12, s31
    s_mul_i32 s32, s23, 17408
    s_waitcnt vmcnt(63)
    v_mul_f32 v153, v12, v153
    v_mul_f32 v155, v12, v155
    v_mul_f32 v157, v12, v157
    v_mul_f32 v159, v12, v159
    v_mul_f32 v161, v12, v161
    v_mul_f32 v163, v12, v163
    v_mul_f32 v165, v12, v165
    v_mul_f32 v167, v12, v167
    v_mul_f32 v169, v12, v169
    v_mul_f32 v171, v12, v171
    v_mul_f32 v173, v12, v173
    v_mul_f32 v175, v12, v175
    v_mul_f32 v177, v12, v177
    v_mul_f32 v179, v12, v179
    v_mul_f32 v181, v12, v181
    v_mul_f32 v183, v12, v183
    v_pk_add_f32 v[184:185], v[152:153], v[168:169]
    v_pk_add_f32 v[168:169], v[152:153], v[168:169] neg_lo:[0,1] neg_hi:[0,1]
    v_pk_add_f32 v[186:187], v[154:155], v[170:171]
    v_pk_add_f32 v[170:171], v[154:155], v[170:171] neg_lo:[0,1] neg_hi:[0,1]
    v_mul_f32 v188, 0x3f6c835e, v170
    v_mul_f32 v189, 0xbec3ef15, v170
    v_fmac_f32 v188, 0x3ec3ef15, v171
    v_fmac_f32 v189, 0x3f6c835e, v171
    v_pk_add_f32 v[190:191], v[156:157], v[172:173]
    v_pk_add_f32 v[172:173], v[156:157], v[172:173] neg_lo:[0,1] neg_hi:[0,1]
    v_add_f32 v192, v172, v173
    v_sub_f32 v193, v173, v172
    v_mul_f32 v192, 0x3f3504f3, v192
    v_mul_f32 v193, 0x3f3504f3, v193
    v_pk_add_f32 v[194:195], v[158:159], v[174:175]
    v_pk_add_f32 v[174:175], v[158:159], v[174:175] neg_lo:[0,1] neg_hi:[0,1]
    v_mul_f32 v196, 0x3ec3ef15, v174
    v_mul_f32 v197, 0xbf6c835e, v174
    v_fmac_f32 v196, 0x3f6c835e, v175
    v_fmac_f32 v197, 0x3ec3ef15, v175
    v_pk_add_f32 v[198:199], v[160:161], v[176:177]
    v_sub_f32 v200, v161, v177
    v_sub_f32 v201, v176, v160
    v_pk_add_f32 v[202:203], v[162:163], v[178:179]
    v_pk_add_f32 v[178:179], v[162:163], v[178:179] neg_lo:[0,1] neg_hi:[0,1]
    v_mul_f32 v204, 0xbec3ef15, v178
    v_mul_f32 v205, 0xbf6c835e, v178
    v_fmac_f32 v204, 0x3f6c835e, v179
    v_fmac_f32 v205, 0xbec3ef15, v179
    v_pk_add_f32 v[206:207], v[164:165], v[180:181]
    v_pk_add_f32 v[180:181], v[164:165], v[180:181] neg_lo:[0,1] neg_hi:[0,1]
    v_sub_f32 v208, v181, v180
    v_add_f32 v209, v180, v181
    v_mul_f32 v208, 0x3f3504f3, v208
    v_mul_f32 v209, 0xbf3504f3, v209
    v_pk_add_f32 v[210:211], v[166:167], v[182:183]
    v_pk_add_f32 v[182:183], v[166:167], v[182:183] neg_lo:[0,1] neg_hi:[0,1]
    v_mul_f32 v212, 0xbf6c835e, v182
    v_mul_f32 v213, 0xbec3ef15, v182
    v_fmac_f32 v212, 0x3ec3ef15, v183
    v_fmac_f32 v213, 0xbf6c835e, v183
    v_pk_add_f32 v[214:215], v[184:185], v[198:199]
    v_pk_add_f32 v[198:199], v[184:185], v[198:199] neg_lo:[0,1] neg_hi:[0,1]
    v_pk_add_f32 v[216:217], v[186:187], v[202:203]
    v_pk_add_f32 v[202:203], v[186:187], v[202:203] neg_lo:[0,1] neg_hi:[0,1]
    v_add_f32 v218, v202, v203
    v_sub_f32 v219, v203, v202
    v_mul_f32 v218, 0x3f3504f3, v218
    v_mul_f32 v219, 0x3f3504f3, v219
    v_pk_add_f32 v[220:221], v[190:191], v[206:207]
    v_sub_f32 v222, v191, v207
    v_sub_f32 v223, v206, v190
    v_pk_add_f32 v[224:225], v[194:195], v[210:211]
    v_pk_add_f32 v[210:211], v[194:195], v[210:211] neg_lo:[0,1] neg_hi:[0,1]
    v_sub_f32 v226, v211, v210
    v_add_f32 v227, v210, v211
    v_mul_f32 v226, 0x3f3504f3, v226
    v_mul_f32 v227, 0xbf3504f3, v227
    v_pk_add_f32 v[228:229], v[214:215], v[220:221]
    v_pk_add_f32 v[220:221], v[214:215], v[220:221] neg_lo:[0,1] neg_hi:[0,1]
    v_pk_add_f32 v[230:231], v[216:217], v[224:225]
    v_sub_f32 v232, v217, v225
    v_sub_f32 v233, v224, v216
    v_pk_add_f32 v[234:235], v[228:229], v[230:231]
    v_pk_add_f32 v[230:231], v[228:229], v[230:231] neg_lo:[0,1] neg_hi:[0,1]
    v_pk_add_f32 v[236:237], v[220:221], v[232:233]
    v_pk_add_f32 v[232:233], v[220:221], v[232:233] neg_lo:[0,1] neg_hi:[0,1]
    v_pk_add_f32 v[238:239], v[198:199], v[222:223]
    v_pk_add_f32 v[222:223], v[198:199], v[222:223] neg_lo:[0,1] neg_hi:[0,1]
    v_pk_add_f32 v[240:241], v[218:219], v[226:227]
    v_sub_f32 v242, v219, v227
    v_sub_f32 v243, v226, v218
    v_pk_add_f32 v[244:245], v[238:239], v[240:241]
    v_pk_add_f32 v[240:241], v[238:239], v[240:241] neg_lo:[0,1] neg_hi:[0,1]
    v_pk_add_f32 v[246:247], v[222:223], v[242:243]
    v_pk_add_f32 v[242:243], v[222:223], v[242:243] neg_lo:[0,1] neg_hi:[0,1]
    v_pk_add_f32 v[248:249], v[168:169], v[200:201]
    v_pk_add_f32 v[200:201], v[168:169], v[200:201] neg_lo:[0,1] neg_hi:[0,1]
    v_pk_add_f32 v[250:251], v[188:189], v[204:205]
    v_pk_add_f32 v[204:205], v[188:189], v[204:205] neg_lo:[0,1] neg_hi:[0,1]
    v_add_f32 v152, v204, v205
    v_sub_f32 v153, v205, v204
    v_mul_f32 v152, 0x3f3504f3, v152
    v_mul_f32 v153, 0x3f3504f3, v153
    v_pk_add_f32 v[154:155], v[192:193], v[208:209]
    v_sub_f32 v170, v193, v209
    v_sub_f32 v171, v208, v192
    v_pk_add_f32 v[156:157], v[196:197], v[212:213]
    v_pk_add_f32 v[212:213], v[196:197], v[212:213] neg_lo:[0,1] neg_hi:[0,1]
    v_sub_f32 v172, v213, v212
    v_add_f32 v173, v212, v213
    v_mul_f32 v172, 0x3f3504f3, v172
    v_mul_f32 v173, 0xbf3504f3, v173
    v_pk_add_f32 v[158:159], v[248:249], v[154:155]
    v_pk_add_f32 v[154:155], v[248:249], v[154:155] neg_lo:[0,1] neg_hi:[0,1]
    v_pk_add_f32 v[174:175], v[250:251], v[156:157]
    v_sub_f32 v160, v251, v157
    v_sub_f32 v161, v156, v250
    v_pk_add_f32 v[176:177], v[158:159], v[174:175]
    v_pk_add_f32 v[174:175], v[158:159], v[174:175] neg_lo:[0,1] neg_hi:[0,1]
    v_pk_add_f32 v[162:163], v[154:155], v[160:161]
    v_pk_add_f32 v[160:161], v[154:155], v[160:161] neg_lo:[0,1] neg_hi:[0,1]
    v_pk_add_f32 v[178:179], v[200:201], v[170:171]
    v_pk_add_f32 v[170:171], v[200:201], v[170:171] neg_lo:[0,1] neg_hi:[0,1]
    v_pk_add_f32 v[164:165], v[152:153], v[172:173]
    v_sub_f32 v180, v153, v173
    v_sub_f32 v181, v172, v152
    v_pk_add_f32 v[166:167], v[178:179], v[164:165]
    v_pk_add_f32 v[164:165], v[178:179], v[164:165] neg_lo:[0,1] neg_hi:[0,1]
    v_pk_add_f32 v[182:183], v[170:171], v[180:181]
    v_pk_add_f32 v[180:181], v[170:171], v[180:181] neg_lo:[0,1] neg_hi:[0,1]
    s_waitcnt vmcnt(54)
    v_pk_mul_f32 v[184:185], v[176:177], v[16:17] op_sel:[0,0] op_sel_hi:[1,0]
    v_pk_fma_f32 v[184:185], v[176:177], v[16:17], v[184:185] op_sel:[1,1,0] op_sel_hi:[0,1,1] neg_lo:[1,0,0]
    v_pk_mul_f32 v[186:187], v[244:245], v[18:19] op_sel:[0,0] op_sel_hi:[1,0]
    v_pk_fma_f32 v[186:187], v[244:245], v[18:19], v[186:187] op_sel:[1,1,0] op_sel_hi:[0,1,1] neg_lo:[1,0,0]
    v_pk_mul_f32 v[202:203], v[166:167], v[20:21] op_sel:[0,0] op_sel_hi:[1,0]
    v_pk_fma_f32 v[202:203], v[166:167], v[20:21], v[202:203] op_sel:[1,1,0] op_sel_hi:[0,1,1] neg_lo:[1,0,0]
    v_pk_mul_f32 v[190:191], v[236:237], v[22:23] op_sel:[0,0] op_sel_hi:[1,0]
    v_pk_fma_f32 v[190:191], v[236:237], v[22:23], v[190:191] op_sel:[1,1,0] op_sel_hi:[0,1,1] neg_lo:[1,0,0]
    v_pk_mul_f32 v[206:207], v[162:163], v[24:25] op_sel:[0,0] op_sel_hi:[1,0]
    v_pk_fma_f32 v[206:207], v[162:163], v[24:25], v[206:207] op_sel:[1,1,0] op_sel_hi:[0,1,1] neg_lo:[1,0,0]
    v_pk_mul_f32 v[194:195], v[246:247], v[26:27] op_sel:[0,0] op_sel_hi:[1,0]
    v_pk_fma_f32 v[194:195], v[246:247], v[26:27], v[194:195] op_sel:[1,1,0] op_sel_hi:[0,1,1] neg_lo:[1,0,0]
    v_pk_mul_f32 v[210:211], v[182:183], v[28:29] op_sel:[0,0] op_sel_hi:[1,0]
    v_pk_fma_f32 v[210:211], v[182:183], v[28:29], v[210:211] op_sel:[1,1,0] op_sel_hi:[0,1,1] neg_lo:[1,0,0]
    v_pk_mul_f32 v[214:215], v[230:231], v[30:31] op_sel:[0,0] op_sel_hi:[1,0]
    v_pk_fma_f32 v[214:215], v[230:231], v[30:31], v[214:215] op_sel:[1,1,0] op_sel_hi:[0,1,1] neg_lo:[1,0,0]
    v_pk_mul_f32 v[216:217], v[174:175], v[32:33] op_sel:[0,0] op_sel_hi:[1,0]
    v_pk_fma_f32 v[216:217], v[174:175], v[32:33], v[216:217] op_sel:[1,1,0] op_sel_hi:[0,1,1] neg_lo:[1,0,0]
    v_pk_mul_f32 v[224:225], v[240:241], v[34:35] op_sel:[0,0] op_sel_hi:[1,0]
    v_pk_fma_f32 v[224:225], v[240:241], v[34:35], v[224:225] op_sel:[1,1,0] op_sel_hi:[0,1,1] neg_lo:[1,0,0]
    v_pk_mul_f32 v[228:229], v[164:165], v[36:37] op_sel:[0,0] op_sel_hi:[1,0]
    v_pk_fma_f32 v[228:229], v[164:165], v[36:37], v[228:229] op_sel:[1,1,0] op_sel_hi:[0,1,1] neg_lo:[1,0,0]
    v_pk_mul_f32 v[220:221], v[232:233], v[38:39] op_sel:[0,0] op_sel_hi:[1,0]
    v_pk_fma_f32 v[220:221], v[232:233], v[38:39], v[220:221] op_sel:[1,1,0] op_sel_hi:[0,1,1] neg_lo:[1,0,0]
    v_pk_mul_f32 v[198:199], v[160:161], v[40:41] op_sel:[0,0] op_sel_hi:[1,0]
    v_pk_fma_f32 v[198:199], v[160:161], v[40:41], v[198:199] op_sel:[1,1,0] op_sel_hi:[0,1,1] neg_lo:[1,0,0]
    v_pk_mul_f32 v[218:219], v[242:243], v[42:43] op_sel:[0,0] op_sel_hi:[1,0]
    v_pk_fma_f32 v[218:219], v[242:243], v[42:43], v[218:219] op_sel:[1,1,0] op_sel_hi:[0,1,1] neg_lo:[1,0,0]
    v_pk_mul_f32 v[226:227], v[180:181], v[44:45] op_sel:[0,0] op_sel_hi:[1,0]
    v_pk_fma_f32 v[226:227], v[180:181], v[44:45], v[226:227] op_sel:[1,1,0] op_sel_hi:[0,1,1] neg_lo:[1,0,0]
    v_add_u32 v13, s32, v4
    ds_write_b64 v13, v[234:235] offset:0
    ds_write_b64 v13, v[184:185] offset:1088
    ds_write_b64 v13, v[186:187] offset:2176
    ds_write_b64 v13, v[202:203] offset:3264
    ds_write_b64 v13, v[190:191] offset:4352
    ds_write_b64 v13, v[206:207] offset:5440
    ds_write_b64 v13, v[194:195] offset:6528
    ds_write_b64 v13, v[210:211] offset:7616
    ds_write_b64 v13, v[214:215] offset:8704
    ds_write_b64 v13, v[216:217] offset:9792
    ds_write_b64 v13, v[224:225] offset:10880
    ds_write_b64 v13, v[228:229] offset:11968
    ds_write_b64 v13, v[220:221] offset:13056
    ds_write_b64 v13, v[198:199] offset:14144
    ds_write_b64 v13, v[218:219] offset:15232
    ds_write_b64 v13, v[226:227] offset:16320
    v_lshrrev_b32 v14, 3, v3
    v_mul_u32_u24 v14, 136, v14
    v_add_u32 v14, v14, v6
    v_lshlrev_b32 v14, 3, v14
    v_add_u32 v14, s32, v14
    s_waitcnt lgkmcnt(0)
    s_barrier
    ds_read_b64 v[238:239], v14 offset:0
    ds_read_b64 v[222:223], v14 offset:64
    ds_read_b64 v[168:169], v14 offset:128
    ds_read_b64 v[188:189], v14 offset:192
    ds_read_b64 v[204:205], v14 offset:256
    ds_read_b64 v[192:193], v14 offset:320
    ds_read_b64 v[208:209], v14 offset:384
    ds_read_b64 v[196:197], v14 offset:448
    ds_read_b64 v[212:213], v14 offset:512
    ds_read_b64 v[248:249], v14 offset:576
    ds_read_b64 v[250:251], v14 offset:640
    ds_read_b64 v[156:157], v14 offset:704
    ds_read_b64 v[158:159], v14 offset:768
    ds_read_b64 v[154:155], v14 offset:832
    ds_read_b64 v[200:201], v14 offset:896
    ds_read_b64 v[152:153], v14 offset:960
    s_waitcnt lgkmcnt(0)
    v_pk_add_f32 v[172:173], v[238:239], v[212:213]
    v_pk_add_f32 v[212:213], v[238:239], v[212:213] neg_lo:[0,1] neg_hi:[0,1]
    v_pk_add_f32 v[178:179], v[222:223], v[248:249]
    v_pk_add_f32 v[248:249], v[222:223], v[248:249] neg_lo:[0,1] neg_hi:[0,1]
    v_mul_f32 v170, 0x3f6c835e, v248
    v_mul_f32 v171, 0xbec3ef15, v248
    v_fmac_f32 v170, 0x3ec3ef15, v249
    v_fmac_f32 v171, 0x3f6c835e, v249
    v_pk_add_f32 v[176:177], v[168:169], v[250:251]
    v_pk_add_f32 v[250:251], v[168:169], v[250:251] neg_lo:[0,1] neg_hi:[0,1]
    v_add_f32 v244, v250, v251
    v_sub_f32 v245, v251, v250
    v_mul_f32 v244, 0x3f3504f3, v244
    v_mul_f32 v245, 0x3f3504f3, v245
    v_pk_add_f32 v[166:167], v[188:189], v[156:157]
    v_pk_add_f32 v[156:157], v[188:189], v[156:157] neg_lo:[0,1] neg_hi:[0,1]
    v_mul_f32 v236, 0x3ec3ef15, v156
    v_mul_f32 v237, 0xbf6c835e, v156
    v_fmac_f32 v236, 0x3f6c835e, v157
    v_fmac_f32 v237, 0x3ec3ef15, v157
    v_pk_add_f32 v[162:163], v[204:205], v[158:159]
    v_sub_f32 v246, v205, v159
    v_sub_f32 v247, v158, v204
    v_pk_add_f32 v[182:183], v[192:193], v[154:155]
    v_pk_add_f32 v[154:155], v[192:193], v[154:155] neg_lo:[0,1] neg_hi:[0,1]
    v_mul_f32 v230, 0xbec3ef15, v154
    v_mul_f32 v231, 0xbf6c835e, v154
    v_fmac_f32 v230, 0x3f6c835e, v155
    v_fmac_f32 v231, 0xbec3ef15, v155
    v_pk_add_f32 v[174:175], v[208:209], v[200:201]
    v_pk_add_f32 v[200:201], v[208:209], v[200:201] neg_lo:[0,1] neg_hi:[0,1]
    v_sub_f32 v240, v201, v200
    v_add_f32 v241, v200, v201
    v_mul_f32 v240, 0x3f3504f3, v240
    v_mul_f32 v241, 0xbf3504f3, v241
    v_pk_add_f32 v[164:165], v[196:197], v[152:153]
    v_pk_add_f32 v[152:153], v[196:197], v[152:153] neg_lo:[0,1] neg_hi:[0,1]
    v_mul_f32 v232, 0xbf6c835e, v152
    v_mul_f32 v233, 0xbec3ef15, v152
    v_fmac_f32 v232, 0x3ec3ef15, v153
    v_fmac_f32 v233, 0xbf6c835e, v153
    v_pk_add_f32 v[160:161], v[172:173], v[162:163]
    v_pk_add_f32 v[162:163], v[172:173], v[162:163] neg_lo:[0,1] neg_hi:[0,1]
    v_pk_add_f32 v[242:243], v[178:179], v[182:183]
    v_pk_add_f32 v[182:183], v[178:179], v[182:183] neg_lo:[0,1] neg_hi:[0,1]
    v_add_f32 v180, v182, v183
    v_sub_f32 v181, v183, v182
    v_mul_f32 v180, 0x3f3504f3, v180
    v_mul_f32 v181, 0x3f3504f3, v181
    v_pk_add_f32 v[234:235], v[176:177], v[174:175]
    v_sub_f32 v184, v177, v175
    v_sub_f32 v185, v174, v176
    v_pk_add_f32 v[186:187], v[166:167], v[164:165]
    v_pk_add_f32 v[164:165], v[166:167], v[164:165] neg_lo:[0,1] neg_hi:[0,1]
    v_sub_f32 v202, v165, v164
    v_add_f32 v203, v164, v165
    v_mul_f32 v202, 0x3f3504f3, v202
    v_mul_f32 v203, 0xbf3504f3, v203
    v_pk_add_f32 v[190:191], v[160:161], v[234:235]
    v_pk_add_f32 v[234:235], v[160:161], v[234:235] neg_lo:[0,1] neg_hi:[0,1]
    v_pk_add_f32 v[206:207], v[242:243], v[186:187]
    v_sub_f32 v194, v243, v187
    v_sub_f32 v195, v186, v242
    v_pk_add_f32 v[210:211], v[190:191], v[206:207]
    v_pk_add_f32 v[206:207], v[190:191], v[206:207] neg_lo:[0,1] neg_hi:[0,1]
    v_pk_add_f32 v[214:215], v[234:235], v[194:195]
    v_pk_add_f32 v[194:195], v[234:235], v[194:195] neg_lo:[0,1] neg_hi:[0,1]
    v_pk_add_f32 v[216:217], v[162:163], v[184:185]
    v_pk_add_f32 v[184:185], v[162:163], v[184:185] neg_lo:[0,1] neg_hi:[0,1]
    v_pk_add_f32 v[224:225], v[180:181], v[202:203]
    v_sub_f32 v228, v181, v203
    v_sub_f32 v229, v202, v180
    v_pk_add_f32 v[220:221], v[216:217], v[224:225]
    v_pk_add_f32 v[224:225], v[216:217], v[224:225] neg_lo:[0,1] neg_hi:[0,1]
    v_pk_add_f32 v[198:199], v[184:185], v[228:229]
    v_pk_add_f32 v[228:229], v[184:185], v[228:229] neg_lo:[0,1] neg_hi:[0,1]
    v_pk_add_f32 v[218:219], v[212:213], v[246:247]
    v_pk_add_f32 v[246:247], v[212:213], v[246:247] neg_lo:[0,1] neg_hi:[0,1]
    v_pk_add_f32 v[226:227], v[170:171], v[230:231]
    v_pk_add_f32 v[230:231], v[170:171], v[230:231] neg_lo:[0,1] neg_hi:[0,1]
    v_add_f32 v238, v230, v231
    v_sub_f32 v239, v231, v230
    v_mul_f32 v238, 0x3f3504f3, v238
    v_mul_f32 v239, 0x3f3504f3, v239
    v_pk_add_f32 v[222:223], v[244:245], v[240:241]
    v_sub_f32 v248, v245, v241
    v_sub_f32 v249, v240, v244
    v_pk_add_f32 v[168:169], v[236:237], v[232:233]
    v_pk_add_f32 v[232:233], v[236:237], v[232:233] neg_lo:[0,1] neg_hi:[0,1]
    v_sub_f32 v250, v233, v232
    v_add_f32 v251, v232, v233
    v_mul_f32 v250, 0x3f3504f3, v250
    v_mul_f32 v251, 0xbf3504f3, v251
    v_pk_add_f32 v[188:189], v[218:219], v[222:223]
    v_pk_add_f32 v[222:223], v[218:219], v[222:223] neg_lo:[0,1] neg_hi:[0,1]
    v_pk_add_f32 v[156:157], v[226:227], v[168:169]
    v_sub_f32 v204, v227, v169
    v_sub_f32 v205, v168, v226
    v_pk_add_f32 v[158:159], v[188:189], v[156:157]
    v_pk_add_f32 v[156:157], v[188:189], v[156:157] neg_lo:[0,1] neg_hi:[0,1]
    v_pk_add_f32 v[192:193], v[222:223], v[204:205]
    v_pk_add_f32 v[204:205], v[222:223], v[204:205] neg_lo:[0,1] neg_hi:[0,1]
    v_pk_add_f32 v[154:155], v[246:247], v[248:249]
    v_pk_add_f32 v[248:249], v[246:247], v[248:249] neg_lo:[0,1] neg_hi:[0,1]
    v_pk_add_f32 v[208:209], v[238:239], v[250:251]
    v_sub_f32 v200, v239, v251
    v_sub_f32 v201, v250, v238
    v_pk_add_f32 v[196:197], v[154:155], v[208:209]
    v_pk_add_f32 v[208:209], v[154:155], v[208:209] neg_lo:[0,1] neg_hi:[0,1]
    v_pk_add_f32 v[152:153], v[248:249], v[200:201]
    v_pk_add_f32 v[200:201], v[248:249], v[200:201] neg_lo:[0,1] neg_hi:[0,1]
    s_waitcnt vmcnt(39)
    v_pk_mul_f32 v[172:173], v[158:159], v[46:47] op_sel:[0,0] op_sel_hi:[1,0]
    v_pk_fma_f32 v[172:173], v[158:159], v[46:47], v[172:173] op_sel:[1,1,0] op_sel_hi:[0,1,1] neg_lo:[1,0,0]
    v_pk_mul_f32 v[178:179], v[220:221], v[48:49] op_sel:[0,0] op_sel_hi:[1,0]
    v_pk_fma_f32 v[178:179], v[220:221], v[48:49], v[178:179] op_sel:[1,1,0] op_sel_hi:[0,1,1] neg_lo:[1,0,0]
    v_pk_mul_f32 v[182:183], v[196:197], v[50:51] op_sel:[0,0] op_sel_hi:[1,0]
    v_pk_fma_f32 v[182:183], v[196:197], v[50:51], v[182:183] op_sel:[1,1,0] op_sel_hi:[0,1,1] neg_lo:[1,0,0]
    v_pk_mul_f32 v[176:177], v[214:215], v[52:53] op_sel:[0,0] op_sel_hi:[1,0]
    v_pk_fma_f32 v[176:177], v[214:215], v[52:53], v[176:177] op_sel:[1,1,0] op_sel_hi:[0,1,1] neg_lo:[1,0,0]
    v_pk_mul_f32 v[174:175], v[192:193], v[54:55] op_sel:[0,0] op_sel_hi:[1,0]
    v_pk_fma_f32 v[174:175], v[192:193], v[54:55], v[174:175] op_sel:[1,1,0] op_sel_hi:[0,1,1] neg_lo:[1,0,0]
    v_pk_mul_f32 v[166:167], v[198:199], v[56:57] op_sel:[0,0] op_sel_hi:[1,0]
    v_pk_fma_f32 v[166:167], v[198:199], v[56:57], v[166:167] op_sel:[1,1,0] op_sel_hi:[0,1,1] neg_lo:[1,0,0]
    v_pk_mul_f32 v[164:165], v[152:153], v[58:59] op_sel:[0,0] op_sel_hi:[1,0]
    v_pk_fma_f32 v[164:165], v[152:153], v[58:59], v[164:165] op_sel:[1,1,0] op_sel_hi:[0,1,1] neg_lo:[1,0,0]
    v_pk_mul_f32 v[160:161], v[206:207], v[60:61] op_sel:[0,0] op_sel_hi:[1,0]
    v_pk_fma_f32 v[160:161], v[206:207], v[60:61], v[160:161] op_sel:[1,1,0] op_sel_hi:[0,1,1] neg_lo:[1,0,0]
    v_pk_mul_f32 v[242:243], v[156:157], v[62:63] op_sel:[0,0] op_sel_hi:[1,0]
    v_pk_fma_f32 v[242:243], v[156:157], v[62:63], v[242:243] op_sel:[1,1,0] op_sel_hi:[0,1,1] neg_lo:[1,0,0]
    v_pk_mul_f32 v[186:187], v[224:225], v[64:65] op_sel:[0,0] op_sel_hi:[1,0]
    v_pk_fma_f32 v[186:187], v[224:225], v[64:65], v[186:187] op_sel:[1,1,0] op_sel_hi:[0,1,1] neg_lo:[1,0,0]
    v_pk_mul_f32 v[190:191], v[208:209], v[66:67] op_sel:[0,0] op_sel_hi:[1,0]
    v_pk_fma_f32 v[190:191], v[208:209], v[66:67], v[190:191] op_sel:[1,1,0] op_sel_hi:[0,1,1] neg_lo:[1,0,0]
    v_pk_mul_f32 v[234:235], v[194:195], v[68:69] op_sel:[0,0] op_sel_hi:[1,0]
    v_pk_fma_f32 v[234:235], v[194:195], v[68:69], v[234:235] op_sel:[1,1,0] op_sel_hi:[0,1,1] neg_lo:[1,0,0]
    v_pk_mul_f32 v[162:163], v[204:205], v[70:71] op_sel:[0,0] op_sel_hi:[1,0]
    v_pk_fma_f32 v[162:163], v[204:205], v[70:71], v[162:163] op_sel:[1,1,0] op_sel_hi:[0,1,1] neg_lo:[1,0,0]
    v_pk_mul_f32 v[180:181], v[228:229], v[72:73] op_sel:[0,0] op_sel_hi:[1,0]
    v_pk_fma_f32 v[180:181], v[228:229], v[72:73], v[180:181] op_sel:[1,1,0] op_sel_hi:[0,1,1] neg_lo:[1,0,0]
    v_pk_mul_f32 v[202:203], v[200:201], v[74:75] op_sel:[0,0] op_sel_hi:[1,0]
    v_pk_fma_f32 v[202:203], v[200:201], v[74:75], v[202:203] op_sel:[1,1,0] op_sel_hi:[0,1,1] neg_lo:[1,0,0]
    v_mul_u32_u24 v13, 264, v6
    v_lshrrev_b32 v15, 3, v3
    v_add_u32 v13, v13, v15
    v_lshlrev_b32 v13, 3, v13
    v_add_u32 v13, s32, v13
    v_add_u32 v13, 34816, v13
    ds_write_b64 v13, v[210:211] offset:0
    ds_write_b64 v13, v[172:173] offset:128
    ds_write_b64 v13, v[178:179] offset:256
    ds_write_b64 v13, v[182:183] offset:384
    ds_write_b64 v13, v[176:177] offset:512
    ds_write_b64 v13, v[174:175] offset:640
    ds_write_b64 v13, v[166:167] offset:768
    ds_write_b64 v13, v[164:165] offset:896
    ds_write_b64 v13, v[160:161] offset:1024
    ds_write_b64 v13, v[242:243] offset:1152
    ds_write_b64 v13, v[186:187] offset:1280
    ds_write_b64 v13, v[190:191] offset:1408
    ds_write_b64 v13, v[234:235] offset:1536
    ds_write_b64 v13, v[162:163] offset:1664
    ds_write_b64 v13, v[180:181] offset:1792
    ds_write_b64 v13, v[202:203] offset:1920
    v_lshlrev_b32 v14, 3, v0
    v_add_u32 v14, 34816, v14
    s_waitcnt lgkmcnt(0)
    s_barrier
    ds_read_b64 v[216:217], v14 offset:0
    ds_read_b64 v[184:185], v14 offset:17408
    ds_read_b64 v[212:213], v14 offset:2112
    ds_read_b64 v[170:171], v14 offset:19520
    ds_read_b64 v[230:231], v14 offset:4224
    ds_read_b64 v[244:245], v14 offset:21632
    ds_read_b64 v[240:241], v14 offset:6336
    ds_read_b64 v[236:237], v14 offset:23744
    ds_read_b64 v[232:233], v14 offset:8448
    ds_read_b64 v[218:219], v14 offset:25856
    ds_read_b64 v[226:227], v14 offset:10560
    ds_read_b64 v[168:169], v14 offset:27968
    ds_read_b64 v[188:189], v14 offset:12672
    ds_read_b64 v[222:223], v14 offset:30080
    ds_read_b64 v[246:247], v14 offset:14784
    ds_read_b64 v[238:239], v14 offset:32192
    s_waitcnt lgkmcnt(0)
    v_pk_add_f32 v[250:251], v[216:217], v[232:233]
    v_pk_add_f32 v[232:233], v[216:217], v[232:233] neg_lo:[0,1] neg_hi:[0,1]
    v_pk_add_f32 v[154:155], v[212:213], v[226:227]
    v_pk_add_f32 v[226:227], v[212:213], v[226:227] neg_lo:[0,1] neg_hi:[0,1]
    v_add_f32 v248, v226, v227
    v_sub_f32 v249, v227, v226
    v_mul_f32 v248, 0x3f3504f3, v248
    v_mul_f32 v249, 0x3f3504f3, v249
    v_pk_add_f32 v[158:159], v[230:231], v[188:189]
    v_sub_f32 v220, v231, v189
    v_sub_f32 v221, v188, v230
    v_pk_add_f32 v[196:197], v[240:241], v[246:247]
    v_pk_add_f32 v[246:247], v[240:241], v[246:247] neg_lo:[0,1] neg_hi:[0,1]
    v_sub_f32 v214, v247, v246
    v_add_f32 v215, v246, v247
    v_mul_f32 v214, 0x3f3504f3, v214
    v_mul_f32 v215, 0xbf3504f3, v215
    v_pk_add_f32 v[192:193], v[250:251], v[158:159]
    v_pk_add_f32 v[158:159], v[250:251], v[158:159] neg_lo:[0,1] neg_hi:[0,1]
    v_pk_add_f32 v[198:199], v[154:155], v[196:197]
    v_sub_f32 v152, v155, v197
    v_sub_f32 v153, v196, v154
    v_pk_add_f32 v[206:207], v[192:193], v[198:199]
    v_pk_add_f32 v[198:199], v[192:193], v[198:199] neg_lo:[0,1] neg_hi:[0,1]
    v_pk_add_f32 v[156:157], v[158:159], v[152:153]
    v_pk_add_f32 v[152:153], v[158:159], v[152:153] neg_lo:[0,1] neg_hi:[0,1]
    v_pk_add_f32 v[224:225], v[232:233], v[220:221]
    v_pk_add_f32 v[220:221], v[232:233], v[220:221] neg_lo:[0,1] neg_hi:[0,1]
    v_pk_add_f32 v[208:209], v[248:249], v[214:215]
    v_sub_f32 v194, v249, v215
    v_sub_f32 v195, v214, v248
    v_pk_add_f32 v[204:205], v[224:225], v[208:209]
    v_pk_add_f32 v[208:209], v[224:225], v[208:209] neg_lo:[0,1] neg_hi:[0,1]
    v_pk_add_f32 v[228:229], v[220:221], v[194:195]
    v_pk_add_f32 v[194:195], v[220:221], v[194:195] neg_lo:[0,1] neg_hi:[0,1]
    v_pk_add_f32 v[200:201], v[184:185], v[218:219]
    v_pk_add_f32 v[218:219], v[184:185], v[218:219] neg_lo:[0,1] neg_hi:[0,1]
    v_pk_add_f32 v[210:211], v[170:171], v[168:169]
    v_pk_add_f32 v[168:169], v[170:171], v[168:169] neg_lo:[0,1] neg_hi:[0,1]
    v_add_f32 v172, v168, v169
    v_sub_f32 v173, v169, v168
    v_mul_f32 v172, 0x3f3504f3, v172
    v_mul_f32 v173, 0x3f3504f3, v173
    v_pk_add_f32 v[178:179], v[244:245], v[222:223]
    v_sub_f32 v182, v245, v223
    v_sub_f32 v183, v222, v244
    v_pk_add_f32 v[176:177], v[236:237], v[238:239]
    v_pk_add_f32 v[238:239], v[236:237], v[238:239] neg_lo:[0,1] neg_hi:[0,1]
    v_sub_f32 v174, v239, v238
    v_add_f32 v175, v238, v239
    v_mul_f32 v174, 0x3f3504f3, v174
    v_mul_f32 v175, 0xbf3504f3, v175
    v_pk_add_f32 v[166:167], v[200:201], v[178:179]
    v_pk_add_f32 v[178:179], v[200:201], v[178:179] neg_lo:[0,1] neg_hi:[0,1]
    v_pk_add_f32 v[164:165], v[210:211], v[176:177]
    v_sub_f32 v160, v211, v177
    v_sub_f32 v161, v176, v210
    v_pk_add_f32 v[242:243], v[166:167], v[164:165]
    v_pk_add_f32 v[164:165], v[166:167], v[164:165] neg_lo:[0,1] neg_hi:[0,1]
    v_pk_add_f32 v[186:187], v[178:179], v[160:161]
    v_pk_add_f32 v[160:161], v[178:179], v[160:161] neg_lo:[0,1] neg_hi:[0,1]
    v_pk_add_f32 v[190:191], v[218:219], v[182:183]
    v_pk_add_f32 v[182:183], v[218:219], v[182:183] neg_lo:[0,1] neg_hi:[0,1]
    v_pk_add_f32 v[234:235], v[172:173], v[174:175]
    v_sub_f32 v162, v173, v175
    v_sub_f32 v163, v174, v172
    v_pk_add_f32 v[180:181], v[190:191], v[234:235]
    v_pk_add_f32 v[234:235], v[190:191], v[234:235] neg_lo:[0,1] neg_hi:[0,1]
    v_pk_add_f32 v[202:203], v[182:183], v[162:163]
    v_pk_add_f32 v[162:163], v[182:183], v[162:163] neg_lo:[0,1] neg_hi:[0,1]
    s_waitcnt vmcnt(0)
    v_mov_b32 v252, v11
    v_sub_f32 v253, 0, v10
    v_mov_b32 v254, v11
    v_mov_b32 v255, v10
    s_mov_b32 s33, 0xffff0000
    s_cmp_lg_u32 s2, 0
    s_cbranch_scc1 k2_wgen
    s_mov_b32 s29, 50331648
    v_sub_u32 v5, 2048, v0
    v_and_b32 v5, 2047, v5
    v_lshlrev_b32 v5, 2, v5
    buffer_load_dword v136, v5, s[16:19], s29 offen
    v_sub_u32 v5, 1792, v0
    v_and_b32 v5, 2047, v5
    v_lshlrev_b32 v5, 2, v5
    buffer_load_dword v137, v5, s[16:19], s29 offen
    v_sub_u32 v5, 1536, v0
    v_and_b32 v5, 2047, v5
    v_lshlrev_b32 v5, 2, v5
    buffer_load_dword v138, v5, s[16:19], s29 offen
    v_sub_u32 v5, 1280, v0
    v_and_b32 v5, 2047, v5
    v_lshlrev_b32 v5, 2, v5
    buffer_load_dword v139, v5, s[16:19], s29 offen
    v_sub_u32 v5, 1024, v0
    v_and_b32 v5, 2047, v5
    v_lshlrev_b32 v5, 2, v5
    buffer_load_dword v140, v5, s[16:19], s29 offen
    v_sub_u32 v5, 768, v0
    v_and_b32 v5, 2047, v5
    v_lshlrev_b32 v5, 2, v5
    buffer_load_dword v141, v5, s[16:19], s29 offen
    v_sub_u32 v5, 512, v0
    v_and_b32 v5, 2047, v5
    v_lshlrev_b32 v5, 2, v5
    buffer_load_dword v142, v5, s[16:19], s29 offen
    v_sub_u32 v5, 256, v0
    v_and_b32 v5, 2047, v5
    v_lshlrev_b32 v5, 2, v5
    buffer_load_dword v143, v5, s[16:19], s29 offen
    s_mov_b32 s29, 54525952
    buffer_load_dword v144, v8, s[16:19], s29 offen offset:0
    buffer_load_dword v145, v8, s[16:19], s29 offen offset:1024
    buffer_load_dword v146, v8, s[16:19], s29 offen offset:2048
    buffer_load_dword v147, v8, s[16:19], s29 offen offset:3072
    s_add_u32 s29, s29, 4096
    buffer_load_dword v148, v8, s[16:19], s29 offen offset:0
    buffer_load_dword v149, v8, s[16:19], s29 offen offset:1024
    buffer_load_dword v150, v8, s[16:19], s29 offen offset:2048
    buffer_load_dword v151, v8, s[16:19], s29 offen offset:3072
    s_waitcnt vmcnt(0)
    v_lshlrev_b32 v5, 16, v120
    v_and_b32 v13, s33, v120
    v_lshlrev_b32 v14, 16, v136
    v_and_b32 v15, s33, v136
    v_add_f32 v5, v5, v14
    v_sub_f32 v13, v13, v15
    v_mul_f32 v16, 0.5, v5
    v_mul_f32 v17, 0.5, v13
    v_lshlrev_b32 v5, 16, v144
    v_and_b32 v13, s33, v144
    v_lshlrev_b32 v14, 16, v128
    v_and_b32 v15, s33, v128
    v_add_f32 v5, v5, v14
    v_sub_f32 v13, v13, v15
    v_mul_f32 v18, 0.5, v5
    v_mul_f32 v19, 0.5, v13
    v_lshlrev_b32 v5, 16, v121
    v_and_b32 v13, s33, v121
    v_lshlrev_b32 v14, 16, v137
    v_and_b32 v15, s33, v137
    v_add_f32 v5, v5, v14
    v_sub_f32 v13, v13, v15
    v_mul_f32 v20, 0.5, v5
    v_mul_f32 v21, 0.5, v13
    v_lshlrev_b32 v5, 16, v145
    v_and_b32 v13, s33, v145
    v_lshlrev_b32 v14, 16, v129
    v_and_b32 v15, s33, v129
    v_add_f32 v5, v5, v14
    v_sub_f32 v13, v13, v15
    v_mul_f32 v22, 0.5, v5
    v_mul_f32 v23, 0.5, v13
    v_lshlrev_b32 v5, 16, v122
    v_and_b32 v13, s33, v122
    v_lshlrev_b32 v14, 16, v138
    v_and_b32 v15, s33, v138
    v_add_f32 v5, v5, v14
    v_sub_f32 v13, v13, v15
    v_mul_f32 v24, 0.5, v5
    v_mul_f32 v25, 0.5, v13
    v_lshlrev_b32 v5, 16, v146
    v_and_b32 v13, s33, v146
    v_lshlrev_b32 v14, 16, v130
    v_and_b32 v15, s33, v130
    v_add_f32 v5, v5, v14
    v_sub_f32 v13, v13, v15
    v_mul_f32 v26, 0.5, v5
    v_mul_f32 v27, 0.5, v13
    v_lshlrev_b32 v5, 16, v123
    v_and_b32 v13, s33, v123
    v_lshlrev_b32 v14, 16, v139
    v_and_b32 v15, s33, v139
    v_add_f32 v5, v5, v14
    v_sub_f32 v13, v13, v15
    v_mul_f32 v28, 0.5, v5
    v_mul_f32 v29, 0.5, v13
    v_lshlrev_b32 v5, 16, v147
    v_and_b32 v13, s33, v147
    v_lshlrev_b32 v14, 16, v131
    v_and_b32 v15, s33, v131
    v_add_f32 v5, v5, v14
    v_sub_f32 v13, v13, v15
    v_mul_f32 v30, 0.5, v5
    v_mul_f32 v31, 0.5, v13
    v_lshlrev_b32 v5, 16, v124
    v_and_b32 v13, s33, v124
    v_lshlrev_b32 v14, 16, v140
    v_and_b32 v15, s33, v140
    v_add_f32 v5, v5, v14
    v_sub_f32 v13, v13, v15
    v_mul_f32 v32, 0.5, v5
    v_mul_f32 v33, 0.5, v13
    v_lshlrev_b32 v5, 16, v148
    v_and_b32 v13, s33, v148
    v_lshlrev_b32 v14, 16, v132
    v_and_b32 v15, s33, v132
    v_add_f32 v5, v5, v14
    v_sub_f32 v13, v13, v15
    v_mul_f32 v34, 0.5, v5
    v_mul_f32 v35, 0.5, v13
    v_lshlrev_b32 v5, 16, v125
    v_and_b32 v13, s33, v125
    v_lshlrev_b32 v14, 16, v141
    v_and_b32 v15, s33, v141
    v_add_f32 v5, v5, v14
    v_sub_f32 v13, v13, v15
    v_mul_f32 v36, 0.5, v5
    v_mul_f32 v37, 0.5, v13
    v_lshlrev_b32 v5, 16, v149
    v_and_b32 v13, s33, v149
    v_lshlrev_b32 v14, 16, v133
    v_and_b32 v15, s33, v133
    v_add_f32 v5, v5, v14
    v_sub_f32 v13, v13, v15
    v_mul_f32 v38, 0.5, v5
    v_mul_f32 v39, 0.5, v13
    v_lshlrev_b32 v5, 16, v126
    v_and_b32 v13, s33, v126
    v_lshlrev_b32 v14, 16, v142
    v_and_b32 v15, s33, v142
    v_add_f32 v5, v5, v14
    v_sub_f32 v13, v13, v15
    v_mul_f32 v40, 0.5, v5
    v_mul_f32 v41, 0.5, v13
    v_lshlrev_b32 v5, 16, v150
    v_and_b32 v13, s33, v150
    v_lshlrev_b32 v14, 16, v134
    v_and_b32 v15, s33, v134
    v_add_f32 v5, v5, v14
    v_sub_f32 v13, v13, v15
    v_mul_f32 v42, 0.5, v5
    v_mul_f32 v43, 0.5, v13
    v_lshlrev_b32 v5, 16, v127
    v_and_b32 v13, s33, v127
    v_lshlrev_b32 v14, 16, v143
    v_and_b32 v15, s33, v143
    v_add_f32 v5, v5, v14
    v_sub_f32 v13, v13, v15
    v_mul_f32 v44, 0.5, v5
    v_mul_f32 v45, 0.5, v13
    v_lshlrev_b32 v5, 16, v151
    v_and_b32 v13, s33, v151
    v_lshlrev_b32 v14, 16, v135
    v_and_b32 v15, s33, v135
    v_add_f32 v5, v5, v14
    v_sub_f32 v13, v13, v15
    v_mul_f32 v46, 0.5, v5
    v_mul_f32 v47, 0.5, v13
    s_branch k2_wdone
k2_wgen:
    v_lshlrev_b32 v16, 16, v120
    v_and_b32 v17, s33, v120
    v_lshlrev_b32 v18, 16, v128
    v_and_b32 v19, s33, v128
    v_sub_f32 v19, 0, v19
    v_lshlrev_b32 v20, 16, v121
    v_and_b32 v21, s33, v121
    v_lshlrev_b32 v22, 16, v129
    v_and_b32 v23, s33, v129
    v_sub_f32 v23, 0, v23
    v_lshlrev_b32 v24, 16, v122
    v_and_b32 v25, s33, v122
    v_lshlrev_b32 v26, 16, v130
    v_and_b32 v27, s33, v130
    v_sub_f32 v27, 0, v27
    v_lshlrev_b32 v28, 16, v123
    v_and_b32 v29, s33, v123
    v_lshlrev_b32 v30, 16, v131
    v_and_b32 v31, s33, v131
    v_sub_f32 v31, 0, v31
    v_lshlrev_b32 v32, 16, v124
    v_and_b32 v33, s33, v124
    v_lshlrev_b32 v34, 16, v132
    v_and_b32 v35, s33, v132
    v_sub_f32 v35, 0, v35
    v_lshlrev_b32 v36, 16, v125
    v_and_b32 v37, s33, v125
    v_lshlrev_b32 v38, 16, v133
    v_and_b32 v39, s33, v133
    v_sub_f32 v39, 0, v39
    v_lshlrev_b32 v40, 16, v126
    v_and_b32 v41, s33, v126
    v_lshlrev_b32 v42, 16, v134
    v_and_b32 v43, s33, v134
    v_sub_f32 v43, 0, v43
    v_lshlrev_b32 v44, 16, v127
    v_and_b32 v45, s33, v127
    v_lshlrev_b32 v46, 16, v135
    v_and_b32 v47, s33, v135
    v_sub_f32 v47, 0, v47
k2_wdone:
    v_pk_add_f32 v[216:217], v[206:207], v[242:243]
    v_pk_add_f32 v[242:243], v[206:207], v[242:243] neg_lo:[0,1] neg_hi:[0,1]
    v_pk_mul_f32 v[212:213], v[242:243], v[252:253] op_sel:[0,0] op_sel_hi:[1,0]
    v_pk_fma_f32 v[212:213], v[242:243], v[252:253], v[212:213] op_sel:[1,1,0] op_sel_hi:[0,1,1] neg_lo:[1,0,0]
    v_pk_add_f32 v[226:227], v[216:217], v[212:213]
    v_pk_add_f32 v[212:213], v[216:217], v[212:213] neg_lo:[0,1] neg_hi:[0,1]
    v_pk_mul_f32 v[230:231], v[226:227], v[16:17] op_sel:[0,0] op_sel_hi:[1,0]
    v_pk_fma_f32 v[230:231], v[226:227], v[16:17], v[230:231] op_sel:[1,1,0] op_sel_hi:[0,1,1] neg_lo:[1,0,0]
    v_pk_mul_f32 v[188:189], v[212:213], v[18:19] op_sel:[0,0] op_sel_hi:[1,0]
    v_pk_fma_f32 v[188:189], v[212:213], v[18:19], v[188:189] op_sel:[1,1,0] op_sel_hi:[0,1,1] neg_lo:[1,0,0]
    v_pk_add_f32 v[240:241], v[230:231], v[188:189]
    v_pk_add_f32 v[188:189], v[230:231], v[188:189] neg_lo:[0,1] neg_hi:[0,1]
    v_pk_mul_f32 v[246:247], v[188:189], v[254:255] op_sel:[0,0] op_sel_hi:[1,0]
    v_pk_fma_f32 v[246:247], v[188:189], v[254:255], v[246:247] op_sel:[1,1,0] op_sel_hi:[0,1,1] neg_lo:[1,0,0]
    v_pk_add_f32 v[250:251], v[240:241], v[246:247]
    v_pk_add_f32 v[246:247], v[240:241], v[246:247] neg_lo:[0,1] neg_hi:[0,1]
    v_pk_add_f32 v[154:155], v[204:205], v[180:181]
    v_pk_add_f32 v[180:181], v[204:205], v[180:181] neg_lo:[0,1] neg_hi:[0,1]
    v_pk_mul_f32 v[196:197], v[180:181], v[252:253] op_sel:[0,0] op_sel_hi:[1,0]
    v_pk_fma_f32 v[196:197], v[180:181], v[252:253], v[196:197] op_sel:[1,1,0] op_sel_hi:[0,1,1] neg_lo:[1,0,0]
    v_pk_add_f32 v[192:193], v[154:155], v[196:197]
    v_pk_add_f32 v[196:197], v[154:155], v[196:197] neg_lo:[0,1] neg_hi:[0,1]
    v_pk_mul_f32 v[158:159], v[192:193], v[20:21] op_sel:[0,0] op_sel_hi:[1,0]
    v_pk_fma_f32 v[158:159], v[192:193], v[20:21], v[158:159] op_sel:[1,1,0] op_sel_hi:[0,1,1] neg_lo:[1,0,0]
    v_pk_mul_f32 v[232:233], v[196:197], v[22:23] op_sel:[0,0] op_sel_hi:[1,0]
    v_pk_fma_f32 v[232:233], v[196:197], v[22:23], v[232:233] op_sel:[1,1,0] op_sel_hi:[0,1,1] neg_lo:[1,0,0]
    v_pk_add_f32 v[248:249], v[158:159], v[232:233]
    v_pk_add_f32 v[232:233], v[158:159], v[232:233] neg_lo:[0,1] neg_hi:[0,1]
    v_pk_mul_f32 v[214:215], v[232:233], v[254:255] op_sel:[0,0] op_sel_hi:[1,0]
    v_pk_fma_f32 v[214:215], v[232:233], v[254:255], v[214:215] op_sel:[1,1,0] op_sel_hi:[0,1,1] neg_lo:[1,0,0]
    v_pk_add_f32 v[224:225], v[248:249], v[214:215]
    v_pk_add_f32 v[214:215], v[248:249], v[214:215] neg_lo:[0,1] neg_hi:[0,1]
    v_pk_add_f32 v[220:221], v[156:157], v[186:187]
    v_pk_add_f32 v[186:187], v[156:157], v[186:187] neg_lo:[0,1] neg_hi:[0,1]
    v_pk_mul_f32 v[184:185], v[186:187], v[252:253] op_sel:[0,0] op_sel_hi:[1,0]
    v_pk_fma_f32 v[184:185], v[186:187], v[252:253], v[184:185] op_sel:[1,1,0] op_sel_hi:[0,1,1] neg_lo:[1,0,0]
    v_pk_add_f32 v[170:171], v[220:221], v[184:185]
    v_pk_add_f32 v[184:185], v[220:221], v[184:185] neg_lo:[0,1] neg_hi:[0,1]
    v_pk_mul_f32 v[168:169], v[170:171], v[24:25] op_sel:[0,0] op_sel_hi:[1,0]
    v_pk_fma_f32 v[168:169], v[170:171], v[24:25], v[168:169] op_sel:[1,1,0] op_sel_hi:[0,1,1] neg_lo:[1,0,0]
    v_pk_mul_f32 v[244:245], v[184:185], v[26:27] op_sel:[0,0] op_sel_hi:[1,0]
    v_pk_fma_f32 v[244:245], v[184:185], v[26:27], v[244:245] op_sel:[1,1,0] op_sel_hi:[0,1,1] neg_lo:[1,0,0]
    v_pk_add_f32 v[222:223], v[168:169], v[244:245]
    v_pk_add_f32 v[244:245], v[168:169], v[244:245] neg_lo:[0,1] neg_hi:[0,1]
    v_pk_mul_f32 v[236:237], v[244:245], v[254:255] op_sel:[0,0] op_sel_hi:[1,0]
    v_pk_fma_f32 v[236:237], v[244:245], v[254:255], v[236:237] op_sel:[1,1,0] op_sel_hi:[0,1,1] neg_lo:[1,0,0]
    v_pk_add_f32 v[238:239], v[222:223], v[236:237]
    v_pk_add_f32 v[236:237], v[222:223], v[236:237] neg_lo:[0,1] neg_hi:[0,1]
    v_pk_add_f32 v[200:201], v[228:229], v[202:203]
    v_pk_add_f32 v[202:203], v[228:229], v[202:203] neg_lo:[0,1] neg_hi:[0,1]
    v_pk_mul_f32 v[210:211], v[202:203], v[252:253] op_sel:[0,0] op_sel_hi:[1,0]
    v_pk_fma_f32 v[210:211], v[202:203], v[252:253], v[210:211] op_sel:[1,1,0] op_sel_hi:[0,1,1] neg_lo:[1,0,0]
    v_pk_add_f32 v[176:177], v[200:201], v[210:211]
    v_pk_add_f32 v[210:211], v[200:201], v[210:211] neg_lo:[0,1] neg_hi:[0,1]
    v_pk_mul_f32 v[166:167], v[176:177], v[28:29] op_sel:[0,0] op_sel_hi:[1,0]
    v_pk_fma_f32 v[166:167], v[176:177], v[28:29], v[166:167] op_sel:[1,1,0] op_sel_hi:[0,1,1] neg_lo:[1,0,0]
    v_pk_mul_f32 v[178:179], v[210:211], v[30:31] op_sel:[0,0] op_sel_hi:[1,0]
    v_pk_fma_f32 v[178:179], v[210:211], v[30:31], v[178:179] op_sel:[1,1,0] op_sel_hi:[0,1,1] neg_lo:[1,0,0]
    v_pk_add_f32 v[218:219], v[166:167], v[178:179]
    v_pk_add_f32 v[178:179], v[166:167], v[178:179] neg_lo:[0,1] neg_hi:[0,1]
    v_pk_mul_f32 v[172:173], v[178:179], v[254:255] op_sel:[0,0] op_sel_hi:[1,0]
    v_pk_fma_f32 v[172:173], v[178:179], v[254:255], v[172:173] op_sel:[1,1,0] op_sel_hi:[0,1,1] neg_lo:[1,0,0]
    v_pk_add_f32 v[174:175], v[218:219], v[172:173]
    v_pk_add_f32 v[172:173], v[218:219], v[172:173] neg_lo:[0,1] neg_hi:[0,1]
    v_pk_add_f32 v[190:191], v[198:199], v[164:165]
    v_pk_add_f32 v[164:165], v[198:199], v[164:165] neg_lo:[0,1] neg_hi:[0,1]
    v_pk_mul_f32 v[182:183], v[164:165], v[252:253] op_sel:[0,0] op_sel_hi:[1,0]
    v_pk_fma_f32 v[182:183], v[164:165], v[252:253], v[182:183] op_sel:[1,1,0] op_sel_hi:[0,1,1] neg_lo:[1,0,0]
    v_pk_add_f32 v[206:207], v[190:191], v[182:183]
    v_pk_add_f32 v[182:183], v[190:191], v[182:183] neg_lo:[0,1] neg_hi:[0,1]
    v_pk_mul_f32 v[242:243], v[206:207], v[32:33] op_sel:[0,0] op_sel_hi:[1,0]
    v_pk_fma_f32 v[242:243], v[206:207], v[32:33], v[242:243] op_sel:[1,1,0] op_sel_hi:[0,1,1] neg_lo:[1,0,0]
    v_pk_mul_f32 v[216:217], v[182:183], v[34:35] op_sel:[0,0] op_sel_hi:[1,0]
    v_pk_fma_f32 v[216:217], v[182:183], v[34:35], v[216:217] op_sel:[1,1,0] op_sel_hi:[0,1,1] neg_lo:[1,0,0]
    v_pk_add_f32 v[226:227], v[242:243], v[216:217]
    v_pk_add_f32 v[216:217], v[242:243], v[216:217] neg_lo:[0,1] neg_hi:[0,1]
    v_pk_mul_f32 v[212:213], v[216:217], v[254:255] op_sel:[0,0] op_sel_hi:[1,0]
    v_pk_fma_f32 v[212:213], v[216:217], v[254:255], v[212:213] op_sel:[1,1,0] op_sel_hi:[0,1,1] neg_lo:[1,0,0]
    v_pk_add_f32 v[230:231], v[226:227], v[212:213]
    v_pk_add_f32 v[212:213], v[226:227], v[212:213] neg_lo:[0,1] neg_hi:[0,1]
    v_pk_add_f32 v[188:189], v[208:209], v[234:235]
    v_pk_add_f32 v[234:235], v[208:209], v[234:235] neg_lo:[0,1] neg_hi:[0,1]
    v_pk_mul_f32 v[240:241], v[234:235], v[252:253] op_sel:[0,0] op_sel_hi:[1,0]
    v_pk_fma_f32 v[240:241], v[234:235], v[252:253], v[240:241] op_sel:[1,1,0] op_sel_hi:[0,1,1] neg_lo:[1,0,0]
    v_pk_add_f32 v[204:205], v[188:189], v[240:241]
    v_pk_add_f32 v[240:241], v[188:189], v[240:241] neg_lo:[0,1] neg_hi:[0,1]
    v_pk_mul_f32 v[180:181], v[204:205], v[36:37] op_sel:[0,0] op_sel_hi:[1,0]
    v_pk_fma_f32 v[180:181], v[204:205], v[36:37], v[180:181] op_sel:[1,1,0] op_sel_hi:[0,1,1] neg_lo:[1,0,0]
    v_pk_mul_f32 v[154:155], v[240:241], v[38:39] op_sel:[0,0] op_sel_hi:[1,0]
    v_pk_fma_f32 v[154:155], v[240:241], v[38:39], v[154:155] op_sel:[1,1,0] op_sel_hi:[0,1,1] neg_lo:[1,0,0]
    v_pk_add_f32 v[192:193], v[180:181], v[154:155]
    v_pk_add_f32 v[154:155], v[180:181], v[154:155] neg_lo:[0,1] neg_hi:[0,1]
    v_pk_mul_f32 v[196:197], v[154:155], v[254:255] op_sel:[0,0] op_sel_hi:[1,0]
    v_pk_fma_f32 v[196:197], v[154:155], v[254:255], v[196:197] op_sel:[1,1,0] op_sel_hi:[0,1,1] neg_lo:[1,0,0]
    v_pk_add_f32 v[158:159], v[192:193], v[196:197]
    v_pk_add_f32 v[196:197], v[192:193], v[196:197] neg_lo:[0,1] neg_hi:[0,1]
    v_pk_add_f32 v[232:233], v[152:153], v[160:161]
    v_pk_add_f32 v[160:161], v[152:153], v[160:161] neg_lo:[0,1] neg_hi:[0,1]
    v_pk_mul_f32 v[248:249], v[160:161], v[252:253] op_sel:[0,0] op_sel_hi:[1,0]
    v_pk_fma_f32 v[248:249], v[160:161], v[252:253], v[248:249] op_sel:[1,1,0] op_sel_hi:[0,1,1] neg_lo:[1,0,0]
    v_pk_add_f32 v[156:157], v[232:233], v[248:249]
    v_pk_add_f32 v[248:249], v[232:233], v[248:249] neg_lo:[0,1] neg_hi:[0,1]
    v_pk_mul_f32 v[186:187], v[156:157], v[40:41] op_sel:[0,0] op_sel_hi:[1,0]
    v_pk_fma_f32 v[186:187], v[156:157], v[40:41], v[186:187] op_sel:[1,1,0] op_sel_hi:[0,1,1] neg_lo:[1,0,0]
    v_pk_mul_f32 v[220:221], v[248:249], v[42:43] op_sel:[0,0] op_sel_hi:[1,0]
    v_pk_fma_f32 v[220:221], v[248:249], v[42:43], v[220:221] op_sel:[1,1,0] op_sel_hi:[0,1,1] neg_lo:[1,0,0]
    v_pk_add_f32 v[170:171], v[186:187], v[220:221]
    v_pk_add_f32 v[220:221], v[186:187], v[220:221] neg_lo:[0,1] neg_hi:[0,1]
    v_pk_mul_f32 v[184:185], v[220:221], v[254:255] op_sel:[0,0] op_sel_hi:[1,0]
    v_pk_fma_f32 v[184:185], v[220:221], v[254:255], v[184:185] op_sel:[1,1,0] op_sel_hi:[0,1,1] neg_lo:[1,0,0]
    v_pk_add_f32 v[168:169], v[170:171], v[184:185]
    v_pk_add_f32 v[184:185], v[170:171], v[184:185] neg_lo:[0,1] neg_hi:[0,1]
    v_pk_add_f32 v[244:245], v[194:195], v[162:163]
    v_pk_add_f32 v[162:163], v[194:195], v[162:163] neg_lo:[0,1] neg_hi:[0,1]
    v_pk_mul_f32 v[222:223], v[162:163], v[252:253] op_sel:[0,0] op_sel_hi:[1,0]
    v_pk_fma_f32 v[222:223], v[162:163], v[252:253], v[222:223] op_sel:[1,1,0] op_sel_hi:[0,1,1] neg_lo:[1,0,0]
    v_pk_add_f32 v[228:229], v[244:245], v[222:223]
    v_pk_add_f32 v[222:223], v[244:245], v[222:223] neg_lo:[0,1] neg_hi:[0,1]
    v_pk_mul_f32 v[202:203], v[228:229], v[44:45] op_sel:[0,0] op_sel_hi:[1,0]
    v_pk_fma_f32 v[202:203], v[228:229], v[44:45], v[202:203] op_sel:[1,1,0] op_sel_hi:[0,1,1] neg_lo:[1,0,0]
    v_pk_mul_f32 v[200:201], v[222:223], v[46:47] op_sel:[0,0] op_sel_hi:[1,0]
    v_pk_fma_f32 v[200:201], v[222:223], v[46:47], v[200:201] op_sel:[1,1,0] op_sel_hi:[0,1,1] neg_lo:[1,0,0]
    v_pk_add_f32 v[176:177], v[202:203], v[200:201]
    v_pk_add_f32 v[200:201], v[202:203], v[200:201] neg_lo:[0,1] neg_hi:[0,1]
    v_pk_mul_f32 v[210:211], v[200:201], v[254:255] op_sel:[0,0] op_sel_hi:[1,0]
    v_pk_fma_f32 v[210:211], v[200:201], v[254:255], v[210:211] op_sel:[1,1,0] op_sel_hi:[0,1,1] neg_lo:[1,0,0]
    v_pk_add_f32 v[166:167], v[176:177], v[210:211]
    v_pk_add_f32 v[210:211], v[176:177], v[210:211] neg_lo:[0,1] neg_hi:[0,1]
    v_pk_add_f32 v[178:179], v[250:251], v[230:231]
    v_pk_add_f32 v[230:231], v[250:251], v[230:231] neg_lo:[0,1] neg_hi:[0,1]
    v_pk_add_f32 v[218:219], v[224:225], v[158:159]
    v_pk_add_f32 v[158:159], v[224:225], v[158:159] neg_lo:[0,1] neg_hi:[0,1]
    v_sub_f32 v198, v158, v159
    v_add_f32 v199, v158, v159
    v_mul_f32 v198, 0x3f3504f3, v198
    v_mul_f32 v199, 0x3f3504f3, v199
    v_pk_add_f32 v[164:165], v[238:239], v[168:169]
    v_sub_f32 v190, v169, v239
    v_sub_f32 v191, v238, v168
    v_pk_add_f32 v[206:207], v[174:175], v[166:167]
    v_pk_add_f32 v[166:167], v[174:175], v[166:167] neg_lo:[0,1] neg_hi:[0,1]
    v_add_f32 v182, v166, v167
    v_sub_f32 v183, v166, v167
    v_mul_f32 v182, 0xbf3504f3, v182
    v_mul_f32 v183, 0x3f3504f3, v183
    v_pk_add_f32 v[242:243], v[178:179], v[164:165]
    v_pk_add_f32 v[164:165], v[178:179], v[164:165] neg_lo:[0,1] neg_hi:[0,1]
    v_pk_add_f32 v[216:217], v[218:219], v[206:207]
    v_sub_f32 v226, v207, v219
    v_sub_f32 v227, v218, v206
    v_pk_add_f32 v[208:209], v[242:243], v[216:217]
    v_pk_add_f32 v[216:217], v[242:243], v[216:217] neg_lo:[0,1] neg_hi:[0,1]
    v_pk_add_f32 v[234:235], v[164:165], v[226:227]
    v_pk_add_f32 v[226:227], v[164:165], v[226:227] neg_lo:[0,1] neg_hi:[0,1]
    v_pk_add_f32 v[188:189], v[230:231], v[190:191]
    v_pk_add_f32 v[190:191], v[230:231], v[190:191] neg_lo:[0,1] neg_hi:[0,1]
    v_pk_add_f32 v[204:205], v[198:199], v[182:183]
    v_sub_f32 v240, v183, v199
    v_sub_f32 v241, v198, v182
    v_pk_add_f32 v[180:181], v[188:189], v[204:205]
    v_pk_add_f32 v[204:205], v[188:189], v[204:205] neg_lo:[0,1] neg_hi:[0,1]
    v_pk_add_f32 v[154:155], v[190:191], v[240:241]
    v_pk_add_f32 v[240:241], v[190:191], v[240:241] neg_lo:[0,1] neg_hi:[0,1]
    v_pk_add_f32 v[192:193], v[246:247], v[212:213]
    v_pk_add_f32 v[212:213], v[246:247], v[212:213] neg_lo:[0,1] neg_hi:[0,1]
    v_pk_add_f32 v[152:153], v[214:215], v[196:197]
    v_pk_add_f32 v[196:197], v[214:215], v[196:197] neg_lo:[0,1] neg_hi:[0,1]
    v_sub_f32 v160, v196, v197
    v_add_f32 v161, v196, v197
    v_mul_f32 v160, 0x3f3504f3, v160
    v_mul_f32 v161, 0x3f3504f3, v161
    v_pk_add_f32 v[232:233], v[236:237], v[184:185]
    v_sub_f32 v156, v185, v237
    v_sub_f32 v157, v236, v184
    v_pk_add_f32 v[248:249], v[172:173], v[210:211]
    v_pk_add_f32 v[210:211], v[172:173], v[210:211] neg_lo:[0,1] neg_hi:[0,1]
    v_add_f32 v186, v210, v211
    v_sub_f32 v187, v210, v211
    v_mul_f32 v186, 0xbf3504f3, v186
    v_mul_f32 v187, 0x3f3504f3, v187
    v_pk_add_f32 v[220:221], v[192:193], v[232:233]
    v_pk_add_f32 v[232:233], v[192:193], v[232:233] neg_lo:[0,1] neg_hi:[0,1]
    v_pk_add_f32 v[170:171], v[152:153], v[248:249]
    v_sub_f32 v194, v249, v153
    v_sub_f32 v195, v152, v248
    v_pk_add_f32 v[162:163], v[220:221], v[170:171]
    v_pk_add_f32 v[170:171], v[220:221], v[170:171] neg_lo:[0,1] neg_hi:[0,1]
    v_pk_add_f32 v[244:245], v[232:233], v[194:195]
    v_pk_add_f32 v[194:195], v[232:233], v[194:195] neg_lo:[0,1] neg_hi:[0,1]
    v_pk_add_f32 v[228:229], v[212:213], v[156:157]
    v_pk_add_f32 v[156:157], v[212:213], v[156:157] neg_lo:[0,1] neg_hi:[0,1]
    v_pk_add_f32 v[222:223], v[160:161], v[186:187]
    v_sub_f32 v202, v187, v161
    v_sub_f32 v203, v160, v186
    v_pk_add_f32 v[200:201], v[228:229], v[222:223]
    v_pk_add_f32 v[222:223], v[228:229], v[222:223] neg_lo:[0,1] neg_hi:[0,1]
    v_pk_add_f32 v[176:177], v[156:157], v[202:203]
    v_pk_add_f32 v[202:203], v[156:157], v[202:203] neg_lo:[0,1] neg_hi:[0,1]
    s_waitcnt vmcnt(0)
    v_pk_mul_f32 v[250:251], v[180:181], v[76:77] op_sel:[0,0] op_sel_hi:[1,0]
    v_pk_fma_f32 v[250:251], v[180:181], v[76:77], v[250:251] op_sel:[1,1,0] op_sel_hi:[0,1,1] neg_hi:[1,0,0]
    v_pk_mul_f32 v[224:225], v[200:201], v[76:77] op_sel:[0,0] op_sel_hi:[1,0]
    v_pk_fma_f32 v[224:225], v[200:201], v[76:77], v[224:225] op_sel:[1,1,0] op_sel_hi:[0,1,1] neg_hi:[1,0,0]
    v_pk_mul_f32 v[158:159], v[234:235], v[78:79] op_sel:[0,0] op_sel_hi:[1,0]
    v_pk_fma_f32 v[158:159], v[234:235], v[78:79], v[158:159] op_sel:[1,1,0] op_sel_hi:[0,1,1] neg_hi:[1,0,0]
    v_pk_mul_f32 v[238:239], v[244:245], v[78:79] op_sel:[0,0] op_sel_hi:[1,0]
    v_pk_fma_f32 v[238:239], v[244:245], v[78:79], v[238:239] op_sel:[1,1,0] op_sel_hi:[0,1,1] neg_hi:[1,0,0]
    v_pk_mul_f32 v[168:169], v[154:155], v[80:81] op_sel:[0,0] op_sel_hi:[1,0]
    v_pk_fma_f32 v[168:169], v[154:155], v[80:81], v[168:169] op_sel:[1,1,0] op_sel_hi:[0,1,1] neg_hi:[1,0,0]
    v_pk_mul_f32 v[174:175], v[176:177], v[80:81] op_sel:[0,0] op_sel_hi:[1,0]
    v_pk_fma_f32 v[174:175], v[176:177], v[80:81], v[174:175] op_sel:[1,1,0] op_sel_hi:[0,1,1] neg_hi:[1,0,0]
    v_pk_mul_f32 v[166:167], v[216:217], v[82:83] op_sel:[0,0] op_sel_hi:[1,0]
    v_pk_fma_f32 v[166:167], v[216:217], v[82:83], v[166:167] op_sel:[1,1,0] op_sel_hi:[0,1,1] neg_hi:[1,0,0]
    v_pk_mul_f32 v[178:179], v[170:171], v[82:83] op_sel:[0,0] op_sel_hi:[1,0]
    v_pk_fma_f32 v[178:179], v[170:171], v[82:83], v[178:179] op_sel:[1,1,0] op_sel_hi:[0,1,1] neg_hi:[1,0,0]
    v_pk_mul_f32 v[218:219], v[204:205], v[84:85] op_sel:[0,0] op_sel_hi:[1,0]
    v_pk_fma_f32 v[218:219], v[204:205], v[84:85], v[218:219] op_sel:[1,1,0] op_sel_hi:[0,1,1] neg_hi:[1,0,0]
    v_pk_mul_f32 v[206:207], v[222:223], v[84:85] op_sel:[0,0] op_sel_hi:[1,0]
    v_pk_fma_f32 v[206:207], v[222:223], v[84:85], v[206:207] op_sel:[1,1,0] op_sel_hi:[0,1,1] neg_hi:[1,0,0]
    v_pk_mul_f32 v[242:243], v[226:227], v[86:87] op_sel:[0,0] op_sel_hi:[1,0]
    v_pk_fma_f32 v[242:243], v[226:227], v[86:87], v[242:243] op_sel:[1,1,0] op_sel_hi:[0,1,1] neg_hi:[1,0,0]
    v_pk_mul_f32 v[164:165], v[194:195], v[86:87] op_sel:[0,0] op_sel_hi:[1,0]
    v_pk_fma_f32 v[164:165], v[194:195], v[86:87], v[164:165] op_sel:[1,1,0] op_sel_hi:[0,1,1] neg_hi:[1,0,0]
    v_pk_mul_f32 v[230:231], v[240:241], v[88:89] op_sel:[0,0] op_sel_hi:[1,0]
    v_pk_fma_f32 v[230:231], v[240:241], v[88:89], v[230:231] op_sel:[1,1,0] op_sel_hi:[0,1,1] neg_hi:[1,0,0]
    v_pk_mul_f32 v[198:199], v[202:203], v[88:89] op_sel:[0,0] op_sel_hi:[1,0]
    v_pk_fma_f32 v[198:199], v[202:203], v[88:89], v[198:199] op_sel:[1,1,0] op_sel_hi:[0,1,1] neg_hi:[1,0,0]
    v_lshlrev_b32 v13, 3, v0
    ds_write_b64 v13, v[208:209] offset:0
    ds_write_b64 v13, v[162:163] offset:17408
    ds_write_b64 v13, v[250:251] offset:2176
    ds_write_b64 v13, v[224:225] offset:19584
    ds_write_b64 v13, v[158:159] offset:4352
    ds_write_b64 v13, v[238:239] offset:21760
    ds_write_b64 v13, v[168:169] offset:6528
    ds_write_b64 v13, v[174:175] offset:23936
    ds_write_b64 v13, v[166:167] offset:8704
    ds_write_b64 v13, v[178:179] offset:26112
    ds_write_b64 v13, v[218:219] offset:10880
    ds_write_b64 v13, v[206:207] offset:28288
    ds_write_b64 v13, v[242:243] offset:13056
    ds_write_b64 v13, v[164:165] offset:30464
    ds_write_b64 v13, v[230:231] offset:15232
    ds_write_b64 v13, v[198:199] offset:32640
    v_lshrrev_b32 v14, 4, v3
    v_mul_u32_u24 v14, 272, v14
    v_add_u32 v14, v14, v7
    v_lshlrev_b32 v14, 3, v14
    v_add_u32 v14, s32, v14
    s_waitcnt lgkmcnt(0)
    s_barrier
    ds_read_b64 v[182:183], v14 offset:0
    ds_read_b64 v[188:189], v14 offset:128
    ds_read_b64 v[190:191], v14 offset:256
    ds_read_b64 v[246:247], v14 offset:384
    ds_read_b64 v[214:215], v14 offset:512
    ds_read_b64 v[196:197], v14 offset:640
    ds_read_b64 v[236:237], v14 offset:768
    ds_read_b64 v[184:185], v14 offset:896
    ds_read_b64 v[172:173], v14 offset:1024
    ds_read_b64 v[210:211], v14 offset:1152
    ds_read_b64 v[192:193], v14 offset:1280
    ds_read_b64 v[152:153], v14 offset:1408
    ds_read_b64 v[248:249], v14 offset:1536
    ds_read_b64 v[220:221], v14 offset:1664
    ds_read_b64 v[232:233], v14 offset:1792
    ds_read_b64 v[212:213], v14 offset:1920
    s_waitcnt lgkmcnt(0)
    v_pk_add_f32 v[160:161], v[182:183], v[172:173]
    v_pk_add_f32 v[172:173], v[182:183], v[172:173] neg_lo:[0,1] neg_hi:[0,1]
    v_pk_add_f32 v[186:187], v[188:189], v[210:211]
    v_pk_add_f32 v[210:211], v[188:189], v[210:211] neg_lo:[0,1] neg_hi:[0,1]
    v_mul_f32 v228, 0x3f6c835e, v210
    v_mul_f32 v229, 0x3ec3ef15, v210
    v_fmac_f32 v228, 0xbec3ef15, v211
    v_fmac_f32 v229, 0x3f6c835e, v211
    v_pk_add_f32 v[156:157], v[190:191], v[192:193]
    v_pk_add_f32 v[192:193], v[190:191], v[192:193] neg_lo:[0,1] neg_hi:[0,1]
    v_sub_f32 v180, v192, v193
    v_add_f32 v181, v192, v193
    v_mul_f32 v180, 0x3f3504f3, v180
    v_mul_f32 v181, 0x3f3504f3, v181
    v_pk_add_f32 v[200:201], v[246:247], v[152:153]
    v_pk_add_f32 v[152:153], v[246:247], v[152:153] neg_lo:[0,1] neg_hi:[0,1]
    v_mul_f32 v234, 0x3ec3ef15, v152
    v_mul_f32 v235, 0x3f6c835e, v152
    v_fmac_f32 v234, 0xbf6c835e, v153
    v_fmac_f32 v235, 0x3ec3ef15, v153
    v_pk_add_f32 v[244:245], v[214:215], v[248:249]
    v_sub_f32 v154, v249, v215
    v_sub_f32 v155, v214, v248
    v_pk_add_f32 v[176:177], v[196:197], v[220:221]
    v_pk_add_f32 v[220:221], v[196:197], v[220:221] neg_lo:[0,1] neg_hi:[0,1]
    v_mul_f32 v216, 0xbec3ef15, v220
    v_mul_f32 v217, 0x3f6c835e, v220
    v_fmac_f32 v216, 0xbf6c835e, v221
    v_fmac_f32 v217, 0xbec3ef15, v221
    v_pk_add_f32 v[170:171], v[236:237], v[232:233]
    v_pk_add_f32 v[232:233], v[236:237], v[232:233] neg_lo:[0,1] neg_hi:[0,1]
    v_add_f32 v204, v232, v233
    v_sub_f32 v205, v232, v233
    v_mul_f32 v204, 0xbf3504f3, v204
    v_mul_f32 v205, 0x3f3504f3, v205
    v_pk_add_f32 v[222:223], v[184:185], v[212:213]
    v_pk_add_f32 v[212:213], v[184:185], v[212:213] neg_lo:[0,1] neg_hi:[0,1]
    v_mul_f32 v226, 0xbf6c835e, v212
    v_mul_f32 v227, 0x3ec3ef15, v212
    v_fmac_f32 v226, 0xbec3ef15, v213
    v_fmac_f32 v227, 0xbf6c835e, v213
    v_pk_add_f32 v[194:195], v[160:161], v[244:245]
    v_pk_add_f32 v[244:245], v[160:161], v[244:245] neg_lo:[0,1] neg_hi:[0,1]
    v_pk_add_f32 v[240:241], v[186:187], v[176:177]
    v_pk_add_f32 v[176:177], v[186:187], v[176:177] neg_lo:[0,1] neg_hi:[0,1]
    v_sub_f32 v202, v176, v177
    v_add_f32 v203, v176, v177
    v_mul_f32 v202, 0x3f3504f3, v202
    v_mul_f32 v203, 0x3f3504f3, v203
    v_pk_add_f32 v[208:209], v[156:157], v[170:171]
    v_sub_f32 v162, v171, v157
    v_sub_f32 v163, v156, v170
    v_pk_add_f32 v[250:251], v[200:201], v[222:223]
    v_pk_add_f32 v[222:223], v[200:201], v[222:223] neg_lo:[0,1] neg_hi:[0,1]
    v_add_f32 v224, v222, v223
    v_sub_f32 v225, v222, v223
    v_mul_f32 v224, 0xbf3504f3, v224
    v_mul_f32 v225, 0x3f3504f3, v225
    v_pk_add_f32 v[158:159], v[194:195], v[208:209]
    v_pk_add_f32 v[208:209], v[194:195], v[208:209] neg_lo:[0,1] neg_hi:[0,1]
    v_pk_add_f32 v[238:239], v[240:241], v[250:251]
    v_sub_f32 v168, v251, v241
    v_sub_f32 v169, v240, v250
    v_pk_add_f32 v[174:175], v[158:159], v[238:239]
    v_pk_add_f32 v[238:239], v[158:159], v[238:239] neg_lo:[0,1] neg_hi:[0,1]
    v_pk_add_f32 v[166:167], v[208:209], v[168:169]
    v_pk_add_f32 v[168:169], v[208:209], v[168:169] neg_lo:[0,1] neg_hi:[0,1]
    v_pk_add_f32 v[178:179], v[244:245], v[162:163]
    v_pk_add_f32 v[162:163], v[244:245], v[162:163] neg_lo:[0,1] neg_hi:[0,1]
    v_pk_add_f32 v[218:219], v[202:203], v[224:225]
    v_sub_f32 v206, v225, v203
    v_sub_f32 v207, v202, v224
    v_pk_add_f32 v[242:243], v[178:179], v[218:219]
    v_pk_add_f32 v[218:219], v[178:179], v[218:219] neg_lo:[0,1] neg_hi:[0,1]
    v_pk_add_f32 v[164:165], v[162:163], v[206:207]
    v_pk_add_f32 v[206:207], v[162:163], v[206:207] neg_lo:[0,1] neg_hi:[0,1]
    v_pk_add_f32 v[230:231], v[172:173], v[154:155]
    v_pk_add_f32 v[154:155], v[172:173], v[154:155] neg_lo:[0,1] neg_hi:[0,1]
    v_pk_add_f32 v[198:199], v[228:229], v[216:217]
    v_pk_add_f32 v[216:217], v[228:229], v[216:217] neg_lo:[0,1] neg_hi:[0,1]
    v_sub_f32 v182, v216, v217
    v_add_f32 v183, v216, v217
    v_mul_f32 v182, 0x3f3504f3, v182
    v_mul_f32 v183, 0x3f3504f3, v183
    v_pk_add_f32 v[188:189], v[180:181], v[204:205]
    v_sub_f32 v210, v205, v181
    v_sub_f32 v211, v180, v204
    v_pk_add_f32 v[190:191], v[234:235], v[226:227]
    v_pk_add_f32 v[226:227], v[234:235], v[226:227] neg_lo:[0,1] neg_hi:[0,1]
    v_add_f32 v192, v226, v227
    v_sub_f32 v193, v226, v227
    v_mul_f32 v192, 0xbf3504f3, v192
    v_mul_f32 v193, 0x3f3504f3, v193
    v_pk_add_f32 v[246:247], v[230:231], v[188:189]
    v_pk_add_f32 v[188:189], v[230:231], v[188:189] neg_lo:[0,1] neg_hi:[0,1]
    v_pk_add_f32 v[152:153], v[198:199], v[190:191]
    v_sub_f32 v214, v191, v199
    v_sub_f32 v215, v198, v190
    v_pk_add_f32 v[248:249], v[246:247], v[152:153]
    v_pk_add_f32 v[152:153], v[246:247], v[152:153] neg_lo:[0,1] neg_hi:[0,1]
    v_pk_add_f32 v[196:197], v[188:189], v[214:215]
    v_pk_add_f32 v[214:215], v[188:189], v[214:215] neg_lo:[0,1] neg_hi:[0,1]
    v_pk_add_f32 v[220:221], v[154:155], v[210:211]
    v_pk_add_f32 v[210:211], v[154:155], v[210:211] neg_lo:[0,1] neg_hi:[0,1]
    v_pk_add_f32 v[236:237], v[182:183], v[192:193]
    v_sub_f32 v232, v193, v183
    v_sub_f32 v233, v182, v192
    v_pk_add_f32 v[184:185], v[220:221], v[236:237]
    v_pk_add_f32 v[236:237], v[220:221], v[236:237] neg_lo:[0,1] neg_hi:[0,1]
    v_pk_add_f32 v[212:213], v[210:211], v[232:233]
    v_pk_add_f32 v[232:233], v[210:211], v[232:233] neg_lo:[0,1] neg_hi:[0,1]
    v_pk_mul_f32 v[160:161], v[248:249], v[90:91] op_sel:[0,0] op_sel_hi:[1,0]
    v_pk_fma_f32 v[160:161], v[248:249], v[90:91], v[160:161] op_sel:[1,1,0] op_sel_hi:[0,1,1] neg_hi:[1,0,0]
    v_pk_mul_f32 v[186:187], v[242:243], v[92:93] op_sel:[0,0] op_sel_hi:[1,0]
    v_pk_fma_f32 v[186:187], v[242:243], v[92:93], v[186:187] op_sel:[1,1,0] op_sel_hi:[0,1,1] neg_hi:[1,0,0]
    v_pk_mul_f32 v[176:177], v[184:185], v[94:95] op_sel:[0,0] op_sel_hi:[1,0]
    v_pk_fma_f32 v[176:177], v[184:185], v[94:95], v[176:177] op_sel:[1,1,0] op_sel_hi:[0,1,1] neg_hi:[1,0,0]
    v_pk_mul_f32 v[156:157], v[166:167], v[96:97] op_sel:[0,0] op_sel_hi:[1,0]
    v_pk_fma_f32 v[156:157], v[166:167], v[96:97], v[156:157] op_sel:[1,1,0] op_sel_hi:[0,1,1] neg_hi:[1,0,0]
    v_pk_mul_f32 v[170:171], v[196:197], v[98:99] op_sel:[0,0] op_sel_hi:[1,0]
    v_pk_fma_f32 v[170:171], v[196:197], v[98:99], v[170:171] op_sel:[1,1,0] op_sel_hi:[0,1,1] neg_hi:[1,0,0]
    v_pk_mul_f32 v[200:201], v[164:165], v[100:101] op_sel:[0,0] op_sel_hi:[1,0]
    v_pk_fma_f32 v[200:201], v[164:165], v[100:101], v[200:201] op_sel:[1,1,0] op_sel_hi:[0,1,1] neg_hi:[1,0,0]
    v_pk_mul_f32 v[222:223], v[212:213], v[102:103] op_sel:[0,0] op_sel_hi:[1,0]
    v_pk_fma_f32 v[222:223], v[212:213], v[102:103], v[222:223] op_sel:[1,1,0] op_sel_hi:[0,1,1] neg_hi:[1,0,0]
    v_pk_mul_f32 v[194:195], v[238:239], v[104:105] op_sel:[0,0] op_sel_hi:[1,0]
    v_pk_fma_f32 v[194:195], v[238:239], v[104:105], v[194:195] op_sel:[1,1,0] op_sel_hi:[0,1,1] neg_hi:[1,0,0]
    v_pk_mul_f32 v[240:241], v[152:153], v[106:107] op_sel:[0,0] op_sel_hi:[1,0]
    v_pk_fma_f32 v[240:241], v[152:153], v[106:107], v[240:241] op_sel:[1,1,0] op_sel_hi:[0,1,1] neg_hi:[1,0,0]
    v_pk_mul_f32 v[250:251], v[218:219], v[108:109] op_sel:[0,0] op_sel_hi:[1,0]
    v_pk_fma_f32 v[250:251], v[218:219], v[108:109], v[250:251] op_sel:[1,1,0] op_sel_hi:[0,1,1] neg_hi:[1,0,0]
    v_pk_mul_f32 v[158:159], v[236:237], v[110:111] op_sel:[0,0] op_sel_hi:[1,0]
    v_pk_fma_f32 v[158:159], v[236:237], v[110:111], v[158:159] op_sel:[1,1,0] op_sel_hi:[0,1,1] neg_hi:[1,0,0]
    v_pk_mul_f32 v[208:209], v[168:169], v[112:113] op_sel:[0,0] op_sel_hi:[1,0]
    v_pk_fma_f32 v[208:209], v[168:169], v[112:113], v[208:209] op_sel:[1,1,0] op_sel_hi:[0,1,1] neg_hi:[1,0,0]
    v_pk_mul_f32 v[244:245], v[214:215], v[114:115] op_sel:[0,0] op_sel_hi:[1,0]
    v_pk_fma_f32 v[244:245], v[214:215], v[114:115], v[244:245] op_sel:[1,1,0] op_sel_hi:[0,1,1] neg_hi:[1,0,0]
    v_pk_mul_f32 v[202:203], v[206:207], v[116:117] op_sel:[0,0] op_sel_hi:[1,0]
    v_pk_fma_f32 v[202:203], v[206:207], v[116:117], v[202:203] op_sel:[1,1,0] op_sel_hi:[0,1,1] neg_hi:[1,0,0]
    v_pk_mul_f32 v[224:225], v[232:233], v[118:119] op_sel:[0,0] op_sel_hi:[1,0]
    v_pk_fma_f32 v[224:225], v[232:233], v[118:119], v[224:225] op_sel:[1,1,0] op_sel_hi:[0,1,1] neg_hi:[1,0,0]
    v_mul_u32_u24 v13, 130, v7
    v_lshrrev_b32 v15, 4, v3
    v_add_u32 v13, v13, v15
    v_lshlrev_b32 v13, 3, v13
    v_add_u32 v13, s32, v13
    v_add_u32 v13, 34816, v13
    ds_write_b64 v13, v[174:175] offset:0
    ds_write_b64 v13, v[160:161] offset:64
    ds_write_b64 v13, v[186:187] offset:128
    ds_write_b64 v13, v[176:177] offset:192
    ds_write_b64 v13, v[156:157] offset:256
    ds_write_b64 v13, v[170:171] offset:320
    ds_write_b64 v13, v[200:201] offset:384
    ds_write_b64 v13, v[222:223] offset:448
    ds_write_b64 v13, v[194:195] offset:512
    ds_write_b64 v13, v[240:241] offset:576
    ds_write_b64 v13, v[250:251] offset:640
    ds_write_b64 v13, v[158:159] offset:704
    ds_write_b64 v13, v[208:209] offset:768
    ds_write_b64 v13, v[244:245] offset:832
    ds_write_b64 v13, v[202:203] offset:896
    ds_write_b64 v13, v[224:225] offset:960
    v_add_u32 v14, s32, v4
    v_add_u32 v14, 34816, v14
    s_waitcnt lgkmcnt(0)
    s_barrier
    ds_read_b64 v[178:179], v14 offset:0
    ds_read_b64 v[162:163], v14 offset:1040
    ds_read_b64 v[172:173], v14 offset:2080
    ds_read_b64 v[228:229], v14 offset:3120
    ds_read_b64 v[216:217], v14 offset:4160
    ds_read_b64 v[180:181], v14 offset:5200
    ds_read_b64 v[204:205], v14 offset:6240
    ds_read_b64 v[234:235], v14 offset:7280
    ds_read_b64 v[226:227], v14 offset:8320
    ds_read_b64 v[230:231], v14 offset:9360
    ds_read_b64 v[198:199], v14 offset:10400
    ds_read_b64 v[190:191], v14 offset:11440
    ds_read_b64 v[246:247], v14 offset:12480
    ds_read_b64 v[188:189], v14 offset:13520
    ds_read_b64 v[154:155], v14 offset:14560
    ds_read_b64 v[182:183], v14 offset:15600
    s_waitcnt lgkmcnt(0)
    v_pk_add_f32 v[192:193], v[178:179], v[226:227]
    v_pk_add_f32 v[226:227], v[178:179], v[226:227] neg_lo:[0,1] neg_hi:[0,1]
    v_pk_add_f32 v[220:221], v[162:163], v[230:231]
    v_pk_add_f32 v[230:231], v[162:163], v[230:231] neg_lo:[0,1] neg_hi:[0,1]
    v_mul_f32 v210, 0x3f6c835e, v230
    v_mul_f32 v211, 0x3ec3ef15, v230
    v_fmac_f32 v210, 0xbec3ef15, v231
    v_fmac_f32 v211, 0x3f6c835e, v231
    v_pk_add_f32 v[248:249], v[172:173], v[198:199]
    v_pk_add_f32 v[198:199], v[172:173], v[198:199] neg_lo:[0,1] neg_hi:[0,1]
    v_sub_f32 v242, v198, v199
    v_add_f32 v243, v198, v199
    v_mul_f32 v242, 0x3f3504f3, v242
    v_mul_f32 v243, 0x3f3504f3, v243
    v_pk_add_f32 v[184:185], v[228:229], v[190:191]
    v_pk_add_f32 v[190:191], v[228:229], v[190:191] neg_lo:[0,1] neg_hi:[0,1]
    v_mul_f32 v166, 0x3ec3ef15, v190
    v_mul_f32 v167, 0x3f6c835e, v190
    v_fmac_f32 v166, 0xbf6c835e, v191
    v_fmac_f32 v167, 0x3ec3ef15, v191
    v_pk_add_f32 v[196:197], v[216:217], v[246:247]
    v_sub_f32 v164, v247, v217
    v_sub_f32 v165, v216, v246
    v_pk_add_f32 v[212:213], v[180:181], v[188:189]
    v_pk_add_f32 v[188:189], v[180:181], v[188:189] neg_lo:[0,1] neg_hi:[0,1]
    v_mul_f32 v238, 0xbec3ef15, v188
    v_mul_f32 v239, 0x3f6c835e, v188
    v_fmac_f32 v238, 0xbf6c835e, v189
    v_fmac_f32 v239, 0xbec3ef15, v189
    v_pk_add_f32 v[152:153], v[204:205], v[154:155]
    v_pk_add_f32 v[154:155], v[204:205], v[154:155] neg_lo:[0,1] neg_hi:[0,1]
    v_add_f32 v218, v154, v155
    v_sub_f32 v219, v154, v155
    v_mul_f32 v218, 0xbf3504f3, v218
    v_mul_f32 v219, 0x3f3504f3, v219
    v_pk_add_f32 v[236:237], v[234:235], v[182:183]
    v_pk_add_f32 v[182:183], v[234:235], v[182:183] neg_lo:[0,1] neg_hi:[0,1]
    v_mul_f32 v168, 0xbf6c835e, v182
    v_mul_f32 v169, 0x3ec3ef15, v182
    v_fmac_f32 v168, 0xbec3ef15, v183
    v_fmac_f32 v169, 0xbf6c835e, v183
    v_pk_add_f32 v[214:215], v[192:193], v[196:197]
    v_pk_add_f32 v[196:197], v[192:193], v[196:197] neg_lo:[0,1] neg_hi:[0,1]
    v_pk_add_f32 v[206:207], v[220:221], v[212:213]
    v_pk_add_f32 v[212:213], v[220:221], v[212:213] neg_lo:[0,1] neg_hi:[0,1]
    v_sub_f32 v232, v212, v213
    v_add_f32 v233, v212, v213
    v_mul_f32 v232, 0x3f3504f3, v232
    v_mul_f32 v233, 0x3f3504f3, v233
    v_pk_add_f32 v[174:175], v[248:249], v[152:153]
    v_sub_f32 v160, v153, v249
    v_sub_f32 v161, v248, v152
    v_pk_add_f32 v[186:187], v[184:185], v[236:237]
    v_pk_add_f32 v[236:237], v[184:185], v[236:237] neg_lo:[0,1] neg_hi:[0,1]
    v_add_f32 v176, v236, v237
    v_sub_f32 v177, v236, v237
    v_mul_f32 v176, 0xbf3504f3, v176
    v_mul_f32 v177, 0x3f3504f3, v177
    v_pk_add_f32 v[156:157], v[214:215], v[174:175]
    v_pk_add_f32 v[174:175], v[214:215], v[174:175] neg_lo:[0,1] neg_hi:[0,1]
    v_pk_add_f32 v[170:171], v[206:207], v[186:187]
    v_sub_f32 v200, v187, v207
    v_sub_f32 v201, v206, v186
    v_pk_add_f32 v[222:223], v[156:157], v[170:171]
    v_pk_add_f32 v[170:171], v[156:157], v[170:171] neg_lo:[0,1] neg_hi:[0,1]
    v_pk_add_f32 v[194:195], v[174:175], v[200:201]
    v_pk_add_f32 v[200:201], v[174:175], v[200:201] neg_lo:[0,1] neg_hi:[0,1]
    v_pk_add_f32 v[240:241], v[196:197], v[160:161]
    v_pk_add_f32 v[160:161], v[196:197], v[160:161] neg_lo:[0,1] neg_hi:[0,1]
    v_pk_add_f32 v[250:251], v[232:233], v[176:177]
    v_sub_f32 v158, v177, v233
    v_sub_f32 v159, v232, v176
    v_pk_add_f32 v[208:209], v[240:241], v[250:251]
    v_pk_add_f32 v[250:251], v[240:241], v[250:251] neg_lo:[0,1] neg_hi:[0,1]
    v_pk_add_f32 v[244:245], v[160:161], v[158:159]
    v_pk_add_f32 v[158:159], v[160:161], v[158:159] neg_lo:[0,1] neg_hi:[0,1]
    v_pk_add_f32 v[202:203], v[226:227], v[164:165]
    v_pk_add_f32 v[164:165], v[226:227], v[164:165] neg_lo:[0,1] neg_hi:[0,1]
    v_pk_add_f32 v[224:225], v[210:211], v[238:239]
    v_pk_add_f32 v[238:239], v[210:211], v[238:239] neg_lo:[0,1] neg_hi:[0,1]
    v_sub_f32 v178, v238, v239
    v_add_f32 v179, v238, v239
    v_mul_f32 v178, 0x3f3504f3, v178
    v_mul_f32 v179, 0x3f3504f3, v179
    v_pk_add_f32 v[162:163], v[242:243], v[218:219]
    v_sub_f32 v230, v219, v243
    v_sub_f32 v231, v242, v218
    v_pk_add_f32 v[172:173], v[166:167], v[168:169]
    v_pk_add_f32 v[168:169], v[166:167], v[168:169] neg_lo:[0,1] neg_hi:[0,1]
    v_add_f32 v198, v168, v169
    v_sub_f32 v199, v168, v169
    v_mul_f32 v198, 0xbf3504f3, v198
    v_mul_f32 v199, 0x3f3504f3, v199
    v_pk_add_f32 v[228:229], v[202:203], v[162:163]
    v_pk_add_f32 v[162:163], v[202:203], v[162:163] neg_lo:[0,1] neg_hi:[0,1]
    v_pk_add_f32 v[190:191], v[224:225], v[172:173]
    v_sub_f32 v216, v173, v225
    v_sub_f32 v217, v224, v172
    v_pk_add_f32 v[246:247], v[228:229], v[190:191]
    v_pk_add_f32 v[190:191], v[228:229], v[190:191] neg_lo:[0,1] neg_hi:[0,1]
    v_pk_add_f32 v[180:181], v[162:163], v[216:217]
    v_pk_add_f32 v[216:217], v[162:163], v[216:217] neg_lo:[0,1] neg_hi:[0,1]
    v_pk_add_f32 v[188:189], v[164:165], v[230:231]
    v_pk_add_f32 v[230:231], v[164:165], v[230:231] neg_lo:[0,1] neg_hi:[0,1]
    v_pk_add_f32 v[204:205], v[178:179], v[198:199]
    v_sub_f32 v154, v199, v179
    v_sub_f32 v155, v178, v198
    v_pk_add_f32 v[234:235], v[188:189], v[204:205]
    v_pk_add_f32 v[204:205], v[188:189], v[204:205] neg_lo:[0,1] neg_hi:[0,1]
    v_pk_add_f32 v[182:183], v[230:231], v[154:155]
    v_pk_add_f32 v[154:155], v[230:231], v[154:155] neg_lo:[0,1] neg_hi:[0,1]
    v_mul_f32 v223, v12, v223
    v_mul_f32 v247, v12, v247
    v_mul_f32 v209, v12, v209
    v_mul_f32 v235, v12, v235
    v_mul_f32 v195, v12, v195
    v_mul_f32 v181, v12, v181
    v_mul_f32 v245, v12, v245
    v_mul_f32 v183, v12, v183
    v_mul_f32 v171, v12, v171
    v_mul_f32 v191, v12, v191
    v_mul_f32 v251, v12, v251
    v_mul_f32 v205, v12, v205
    v_mul_f32 v201, v12, v201
    v_mul_f32 v217, v12, v217
    v_mul_f32 v159, v12, v159
    v_mul_f32 v155, v12, v155
    s_cmp_eq_u32 s23, 0
    s_cbranch_scc1 k2_store
    s_cmp_eq_u32 s2, 0
    s_cbranch_scc1 k2_end
    s_cmp_eq_u32 s2, 256
    s_cbranch_scc1 k2_end
k2_store:
    s_cmp_eq_u32 s23, 0
    s_cselect_b32 s28, s2, s21
    s_lshl_b32 s28, s28, 14
    s_add_u32 s28, s28, 41943040
    buffer_store_dwordx2 v[222:223], v4, s[16:19], s28 offen offset:0
    buffer_store_dwordx2 v[246:247], v4, s[16:19], s28 offen offset:1024
    buffer_store_dwordx2 v[208:209], v4, s[16:19], s28 offen offset:2048
    buffer_store_dwordx2 v[234:235], v4, s[16:19], s28 offen offset:3072
    s_add_u32 s28, s28, 4096
    buffer_store_dwordx2 v[194:195], v4, s[16:19], s28 offen offset:0
    buffer_store_dwordx2 v[180:181], v4, s[16:19], s28 offen offset:1024
    buffer_store_dwordx2 v[244:245], v4, s[16:19], s28 offen offset:2048
    buffer_store_dwordx2 v[182:183], v4, s[16:19], s28 offen offset:3072
    s_add_u32 s28, s28, 4096
    buffer_store_dwordx2 v[170:171], v4, s[16:19], s28 offen offset:0
    buffer_store_dwordx2 v[190:191], v4, s[16:19], s28 offen offset:1024
    buffer_store_dwordx2 v[250:251], v4, s[16:19], s28 offen offset:2048
    buffer_store_dwordx2 v[204:205], v4, s[16:19], s28 offen offset:3072
    s_add_u32 s28, s28, 4096
    buffer_store_dwordx2 v[200:201], v4, s[16:19], s28 offen offset:0
    buffer_store_dwordx2 v[216:217], v4, s[16:19], s28 offen offset:1024
    buffer_store_dwordx2 v[158:159], v4, s[16:19], s28 offen offset:2048
    buffer_store_dwordx2 v[154:155], v4, s[16:19], s28 offen offset:3072
    s_waitcnt vmcnt(0)
k2_end:
    s_endpgm

.globl k3_kernel
.p2align 8
.type k3_kernel,@function
k3_kernel:
    s_cmp_ge_u32 s2, 256
    s_cbranch_scc1 k3_end
    s_load_dwordx2 s[4:5], s[0:1], 0
    s_load_dwordx2 s[8:9], s[0:1], 56
    s_load_dwordx2 s[6:7], s[0:1], 72
    v_and_b32 v1, 63, v0
    v_lshrrev_b32 v2, 6, v0
    s_nop 0
    v_readfirstlane_b32 s22, v2
    s_getpc_b64 s[24:25]
    s_add_u32 s24, s24, twtab@rel32@lo+4
    s_addc_u32 s25, s25, twtab@rel32@hi+12
    s_mov_b32 s26, 16384
    s_mov_b32 s27, 0x00020000
    s_waitcnt lgkmcnt(0)
    s_mov_b32 s16, s6
    s_mov_b32 s17, s7
    s_mov_b32 s18, 268435456
    s_mov_b32 s19, 0x00020000
    s_mov_b32 s12, s4
    s_mov_b32 s13, s5
    s_mov_b32 s14, 4194304
    s_mov_b32 s15, 0x00020000
    s_mov_b32 s36, s8
    s_mov_b32 s37, s9
    s_mov_b32 s38, 4194304
    s_mov_b32 s39, 0x00020000
    s_and_b32 s20, s2, 7
    s_lshl_b32 s20, s20, 5
    s_lshr_b32 s21, s2, 3
    s_add_u32 s20, s20, s21
    s_lshl_b32 s20, s20, 3
    s_add_u32 s21, s20, s22
    v_lshrrev_b32 v4, 2, v0
    v_and_b32 v5, 3, v0
    v_lshlrev_b32 v6, 14, v4
    v_lshlrev_b32 v7, 4, v5
    v_add_u32 v6, v6, v7
    s_lshl_b32 s35, s20, 3
    s_add_u32 s35, s35, 41943040
    buffer_load_dwordx4 v[48:51], v6, s[16:19], s35 offen
    s_add_u32 s35, s35, 2097152
    buffer_load_dwordx4 v[52:55], v6, s[16:19], s35 offen
    s_add_u32 s35, s35, 2097152
    buffer_load_dwordx4 v[56:59], v6, s[16:19], s35 offen
    s_add_u32 s35, s35, 2097152
    buffer_load_dwordx4 v[60:63], v6, s[16:19], s35 offen
    v_lshlrev_b32 v3, 2, v1
    s_lshl_b32 s23, s21, 11
    s_add_u32 s31, s23, 20971520
    buffer_load_dword v16, v3, s[12:15], s23 offen offset:0
    buffer_load_dword v24, v3, s[16:19], s31 offen offset:0
    buffer_load_dword v17, v3, s[12:15], s23 offen offset:256
    buffer_load_dword v25, v3, s[16:19], s31 offen offset:256
    buffer_load_dword v18, v3, s[12:15], s23 offen offset:512
    buffer_load_dword v26, v3, s[16:19], s31 offen offset:512
    buffer_load_dword v19, v3, s[12:15], s23 offen offset:768
    buffer_load_dword v27, v3, s[16:19], s31 offen offset:768
    buffer_load_dword v20, v3, s[12:15], s23 offen offset:1024
    buffer_load_dword v28, v3, s[16:19], s31 offen offset:1024
    buffer_load_dword v21, v3, s[12:15], s23 offen offset:1280
    buffer_load_dword v29, v3, s[16:19], s31 offen offset:1280
    buffer_load_dword v22, v3, s[12:15], s23 offen offset:1536
    buffer_load_dword v30, v3, s[16:19], s31 offen offset:1536
    buffer_load_dword v23, v3, s[12:15], s23 offen offset:1792
    buffer_load_dword v31, v3, s[16:19], s31 offen offset:1792
    v_mul_u32_u24 v8, 4, v1
    v_and_b32 v8, 2047, v8
    v_lshlrev_b32 v8, 3, v8
    buffer_load_dwordx2 v[96:97], v8, s[24:27], 0 offen
    v_mul_u32_u24 v8, 8, v1
    v_and_b32 v8, 2047, v8
    v_lshlrev_b32 v8, 3, v8
    buffer_load_dwordx2 v[98:99], v8, s[24:27], 0 offen
    v_mul_u32_u24 v8, 12, v1
    v_and_b32 v8, 2047, v8
    v_lshlrev_b32 v8, 3, v8
    buffer_load_dwordx2 v[100:101], v8, s[24:27], 0 offen
    v_mul_u32_u24 v8, 16, v1
    v_and_b32 v8, 2047, v8
    v_lshlrev_b32 v8, 3, v8
    buffer_load_dwordx2 v[102:103], v8, s[24:27], 0 offen
    v_mul_u32_u24 v8, 20, v1
    v_and_b32 v8, 2047, v8
    v_lshlrev_b32 v8, 3, v8
    buffer_load_dwordx2 v[104:105], v8, s[24:27], 0 offen
    v_mul_u32_u24 v8, 24, v1
    v_and_b32 v8, 2047, v8
    v_lshlrev_b32 v8, 3, v8
    buffer_load_dwordx2 v[106:107], v8, s[24:27], 0 offen
    v_mul_u32_u24 v8, 28, v1
    v_and_b32 v8, 2047, v8
    v_lshlrev_b32 v8, 3, v8
    buffer_load_dwordx2 v[108:109], v8, s[24:27], 0 offen
    v_and_b32 v9, 7, v1
    v_mul_u32_u24 v8, 32, v9
    v_and_b32 v8, 2047, v8
    v_lshlrev_b32 v8, 3, v8
    buffer_load_dwordx2 v[112:113], v8, s[24:27], 0 offen
    v_mul_u32_u24 v8, 64, v9
    v_and_b32 v8, 2047, v8
    v_lshlrev_b32 v8, 3, v8
    buffer_load_dwordx2 v[114:115], v8, s[24:27], 0 offen
    v_mul_u32_u24 v8, 96, v9
    v_and_b32 v8, 2047, v8
    v_lshlrev_b32 v8, 3, v8
    buffer_load_dwordx2 v[116:117], v8, s[24:27], 0 offen
    v_mul_u32_u24 v8, 128, v9
    v_and_b32 v8, 2047, v8
    v_lshlrev_b32 v8, 3, v8
    buffer_load_dwordx2 v[118:119], v8, s[24:27], 0 offen
    v_mul_u32_u24 v8, 160, v9
    v_and_b32 v8, 2047, v8
    v_lshlrev_b32 v8, 3, v8
    buffer_load_dwordx2 v[120:121], v8, s[24:27], 0 offen
    v_mul_u32_u24 v8, 192, v9
    v_and_b32 v8, 2047, v8
    v_lshlrev_b32 v8, 3, v8
    buffer_load_dwordx2 v[122:123], v8, s[24:27], 0 offen
    v_mul_u32_u24 v8, 224, v9
    v_and_b32 v8, 2047, v8
    v_lshlrev_b32 v8, 3, v8
    buffer_load_dwordx2 v[124:125], v8, s[24:27], 0 offen
    v_mul_u32_u24 v6, 8256, v5
    v_lshlrev_b32 v7, 3, v4
    v_add_u32 v6, v6, v7
    v_add_u32 v6, 40960, v6
    s_waitcnt vmcnt(33)
    ds_write_b64 v6, v[48:49] offset:0
    ds_write_b64 v6, v[50:51] offset:4128
    s_waitcnt vmcnt(32)
    ds_write_b64 v6, v[52:53] offset:1024
    ds_write_b64 v6, v[54:55] offset:5152
    s_waitcnt vmcnt(31)
    ds_write_b64 v6, v[56:57] offset:2048
    ds_write_b64 v6, v[58:59] offset:6176
    s_waitcnt vmcnt(30)
    ds_write_b64 v6, v[60:61] offset:3072
    ds_write_b64 v6, v[62:63] offset:7200
    s_waitcnt lgkmcnt(0)
    s_barrier
    s_mul_i32 s34, s22, 4128
    s_add_u32 s34, s34, 40960
    v_lshlrev_b32 v4, 3, v1
    v_add_u32 v7, s34, v4
    ds_read_b64 v[32:33], v7 offset:0
    ds_read_b64 v[34:35], v7 offset:512
    ds_read_b64 v[36:37], v7 offset:1024
    ds_read_b64 v[38:39], v7 offset:1536
    ds_read_b64 v[40:41], v7 offset:2048
    ds_read_b64 v[42:43], v7 offset:2560
    ds_read_b64 v[44:45], v7 offset:3072
    ds_read_b64 v[46:47], v7 offset:3584
    s_waitcnt lgkmcnt(0)
    v_pk_add_f32 v[48:49], v[32:33], v[40:41]
    v_pk_add_f32 v[40:41], v[32:33], v[40:41] neg_lo:[0,1] neg_hi:[0,1]
    v_pk_add_f32 v[50:51], v[34:35], v[42:43]
    v_pk_add_f32 v[42:43], v[34:35], v[42:43] neg_lo:[0,1] neg_hi:[0,1]
    v_sub_f32 v52, v42, v43
    v_add_f32 v53, v42, v43
    v_mul_f32 v52, 0x3f3504f3, v52
    v_mul_f32 v53, 0x3f3504f3, v53
    v_pk_add_f32 v[54:55], v[36:37], v[44:45]
    v_sub_f32 v56, v45, v37
    v_sub_f32 v57, v36, v44
    v_pk_add_f32 v[58:59], v[38:39], v[46:47]
    v_pk_add_f32 v[46:47], v[38:39], v[46:47] neg_lo:[0,1] neg_hi:[0,1]
    v_add_f32 v60, v46, v47
    v_sub_f32 v61, v46, v47
    v_mul_f32 v60, 0xbf3504f3, v60
    v_mul_f32 v61, 0x3f3504f3, v61
    v_pk_add_f32 v[62:63], v[48:49], v[54:55]
    v_pk_add_f32 v[54:55], v[48:49], v[54:55] neg_lo:[0,1] neg_hi:[0,1]
    v_pk_add_f32 v[64:65], v[50:51], v[58:59]
    v_sub_f32 v66, v59, v51
    v_sub_f32 v67, v50, v58
    v_pk_add_f32 v[68:69], v[62:63], v[64:65]
    v_pk_add_f32 v[64:65], v[62:63], v[64:65] neg_lo:[0,1] neg_hi:[0,1]
    v_pk_add_f32 v[70:71], v[54:55], v[66:67]
    v_pk_add_f32 v[66:67], v[54:55], v[66:67] neg_lo:[0,1] neg_hi:[0,1]
    v_pk_add_f32 v[72:73], v[40:41], v[56:57]
    v_pk_add_f32 v[56:57], v[40:41], v[56:57] neg_lo:[0,1] neg_hi:[0,1]
    v_pk_add_f32 v[74:75], v[52:53], v[60:61]
    v_sub_f32 v76, v61, v53
    v_sub_f32 v77, v52, v60
    v_pk_add_f32 v[78:79], v[72:73], v[74:75]
    v_pk_add_f32 v[74:75], v[72:73], v[74:75] neg_lo:[0,1] neg_hi:[0,1]
    v_pk_add_f32 v[80:81], v[56:57], v[76:77]
    v_pk_add_f32 v[76:77], v[56:57], v[76:77] neg_lo:[0,1] neg_hi:[0,1]
    s_waitcnt vmcnt(7)
    v_pk_mul_f32 v[82:83], v[78:79], v[96:97] op_sel:[0,0] op_sel_hi:[1,0]
    v_pk_fma_f32 v[82:83], v[78:79], v[96:97], v[82:83] op_sel:[1,1,0] op_sel_hi:[0,1,1] neg_hi:[1,0,0]
    v_pk_mul_f32 v[84:85], v[70:71], v[98:99] op_sel:[0,0] op_sel_hi:[1,0]
    v_pk_fma_f32 v[84:85], v[70:71], v[98:99], v[84:85] op_sel:[1,1,0] op_sel_hi:[0,1,1] neg_hi:[1,0,0]
    v_pk_mul_f32 v[86:87], v[80:81], v[100:101] op_sel:[0,0] op_sel_hi:[1,0]
    v_pk_fma_f32 v[86:87], v[80:81], v[100:101], v[86:87] op_sel:[1,1,0] op_sel_hi:[0,1,1] neg_hi:[1,0,0]
    v_pk_mul_f32 v[88:89], v[64:65], v[102:103] op_sel:[0,0] op_sel_hi:[1,0]
    v_pk_fma_f32 v[88:89], v[64:65], v[102:103], v[88:89] op_sel:[1,1,0] op_sel_hi:[0,1,1] neg_hi:[1,0,0]
    v_pk_mul_f32 v[90:91], v[74:75], v[104:105] op_sel:[0,0] op_sel_hi:[1,0]
    v_pk_fma_f32 v[90:91], v[74:75], v[104:105], v[90:91] op_sel:[1,1,0] op_sel_hi:[0,1,1] neg_hi:[1,0,0]
    v_pk_mul_f32 v[92:93], v[66:67], v[106:107] op_sel:[0,0] op_sel_hi:[1,0]
    v_pk_fma_f32 v[92:93], v[66:67], v[106:107], v[92:93] op_sel:[1,1,0] op_sel_hi:[0,1,1] neg_hi:[1,0,0]
    v_pk_mul_f32 v[94:95], v[76:77], v[108:109] op_sel:[0,0] op_sel_hi:[1,0]
    v_pk_fma_f32 v[94:95], v[76:77], v[108:109], v[94:95] op_sel:[1,1,0] op_sel_hi:[0,1,1] neg_hi:[1,0,0]
    s_mul_i32 s33, s22, 5120
    v_add_u32 v4, s33, v4
    ds_write_b64 v4, v[68:69] offset:0
    ds_write_b64 v4, v[82:83] offset:576
    ds_write_b64 v4, v[84:85] offset:1152
    ds_write_b64 v4, v[86:87] offset:1728
    ds_write_b64 v4, v[88:89] offset:2304
    ds_write_b64 v4, v[90:91] offset:2880
    ds_write_b64 v4, v[92:93] offset:3456
    ds_write_b64 v4, v[94:95] offset:4032
    v_lshrrev_b32 v5, 3, v1
    v_mul_u32_u24 v5, 72, v5
    v_add_u32 v5, v5, v9
    v_lshlrev_b32 v5, 3, v5
    v_add_u32 v5, s33, v5
    s_waitcnt lgkmcnt(0)
    ds_read_b64 v[32:33], v5 offset:0
    ds_read_b64 v[34:35], v5 offset:64
    ds_read_b64 v[42:43], v5 offset:128
    ds_read_b64 v[36:37], v5 offset:192
    ds_read_b64 v[44:45], v5 offset:256
    ds_read_b64 v[38:39], v5 offset:320
    ds_read_b64 v[46:47], v5 offset:384
    ds_read_b64 v[48:49], v5 offset:448
    s_waitcnt lgkmcnt(0)
    v_pk_add_f32 v[50:51], v[32:33], v[44:45]
    v_pk_add_f32 v[44:45], v[32:33], v[44:45] neg_lo:[0,1] neg_hi:[0,1]
    v_pk_add_f32 v[58:59], v[34:35], v[38:39]
    v_pk_add_f32 v[38:39], v[34:35], v[38:39] neg_lo:[0,1] neg_hi:[0,1]
    v_sub_f32 v62, v38, v39
    v_add_f32 v63, v38, v39
    v_mul_f32 v62, 0x3f3504f3, v62
    v_mul_f32 v63, 0x3f3504f3, v63
    v_pk_add_f32 v[54:55], v[42:43], v[46:47]
    v_sub_f32 v40, v47, v43
    v_sub_f32 v41, v42, v46
    v_pk_add_f32 v[52:53], v[36:37], v[48:49]
    v_pk_add_f32 v[48:49], v[36:37], v[48:49] neg_lo:[0,1] neg_hi:[0,1]
    v_add_f32 v60, v48, v49
    v_sub_f32 v61, v48, v49
    v_mul_f32 v60, 0xbf3504f3, v60
    v_mul_f32 v61, 0x3f3504f3, v61
    v_pk_add_f32 v[72:73], v[50:51], v[54:55]
    v_pk_add_f32 v[54:55], v[50:51], v[54:55] neg_lo:[0,1] neg_hi:[0,1]
    v_pk_add_f32 v[56:57], v[58:59], v[52:53]
    v_sub_f32 v78, v53, v59
    v_sub_f32 v79, v58, v52
    v_pk_add_f32 v[70:71], v[72:73], v[56:57]
    v_pk_add_f32 v[56:57], v[72:73], v[56:57] neg_lo:[0,1] neg_hi:[0,1]
    v_pk_add_f32 v[80:81], v[54:55], v[78:79]
    v_pk_add_f32 v[78:79], v[54:55], v[78:79] neg_lo:[0,1] neg_hi:[0,1]
    v_pk_add_f32 v[64:65], v[44:45], v[40:41]
    v_pk_add_f32 v[40:41], v[44:45], v[40:41] neg_lo:[0,1] neg_hi:[0,1]
    v_pk_add_f32 v[74:75], v[62:63], v[60:61]
    v_sub_f32 v66, v61, v63
    v_sub_f32 v67, v62, v60
    v_pk_add_f32 v[76:77], v[64:65], v[74:75]
    v_pk_add_f32 v[74:75], v[64:65], v[74:75] neg_lo:[0,1] neg_hi:[0,1]
    v_pk_add_f32 v[68:69], v[40:41], v[66:67]
    v_pk_add_f32 v[66:67], v[40:41], v[66:67] neg_lo:[0,1] neg_hi:[0,1]
    s_waitcnt vmcnt(0)
    v_pk_mul_f32 v[82:83], v[76:77], v[112:113] op_sel:[0,0] op_sel_hi:[1,0]
    v_pk_fma_f32 v[82:83], v[76:77], v[112:113], v[82:83] op_sel:[1,1,0] op_sel_hi:[0,1,1] neg_hi:[1,0,0]
    v_pk_mul_f32 v[84:85], v[80:81], v[114:115] op_sel:[0,0] op_sel_hi:[1,0]
    v_pk_fma_f32 v[84:85], v[80:81], v[114:115], v[84:85] op_sel:[1,1,0] op_sel_hi:[0,1,1] neg_hi:[1,0,0]
    v_pk_mul_f32 v[86:87], v[68:69], v[116:117] op_sel:[0,0] op_sel_hi:[1,0]
    v_pk_fma_f32 v[86:87], v[68:69], v[116:117], v[86:87] op_sel:[1,1,0] op_sel_hi:[0,1,1] neg_hi:[1,0,0]
    v_pk_mul_f32 v[88:89], v[56:57], v[118:119] op_sel:[0,0] op_sel_hi:[1,0]
    v_pk_fma_f32 v[88:89], v[56:57], v[118:119], v[88:89] op_sel:[1,1,0] op_sel_hi:[0,1,1] neg_hi:[1,0,0]
    v_pk_mul_f32 v[90:91], v[74:75], v[120:121] op_sel:[0,0] op_sel_hi:[1,0]
    v_pk_fma_f32 v[90:91], v[74:75], v[120:121], v[90:91] op_sel:[1,1,0] op_sel_hi:[0,1,1] neg_hi:[1,0,0]
    v_pk_mul_f32 v[92:93], v[78:79], v[122:123] op_sel:[0,0] op_sel_hi:[1,0]
    v_pk_fma_f32 v[92:93], v[78:79], v[122:123], v[92:93] op_sel:[1,1,0] op_sel_hi:[0,1,1] neg_hi:[1,0,0]
    v_pk_mul_f32 v[94:95], v[66:67], v[124:125] op_sel:[0,0] op_sel_hi:[1,0]
    v_pk_fma_f32 v[94:95], v[66:67], v[124:125], v[94:95] op_sel:[1,1,0] op_sel_hi:[0,1,1] neg_hi:[1,0,0]
    v_mul_u32_u24 v6, 74, v9
    v_lshrrev_b32 v7, 3, v1
    v_add_u32 v6, v6, v7
    v_lshlrev_b32 v6, 3, v6
    v_add_u32 v6, s33, v6
    ds_write_b64 v6, v[70:71] offset:0
    ds_write_b64 v6, v[82:83] offset:64
    ds_write_b64 v6, v[84:85] offset:128
    ds_write_b64 v6, v[86:87] offset:192
    ds_write_b64 v6, v[88:89] offset:256
    ds_write_b64 v6, v[90:91] offset:320
    ds_write_b64 v6, v[92:93] offset:384
    ds_write_b64 v6, v[94:95] offset:448
    s_waitcnt lgkmcnt(0)
    ds_read_b64 v[32:33], v4 offset:0
    ds_read_b64 v[34:35], v4 offset:592
    ds_read_b64 v[38:39], v4 offset:1184
    ds_read_b64 v[42:43], v4 offset:1776
    ds_read_b64 v[46:47], v4 offset:2368
    ds_read_b64 v[36:37], v4 offset:2960
    ds_read_b64 v[48:49], v4 offset:3552
    ds_read_b64 v[50:51], v4 offset:4144
    s_waitcnt lgkmcnt(0)
    v_pk_add_f32 v[58:59], v[32:33], v[46:47]
    v_pk_add_f32 v[46:47], v[32:33], v[46:47] neg_lo:[0,1] neg_hi:[0,1]
    v_pk_add_f32 v[52:53], v[34:35], v[36:37]
    v_pk_add_f32 v[36:37], v[34:35], v[36:37] neg_lo:[0,1] neg_hi:[0,1]
    v_sub_f32 v72, v36, v37
    v_add_f32 v73, v36, v37
    v_mul_f32 v72, 0x3f3504f3, v72
    v_mul_f32 v73, 0x3f3504f3, v73
    v_pk_add_f32 v[54:55], v[38:39], v[48:49]
    v_sub_f32 v44, v49, v39
    v_sub_f32 v45, v38, v48
    v_pk_add_f32 v[62:63], v[42:43], v[50:51]
    v_pk_add_f32 v[50:51], v[42:43], v[50:51] neg_lo:[0,1] neg_hi:[0,1]
    v_add_f32 v60, v50, v51
    v_sub_f32 v61, v50, v51
    v_mul_f32 v60, 0xbf3504f3, v60
    v_mul_f32 v61, 0x3f3504f3, v61
    v_pk_add_f32 v[64:65], v[58:59], v[54:55]
    v_pk_add_f32 v[54:55], v[58:59], v[54:55] neg_lo:[0,1] neg_hi:[0,1]
    v_pk_add_f32 v[40:41], v[52:53], v[62:63]
    v_sub_f32 v76, v63, v53
    v_sub_f32 v77, v52, v62
    v_pk_add_f32 v[80:81], v[64:65], v[40:41]
    v_pk_add_f32 v[40:41], v[64:65], v[40:41] neg_lo:[0,1] neg_hi:[0,1]
    v_pk_add_f32 v[68:69], v[54:55], v[76:77]
    v_pk_add_f32 v[76:77], v[54:55], v[76:77] neg_lo:[0,1] neg_hi:[0,1]
    v_pk_add_f32 v[56:57], v[46:47], v[44:45]
    v_pk_add_f32 v[44:45], v[46:47], v[44:45] neg_lo:[0,1] neg_hi:[0,1]
    v_pk_add_f32 v[74:75], v[72:73], v[60:61]
    v_sub_f32 v78, v61, v73
    v_sub_f32 v79, v72, v60
    v_pk_add_f32 v[66:67], v[56:57], v[74:75]
    v_pk_add_f32 v[74:75], v[56:57], v[74:75] neg_lo:[0,1] neg_hi:[0,1]
    v_pk_add_f32 v[70:71], v[44:45], v[78:79]
    v_pk_add_f32 v[78:79], v[44:45], v[78:79] neg_lo:[0,1] neg_hi:[0,1]
    s_mov_b32 s30, 0x34800000
    s_mov_b32 s32, 0xffff0000
    v_mul_f32 v80, s30, v80
    v_mul_f32 v81, s30, v81
    v_cvt_pk_bf16_f32 v10, v80, v81
    v_lshlrev_b32 v80, 16, v10
    v_and_b32 v81, s32, v10
    v_lshlrev_b32 v11, 16, v24
    v_and_b32 v12, s32, v24
    v_mul_f32 v80, v80, v11
    v_mul_f32 v81, v81, v12
    v_cvt_pk_bf16_f32 v10, v80, v81
    v_lshlrev_b32 v80, 16, v10
    v_and_b32 v81, s32, v10
    v_lshlrev_b32 v11, 16, v16
    v_and_b32 v12, s32, v16
    v_add_f32 v80, v11, v80
    v_add_f32 v81, v12, v81
    v_cvt_pk_bf16_f32 v16, v80, v81
    buffer_store_dword v16, v3, s[36:39], s23 offen offset:0
    v_mul_f32 v66, s30, v66
    v_mul_f32 v67, s30, v67
    v_cvt_pk_bf16_f32 v10, v66, v67
    v_lshlrev_b32 v66, 16, v10
    v_and_b32 v67, s32, v10
    v_lshlrev_b32 v11, 16, v25
    v_and_b32 v12, s32, v25
    v_mul_f32 v66, v66, v11
    v_mul_f32 v67, v67, v12
    v_cvt_pk_bf16_f32 v10, v66, v67
    v_lshlrev_b32 v66, 16, v10
    v_and_b32 v67, s32, v10
    v_lshlrev_b32 v11, 16, v17
    v_and_b32 v12, s32, v17
    v_add_f32 v66, v11, v66
    v_add_f32 v67, v12, v67
    v_cvt_pk_bf16_f32 v17, v66, v67
    buffer_store_dword v17, v3, s[36:39], s23 offen offset:256
    v_mul_f32 v68, s30, v68
    v_mul_f32 v69, s30, v69
    v_cvt_pk_bf16_f32 v10, v68, v69
    v_lshlrev_b32 v68, 16, v10
    v_and_b32 v69, s32, v10
    v_lshlrev_b32 v11, 16, v26
    v_and_b32 v12, s32, v26
    v_mul_f32 v68, v68, v11
    v_mul_f32 v69, v69, v12
    v_cvt_pk_bf16_f32 v10, v68, v69
    v_lshlrev_b32 v68, 16, v10
    v_and_b32 v69, s32, v10
    v_lshlrev_b32 v11, 16, v18
    v_and_b32 v12, s32, v18
    v_add_f32 v68, v11, v68
    v_add_f32 v69, v12, v69
    v_cvt_pk_bf16_f32 v18, v68, v69
    buffer_store_dword v18, v3, s[36:39], s23 offen offset:512
    v_mul_f32 v70, s30, v70
    v_mul_f32 v71, s30, v71
    v_cvt_pk_bf16_f32 v10, v70, v71
    v_lshlrev_b32 v70, 16, v10
    v_and_b32 v71, s32, v10
    v_lshlrev_b32 v11, 16, v27
    v_and_b32 v12, s32, v27
    v_mul_f32 v70, v70, v11
    v_mul_f32 v71, v71, v12
    v_cvt_pk_bf16_f32 v10, v70, v71
    v_lshlrev_b32 v70, 16, v10
    v_and_b32 v71, s32, v10
    v_lshlrev_b32 v11, 16, v19
    v_and_b32 v12, s32, v19
    v_add_f32 v70, v11, v70
    v_add_f32 v71, v12, v71
    v_cvt_pk_bf16_f32 v19, v70, v71
    buffer_store_dword v19, v3, s[36:39], s23 offen offset:768
    v_mul_f32 v40, s30, v40
    v_mul_f32 v41, s30, v41
    v_cvt_pk_bf16_f32 v10, v40, v41
    v_lshlrev_b32 v40, 16, v10
    v_and_b32 v41, s32, v10
    v_lshlrev_b32 v11, 16, v28
    v_and_b32 v12, s32, v28
    v_mul_f32 v40, v40, v11
    v_mul_f32 v41, v41, v12
    v_cvt_pk_bf16_f32 v10, v40, v41
    v_lshlrev_b32 v40, 16, v10
    v_and_b32 v41, s32, v10
    v_lshlrev_b32 v11, 16, v20
    v_and_b32 v12, s32, v20
    v_add_f32 v40, v11, v40
    v_add_f32 v41, v12, v41
    v_cvt_pk_bf16_f32 v20, v40, v41
    buffer_store_dword v20, v3, s[36:39], s23 offen offset:1024
    v_mul_f32 v74, s30, v74
    v_mul_f32 v75, s30, v75
    v_cvt_pk_bf16_f32 v10, v74, v75
    v_lshlrev_b32 v74, 16, v10
    v_and_b32 v75, s32, v10
    v_lshlrev_b32 v11, 16, v29
    v_and_b32 v12, s32, v29
    v_mul_f32 v74, v74, v11
    v_mul_f32 v75, v75, v12
    v_cvt_pk_bf16_f32 v10, v74, v75
    v_lshlrev_b32 v74, 16, v10
    v_and_b32 v75, s32, v10
    v_lshlrev_b32 v11, 16, v21
    v_and_b32 v12, s32, v21
    v_add_f32 v74, v11, v74
    v_add_f32 v75, v12, v75
    v_cvt_pk_bf16_f32 v21, v74, v75
    buffer_store_dword v21, v3, s[36:39], s23 offen offset:1280
    v_mul_f32 v76, s30, v76
    v_mul_f32 v77, s30, v77
    v_cvt_pk_bf16_f32 v10, v76, v77
    v_lshlrev_b32 v76, 16, v10
    v_and_b32 v77, s32, v10
    v_lshlrev_b32 v11, 16, v30
    v_and_b32 v12, s32, v30
    v_mul_f32 v76, v76, v11
    v_mul_f32 v77, v77, v12
    v_cvt_pk_bf16_f32 v10, v76, v77
    v_lshlrev_b32 v76, 16, v10
    v_and_b32 v77, s32, v10
    v_lshlrev_b32 v11, 16, v22
    v_and_b32 v12, s32, v22
    v_add_f32 v76, v11, v76
    v_add_f32 v77, v12, v77
    v_cvt_pk_bf16_f32 v22, v76, v77
    buffer_store_dword v22, v3, s[36:39], s23 offen offset:1536
    v_mul_f32 v78, s30, v78
    v_mul_f32 v79, s30, v79
    v_cvt_pk_bf16_f32 v10, v78, v79
    v_lshlrev_b32 v78, 16, v10
    v_and_b32 v79, s32, v10
    v_lshlrev_b32 v11, 16, v31
    v_and_b32 v12, s32, v31
    v_mul_f32 v78, v78, v11
    v_mul_f32 v79, v79, v12
    v_cvt_pk_bf16_f32 v10, v78, v79
    v_lshlrev_b32 v78, 16, v10
    v_and_b32 v79, s32, v10
    v_lshlrev_b32 v11, 16, v23
    v_and_b32 v12, s32, v23
    v_add_f32 v78, v11, v78
    v_add_f32 v79, v12, v79
    v_cvt_pk_bf16_f32 v23, v78, v79
    buffer_store_dword v23, v3, s[36:39], s23 offen offset:1792
    s_waitcnt vmcnt(0)
k3_end:
    s_endpgm

.section .rodata,"a"
.p2align 6

.p2align 6
.amdhsa_kernel k1_kernel
  .amdhsa_next_free_vgpr 128
  .amdhsa_next_free_sgpr 40
  .amdhsa_accum_offset 128
  .amdhsa_group_segment_fixed_size 0
  .amdhsa_kernarg_size 80
  .amdhsa_user_sgpr_count 2
  .amdhsa_user_sgpr_kernarg_segment_ptr 1
  .amdhsa_system_sgpr_workgroup_id_x 1
.end_amdhsa_kernel

.p2align 6
.amdhsa_kernel gemm1_kernel
  .amdhsa_next_free_vgpr 248
  .amdhsa_next_free_sgpr 40
  .amdhsa_accum_offset 248
  .amdhsa_group_segment_fixed_size 0
  .amdhsa_kernarg_size 80
  .amdhsa_user_sgpr_count 2
  .amdhsa_user_sgpr_kernarg_segment_ptr 1
  .amdhsa_system_sgpr_workgroup_id_x 1
.end_amdhsa_kernel

.p2align 6
.amdhsa_kernel gemm2_kernel
  .amdhsa_next_free_vgpr 256
  .amdhsa_next_free_sgpr 40
  .amdhsa_accum_offset 256
  .amdhsa_group_segment_fixed_size 0
  .amdhsa_kernarg_size 80
  .amdhsa_user_sgpr_count 2
  .amdhsa_user_sgpr_kernarg_segment_ptr 1
  .amdhsa_system_sgpr_workgroup_id_x 1
.end_amdhsa_kernel

.p2align 6
.amdhsa_kernel k2_kernel
  .amdhsa_next_free_vgpr 256
  .amdhsa_next_free_sgpr 40
  .amdhsa_accum_offset 256
  .amdhsa_group_segment_fixed_size 0
  .amdhsa_kernarg_size 80
  .amdhsa_user_sgpr_count 2
  .amdhsa_user_sgpr_kernarg_segment_ptr 1
  .amdhsa_system_sgpr_workgroup_id_x 1
.end_amdhsa_kernel

.p2align 6
.amdhsa_kernel k3_kernel
  .amdhsa_next_free_vgpr 128
  .amdhsa_next_free_sgpr 44
  .amdhsa_accum_offset 128
  .amdhsa_group_segment_fixed_size 0
  .amdhsa_kernarg_size 80
  .amdhsa_user_sgpr_count 2
  .amdhsa_user_sgpr_kernarg_segment_ptr 1
  .amdhsa_system_sgpr_workgroup_id_x 1
.end_amdhsa_kernel

.p2align 8
.type twtab,@object
.size twtab, 16384
twtab:
.long 0x3f800000, 0x80000000
.long 0x3f7fffb1, 0xbb490fc6
.long 0x3f7ffec4, 0xbbc90f88
.long 0x3f7ffd39, 0xbc16cb58
.long 0x3f7ffb11, 0xbc490e90
.long 0x3f7ff84a, 0xbc7b514b
.long 0x3f7ff4e6, 0xbc96c9b6
.long 0x3f7ff0e3, 0xbcafea69
.long 0x3f7fec43, 0xbcc90ab0
.long 0x3f7fe705, 0xbce22a7a
.long 0x3f7fe129, 0xbcfb49ba
.long 0x3f7fdaaf, 0xbd0a342f
.long 0x3f7fd397, 0xbd16c32c
.long 0x3f7fcbe2, 0xbd2351cb
.long 0x3f7fc38f, 0xbd2fe007
.long 0x3f7fba9e, 0xbd3c6dd5
.long 0x3f7fb10f, 0xbd48fb30
.long 0x3f7fa6e3, 0xbd55880e
.long 0x3f7f9c18, 0xbd621469
.long 0x3f7f90b1, 0xbd6ea038
.long 0x3f7f84ab, 0xbd7b2b74
.long 0x3f7f7808, 0xbd83db0a
.long 0x3f7f6ac7, 0xbd8a200a
.long 0x3f7f5ce9, 0xbd9064b4
.long 0x3f7f4e6d, 0xbd96a905
.long 0x3f7f3f54, 0xbd9cecf9
.long 0x3f7f2f9d, 0xbda3308c
.long 0x3f7f1f49, 0xbda973ba
.long 0x3f7f0e58, 0xbdafb680
.long 0x3f7efcc9, 0xbdb5f8da
.long 0x3f7eea9d, 0xbdbc3ac3
.long 0x3f7ed7d4, 0xbdc27c39
.long 0x3f7ec46d, 0xbdc8bd36
.long 0x3f7eb069, 0xbdcefdb7
.long 0x3f7e9bc9, 0xbdd53db9
.long 0x3f7e868b, 0xbddb7d37
.long 0x3f7e70b0, 0xbde1bc2e
.long 0x3f7e5a38, 0xbde7fa9a
.long 0x3f7e4323, 0xbdee3876
.long 0x3f7e2b72, 0xbdf475c0
.long 0x3f7e1324, 0xbdfab273
.long 0x3f7dfa38, 0xbe007745
.long 0x3f7de0b1, 0xbe039502
.long 0x3f7dc68c, 0xbe06b26e
.long 0x3f7dabcc, 0xbe09cf86
.long 0x3f7d906e, 0xbe0cec4a
.long 0x3f7d7474, 0xbe1008b7
.long 0x3f7d57de, 0xbe1324ca
.long 0x3f7d3aac, 0xbe164083
.long 0x3f7d1cdd, 0xbe195be0
.long 0x3f7cfe73, 0xbe1c76de
.long 0x3f7cdf6c, 0xbe1f917b
.long 0x3f7cbfc9, 0xbe22abb6
.long 0x3f7c9f8a, 0xbe25c58c
.long 0x3f7c7eb0, 0xbe28defc
.long 0x3f7c5d3a, 0xbe2bf804
.long 0x3f7c3b28, 0xbe2f10a2
.long 0x3f7c187a, 0xbe3228d4
.long 0x3f7bf531, 0xbe354098
.long 0x3f7bd14d, 0xbe3857ec
.long 0x3f7baccd, 0xbe3b6ecf
.long 0x3f7b87b2, 0xbe3e853e
.long 0x3f7b61fc, 0xbe419b37
.long 0x3f7b3bab, 0xbe44b0b9
.long 0x3f7b14be, 0xbe47c5c2
.long 0x3f7aed37, 0xbe4ada4f
.long 0x3f7ac516, 0xbe4dee60
.long 0x3f7a9c59, 0xbe5101f1
.long 0x3f7a7302, 0xbe541501
.long 0x3f7a4910, 0xbe57278f
.long 0x3f7a1e84, 0xbe5a3997
.long 0x3f79f35e, 0xbe5d4b1a
.long 0x3f79c79d, 0xbe605c13
.long 0x3f799b43, 0xbe636c83
.long 0x3f796e4e, 0xbe667c66
.long 0x3f7940c0, 0xbe698bba
.long 0x3f791298, 0xbe6c9a7f
.long 0x3f78e3d6, 0xbe6fa8b2
.long 0x3f78b47b, 0xbe72b651
.long 0x3f788486, 0xbe75c35a
.long 0x3f7853f8, 0xbe78cfcc
.long 0x3f7822d1, 0xbe7bdba4
.long 0x3f77f110, 0xbe7ee6e1
.long 0x3f77beb7, 0xbe80f8c0
.long 0x3f778bc5, 0xbe827dc0
.long 0x3f77583a, 0xbe840270
.long 0x3f772417, 0xbe8586ce
.long 0x3f76ef5b, 0xbe870ada
.long 0x3f76ba07, 0xbe888e93
.long 0x3f76841b, 0xbe8a11f7
.long 0x3f764d97, 0xbe8b9507
.long 0x3f76167a, 0xbe8d17c0
.long 0x3f75dec6, 0xbe8e9a22
.long 0x3f75a67b, 0xbe901c2c
.long 0x3f756d97, 0xbe919ddd
.long 0x3f75341d, 0xbe931f35
.long 0x3f74fa0b, 0xbe94a031
.long 0x3f74bf62, 0xbe9620d2
.long 0x3f748422, 0xbe97a117
.long 0x3f74484b, 0xbe9920fe
.long 0x3f740bdd, 0xbe9aa086
.long 0x3f73ced9, 0xbe9c1faf
.long 0x3f73913f, 0xbe9d9e78
.long 0x3f73530e, 0xbe9f1cdf
.long 0x3f731447, 0xbea09ae5
.long 0x3f72d4eb, 0xbea21887
.long 0x3f7294f8, 0xbea395c5
.long 0x3f725470, 0xbea5129f
.long 0x3f721352, 0xbea68f12
.long 0x3f71d19f, 0xbea80b1f
.long 0x3f718f57, 0xbea986c4
.long 0x3f714c7a, 0xbeab0201
.long 0x3f710908, 0xbeac7cd4
.long 0x3f70c501, 0xbeadf73c
.long 0x3f708066, 0xbeaf713a
.long 0x3f703b37, 0xbeb0eacb
.long 0x3f6ff573, 0xbeb263ef
.long 0x3f6faf1b, 0xbeb3dca5
.long 0x3f6f6830, 0xbeb554ec
.long 0x3f6f20b0, 0xbeb6ccc3
.long 0x3f6ed89e, 0xbeb8442a
.long 0x3f6e8ff8, 0xbeb9bb1e
.long 0x3f6e46be, 0xbebb31a0
.long 0x3f6dfcf2, 0xbebca7af
.long 0x3f6db293, 0xbebe1d4a
.long 0x3f6d67a1, 0xbebf926f
.long 0x3f6d1c1d, 0xbec1071e
.long 0x3f6cd007, 0xbec27b55
.long 0x3f6c835e, 0xbec3ef15
.long 0x3f6c3624, 0xbec5625c
.long 0x3f6be858, 0xbec6d529
.long 0x3f6b99fb, 0xbec8477c
.long 0x3f6b4b0c, 0xbec9b953
.long 0x3f6afb8c, 0xbecb2aae
.long 0x3f6aab7b, 0xbecc9b8b
.long 0x3f6a5ad9, 0xbece0bea
.long 0x3f6a09a7, 0xbecf7bca
.long 0x3f69b7e4, 0xbed0eb2a
.long 0x3f696591, 0xbed25a09
.long 0x3f6912ae, 0xbed3c867
.long 0x3f68bf3c, 0xbed53641
.long 0x3f686b39, 0xbed6a399
.long 0x3f6816a8, 0xbed8106b
.long 0x3f67c187, 0xbed97cb9
.long 0x3f676bd8, 0xbedae880
.long 0x3f671599, 0xbedc53c1
.long 0x3f66becc, 0xbeddbe79
.long 0x3f666771, 0xbedf28a9
.long 0x3f660f88, 0xbee0924f
.long 0x3f65b710, 0xbee1fb6a
.long 0x3f655e0b, 0xbee363fa
.long 0x3f650479, 0xbee4cbfe
.long 0x3f64aa59, 0xbee63375
.long 0x3f644fac, 0xbee79a5d
.long 0x3f63f473, 0xbee900b7
.long 0x3f6398ac, 0xbeea6681
.long 0x3f633c5a, 0xbeebcbbb
.long 0x3f62df7b, 0xbeed3063
.long 0x3f628210, 0xbeee9479
.long 0x3f62241a, 0xbeeff7fb
.long 0x3f61c598, 0xbef15aea
.long 0x3f61668a, 0xbef2bd43
.long 0x3f6106f2, 0xbef41f07
.long 0x3f60a6cf, 0xbef58035
.long 0x3f604621, 0xbef6e0cb
.long 0x3f5fe4e9, 0xbef840c8
.long 0x3f5f8327, 0xbef9a02d
.long 0x3f5f20db, 0xbefafef7
.long 0x3f5ebe05, 0xbefc5d27
.long 0x3f5e5aa6, 0xbefdbabb
.long 0x3f5df6be, 0xbeff17b2
.long 0x3f5d924d, 0xbf003a06
.long 0x3f5d2d53, 0xbf00e7e4
.long 0x3f5cc7d1, 0xbf019573
.long 0x3f5c61c7, 0xbf0242b1
.long 0x3f5bfb34, 0xbf02ef9f
.long 0x3f5b941a, 0xbf039c3d
.long 0x3f5b2c79, 0xbf044889
.long 0x3f5ac450, 0xbf04f484
.long 0x3f5a5ba0, 0xbf05a02c
.long 0x3f59f26a, 0xbf064b82
.long 0x3f5988ad, 0xbf06f686
.long 0x3f591e6a, 0xbf07a136
.long 0x3f58b3a1, 0xbf084b92
.long 0x3f584853, 0xbf08f59b
.long 0x3f57dc7f, 0xbf099f4e
.long 0x3f577026, 0xbf0a48ad
.long 0x3f570348, 0xbf0af1b7
.long 0x3f5695e5, 0xbf0b9a6b
.long 0x3f5627fe, 0xbf0c42c9
.long 0x3f55b993, 0xbf0cead0
.long 0x3f554aa4, 0xbf0d9281
.long 0x3f54db31, 0xbf0e39da
.long 0x3f546b3b, 0xbf0ee0db
.long 0x3f53fac3, 0xbf0f8784
.long 0x3f5389c7, 0xbf102dd5
.long 0x3f531849, 0xbf10d3cd
.long 0x3f52a649, 0xbf11796b
.long 0x3f5233c6, 0xbf121eb0
.long 0x3f51c0c2, 0xbf12c39a
.long 0x3f514d3d, 0xbf13682a
.long 0x3f50d937, 0xbf140c5f
.long 0x3f5064af, 0xbf14b039
.long 0x3f4fefa8, 0xbf1553b7
.long 0x3f4f7a1f, 0xbf15f6d9
.long 0x3f4f0417, 0xbf16999f
.long 0x3f4e8d90, 0xbf173c07
.long 0x3f4e1689, 0xbf17de12
.long 0x3f4d9f02, 0xbf187fc0
.long 0x3f4d26fd, 0xbf19210f
.long 0x3f4cae79, 0xbf19c200
.long 0x3f4c3578, 0xbf1a6293
.long 0x3f4bbbf8, 0xbf1b02c6
.long 0x3f4b41fa, 0xbf1ba299
.long 0x3f4ac77f, 0xbf1c420c
.long 0x3f4a4c87, 0xbf1ce11f
.long 0x3f49d112, 0xbf1d7fd1
.long 0x3f495521, 0xbf1e1e22
.long 0x3f48d8b3, 0xbf1ebc12
.long 0x3f485bca, 0xbf1f599f
.long 0x3f47de65, 0xbf1ff6cb
.long 0x3f476085, 0xbf209393
.long 0x3f46e22a, 0xbf212ff9
.long 0x3f466354, 0xbf21cbfb
.long 0x3f45e403, 0xbf226799
.long 0x3f456439, 0xbf2302d3
.long 0x3f44e3f5, 0xbf239da9
.long 0x3f446337, 0xbf24381a
.long 0x3f43e200, 0xbf24d225
.long 0x3f436051, 0xbf256bcb
.long 0x3f42de29, 0xbf26050a
.long 0x3f425b89, 0xbf269de3
.long 0x3f41d870, 0xbf273656
.long 0x3f4154e1, 0xbf27ce61
.long 0x3f40d0da, 0xbf286605
.long 0x3f404c5c, 0xbf28fd41
.long 0x3f3fc767, 0xbf299415
.long 0x3f3f41fc, 0xbf2a2a80
.long 0x3f3ebc1b, 0xbf2ac082
.long 0x3f3e35c5, 0xbf2b561b
.long 0x3f3daef9, 0xbf2beb4a
.long 0x3f3d27b8, 0xbf2c800f
.long 0x3f3ca003, 0xbf2d1469
.long 0x3f3c17d9, 0xbf2da859
.long 0x3f3b8f3b, 0xbf2e3bde
.long 0x3f3b0629, 0xbf2ecef7
.long 0x3f3a7ca4, 0xbf2f61a5
.long 0x3f39f2ac, 0xbf2ff3e6
.long 0x3f396842, 0xbf3085bb
.long 0x3f38dd65, 0xbf311722
.long 0x3f385216, 0xbf31a81d
.long 0x3f37c655, 0xbf3238aa
.long 0x3f373a23, 0xbf32c8c9
.long 0x3f36ad7f, 0xbf33587a
.long 0x3f36206c, 0xbf33e7bc
.long 0x3f3592e7, 0xbf34768f
.long 0x3f3504f3, 0xbf3504f3
.long 0x3f34768f, 0xbf3592e7
.long 0x3f33e7bc, 0xbf36206c
.long 0x3f33587a, 0xbf36ad7f
.long 0x3f32c8c9, 0xbf373a23
.long 0x3f3238aa, 0xbf37c655
.long 0x3f31a81d, 0xbf385216
.long 0x3f311722, 0xbf38dd65
.long 0x3f3085bb, 0xbf396842
.long 0x3f2ff3e6, 0xbf39f2ac
.long 0x3f2f61a5, 0xbf3a7ca4
.long 0x3f2ecef7, 0xbf3b0629
.long 0x3f2e3bde, 0xbf3b8f3b
.long 0x3f2da859, 0xbf3c17d9
.long 0x3f2d1469, 0xbf3ca003
.long 0x3f2c800f, 0xbf3d27b8
.long 0x3f2beb4a, 0xbf3daef9
.long 0x3f2b561b, 0xbf3e35c5
.long 0x3f2ac082, 0xbf3ebc1b
.long 0x3f2a2a80, 0xbf3f41fc
.long 0x3f299415, 0xbf3fc767
.long 0x3f28fd41, 0xbf404c5c
.long 0x3f286605, 0xbf40d0da
.long 0x3f27ce61, 0xbf4154e1
.long 0x3f273656, 0xbf41d870
.long 0x3f269de3, 0xbf425b89
.long 0x3f26050a, 0xbf42de29
.long 0x3f256bcb, 0xbf436051
.long 0x3f24d225, 0xbf43e200
.long 0x3f24381a, 0xbf446337
.long 0x3f239da9, 0xbf44e3f5
.long 0x3f2302d3, 0xbf456439
.long 0x3f226799, 0xbf45e403
.long 0x3f21cbfb, 0xbf466354
.long 0x3f212ff9, 0xbf46e22a
.long 0x3f209393, 0xbf476085
.long 0x3f1ff6cb, 0xbf47de65
.long 0x3f1f599f, 0xbf485bca
.long 0x3f1ebc12, 0xbf48d8b3
.long 0x3f1e1e22, 0xbf495521
.long 0x3f1d7fd1, 0xbf49d112
.long 0x3f1ce11f, 0xbf4a4c87
.long 0x3f1c420c, 0xbf4ac77f
.long 0x3f1ba299, 0xbf4b41fa
.long 0x3f1b02c6, 0xbf4bbbf8
.long 0x3f1a6293, 0xbf4c3578
.long 0x3f19c200, 0xbf4cae79
.long 0x3f19210f, 0xbf4d26fd
.long 0x3f187fc0, 0xbf4d9f02
.long 0x3f17de12, 0xbf4e1689
.long 0x3f173c07, 0xbf4e8d90
.long 0x3f16999f, 0xbf4f0417
.long 0x3f15f6d9, 0xbf4f7a1f
.long 0x3f1553b7, 0xbf4fefa8
.long 0x3f14b039, 0xbf5064af
.long 0x3f140c5f, 0xbf50d937
.long 0x3f13682a, 0xbf514d3d
.long 0x3f12c39a, 0xbf51c0c2
.long 0x3f121eb0, 0xbf5233c6
.long 0x3f11796b, 0xbf52a649
.long 0x3f10d3cd, 0xbf531849
.long 0x3f102dd5, 0xbf5389c7
.long 0x3f0f8784, 0xbf53fac3
.long 0x3f0ee0db, 0xbf546b3b
.long 0x3f0e39da, 0xbf54db31
.long 0x3f0d9281, 0xbf554aa4
.long 0x3f0cead0, 0xbf55b993
.long 0x3f0c42c9, 0xbf5627fe
.long 0x3f0b9a6b, 0xbf5695e5
.long 0x3f0af1b7, 0xbf570348
.long 0x3f0a48ad, 0xbf577026
.long 0x3f099f4e, 0xbf57dc7f
.long 0x3f08f59b, 0xbf584853
.long 0x3f084b92, 0xbf58b3a1
.long 0x3f07a136, 0xbf591e6a
.long 0x3f06f686, 0xbf5988ad
.long 0x3f064b82, 0xbf59f26a
.long 0x3f05a02c, 0xbf5a5ba0
.long 0x3f04f484, 0xbf5ac450
.long 0x3f044889, 0xbf5b2c79
.long 0x3f039c3d, 0xbf5b941a
.long 0x3f02ef9f, 0xbf5bfb34
.long 0x3f0242b1, 0xbf5c61c7
.long 0x3f019573, 0xbf5cc7d1
.long 0x3f00e7e4, 0xbf5d2d53
.long 0x3f003a06, 0xbf5d924d
.long 0x3eff17b2, 0xbf5df6be
.long 0x3efdbabb, 0xbf5e5aa6
.long 0x3efc5d27, 0xbf5ebe05
.long 0x3efafef7, 0xbf5f20db
.long 0x3ef9a02d, 0xbf5f8327
.long 0x3ef840c8, 0xbf5fe4e9
.long 0x3ef6e0cb, 0xbf604621
.long 0x3ef58035, 0xbf60a6cf
.long 0x3ef41f07, 0xbf6106f2
.long 0x3ef2bd43, 0xbf61668a
.long 0x3ef15aea, 0xbf61c598
.long 0x3eeff7fb, 0xbf62241a
.long 0x3eee9479, 0xbf628210
.long 0x3eed3063, 0xbf62df7b
.long 0x3eebcbbb, 0xbf633c5a
.long 0x3eea6681, 0xbf6398ac
.long 0x3ee900b7, 0xbf63f473
.long 0x3ee79a5d, 0xbf644fac
.long 0x3ee63375, 0xbf64aa59
.long 0x3ee4cbfe, 0xbf650479
.long 0x3ee363fa, 0xbf655e0b
.long 0x3ee1fb6a, 0xbf65b710
.long 0x3ee0924f, 0xbf660f88
.long 0x3edf28a9, 0xbf666771
.long 0x3eddbe79, 0xbf66becc
.long 0x3edc53c1, 0xbf671599
.long 0x3edae880, 0xbf676bd8
.long 0x3ed97cb9, 0xbf67c187
.long 0x3ed8106b, 0xbf6816a8
.long 0x3ed6a399, 0xbf686b39
.long 0x3ed53641, 0xbf68bf3c
.long 0x3ed3c867, 0xbf6912ae
.long 0x3ed25a09, 0xbf696591
.long 0x3ed0eb2a, 0xbf69b7e4
.long 0x3ecf7bca, 0xbf6a09a7
.long 0x3ece0bea, 0xbf6a5ad9
.long 0x3ecc9b8b, 0xbf6aab7b
.long 0x3ecb2aae, 0xbf6afb8c
.long 0x3ec9b953, 0xbf6b4b0c
.long 0x3ec8477c, 0xbf6b99fb
.long 0x3ec6d529, 0xbf6be858
.long 0x3ec5625c, 0xbf6c3624
.long 0x3ec3ef15, 0xbf6c835e
.long 0x3ec27b55, 0xbf6cd007
.long 0x3ec1071e, 0xbf6d1c1d
.long 0x3ebf926f, 0xbf6d67a1
.long 0x3ebe1d4a, 0xbf6db293
.long 0x3ebca7af, 0xbf6dfcf2
.long 0x3ebb31a0, 0xbf6e46be
.long 0x3eb9bb1e, 0xbf6e8ff8
.long 0x3eb8442a, 0xbf6ed89e
.long 0x3eb6ccc3, 0xbf6f20b0
.long 0x3eb554ec, 0xbf6f6830
.long 0x3eb3dca5, 0xbf6faf1b
.long 0x3eb263ef, 0xbf6ff573
.long 0x3eb0eacb, 0xbf703b37
.long 0x3eaf713a, 0xbf708066
.long 0x3eadf73c, 0xbf70c501
.long 0x3eac7cd4, 0xbf710908
.long 0x3eab0201, 0xbf714c7a
.long 0x3ea986c4, 0xbf718f57
.long 0x3ea80b1f, 0xbf71d19f
.long 0x3ea68f12, 0xbf721352
.long 0x3ea5129f, 0xbf725470
.long 0x3ea395c5, 0xbf7294f8
.long 0x3ea21887, 0xbf72d4eb
.long 0x3ea09ae5, 0xbf731447
.long 0x3e9f1cdf, 0xbf73530e
.long 0x3e9d9e78, 0xbf73913f
.long 0x3e9c1faf, 0xbf73ced9
.long 0x3e9aa086, 0xbf740bdd
.long 0x3e9920fe, 0xbf74484b
.long 0x3e97a117, 0xbf748422
.long 0x3e9620d2, 0xbf74bf62
.long 0x3e94a031, 0xbf74fa0b
.long 0x3e931f35, 0xbf75341d
.long 0x3e919ddd, 0xbf756d97
.long 0x3e901c2c, 0xbf75a67b
.long 0x3e8e9a22, 0xbf75dec6
.long 0x3e8d17c0, 0xbf76167a
.long 0x3e8b9507, 0xbf764d97
.long 0x3e8a11f7, 0xbf76841b
.long 0x3e888e93, 0xbf76ba07
.long 0x3e870ada, 0xbf76ef5b
.long 0x3e8586ce, 0xbf772417
.long 0x3e840270, 0xbf77583a
.long 0x3e827dc0, 0xbf778bc5
.long 0x3e80f8c0, 0xbf77beb7
.long 0x3e7ee6e1, 0xbf77f110
.long 0x3e7bdba4, 0xbf7822d1
.long 0x3e78cfcc, 0xbf7853f8
.long 0x3e75c35a, 0xbf788486
.long 0x3e72b651, 0xbf78b47b
.long 0x3e6fa8b2, 0xbf78e3d6
.long 0x3e6c9a7f, 0xbf791298
.long 0x3e698bba, 0xbf7940c0
.long 0x3e667c66, 0xbf796e4e
.long 0x3e636c83, 0xbf799b43
.long 0x3e605c13, 0xbf79c79d
.long 0x3e5d4b1a, 0xbf79f35e
.long 0x3e5a3997, 0xbf7a1e84
.long 0x3e57278f, 0xbf7a4910
.long 0x3e541501, 0xbf7a7302
.long 0x3e5101f1, 0xbf7a9c59
.long 0x3e4dee60, 0xbf7ac516
.long 0x3e4ada4f, 0xbf7aed37
.long 0x3e47c5c2, 0xbf7b14be
.long 0x3e44b0b9, 0xbf7b3bab
.long 0x3e419b37, 0xbf7b61fc
.long 0x3e3e853e, 0xbf7b87b2
.long 0x3e3b6ecf, 0xbf7baccd
.long 0x3e3857ec, 0xbf7bd14d
.long 0x3e354098, 0xbf7bf531
.long 0x3e3228d4, 0xbf7c187a
.long 0x3e2f10a2, 0xbf7c3b28
.long 0x3e2bf804, 0xbf7c5d3a
.long 0x3e28defc, 0xbf7c7eb0
.long 0x3e25c58c, 0xbf7c9f8a
.long 0x3e22abb6, 0xbf7cbfc9
.long 0x3e1f917b, 0xbf7cdf6c
.long 0x3e1c76de, 0xbf7cfe73
.long 0x3e195be0, 0xbf7d1cdd
.long 0x3e164083, 0xbf7d3aac
.long 0x3e1324ca, 0xbf7d57de
.long 0x3e1008b7, 0xbf7d7474
.long 0x3e0cec4a, 0xbf7d906e
.long 0x3e09cf86, 0xbf7dabcc
.long 0x3e06b26e, 0xbf7dc68c
.long 0x3e039502, 0xbf7de0b1
.long 0x3e007745, 0xbf7dfa38
.long 0x3dfab273, 0xbf7e1324
.long 0x3df475c0, 0xbf7e2b72
.long 0x3dee3876, 0xbf7e4323
.long 0x3de7fa9a, 0xbf7e5a38
.long 0x3de1bc2e, 0xbf7e70b0
.long 0x3ddb7d37, 0xbf7e868b
.long 0x3dd53db9, 0xbf7e9bc9
.long 0x3dcefdb7, 0xbf7eb069
.long 0x3dc8bd36, 0xbf7ec46d
.long 0x3dc27c39, 0xbf7ed7d4
.long 0x3dbc3ac3, 0xbf7eea9d
.long 0x3db5f8da, 0xbf7efcc9
.long 0x3dafb680, 0xbf7f0e58
.long 0x3da973ba, 0xbf7f1f49
.long 0x3da3308c, 0xbf7f2f9d
.long 0x3d9cecf9, 0xbf7f3f54
.long 0x3d96a905, 0xbf7f4e6d
.long 0x3d9064b4, 0xbf7f5ce9
.long 0x3d8a200a, 0xbf7f6ac7
.long 0x3d83db0a, 0xbf7f7808
.long 0x3d7b2b74, 0xbf7f84ab
.long 0x3d6ea038, 0xbf7f90b1
.long 0x3d621469, 0xbf7f9c18
.long 0x3d55880e, 0xbf7fa6e3
.long 0x3d48fb30, 0xbf7fb10f
.long 0x3d3c6dd5, 0xbf7fba9e
.long 0x3d2fe007, 0xbf7fc38f
.long 0x3d2351cb, 0xbf7fcbe2
.long 0x3d16c32c, 0xbf7fd397
.long 0x3d0a342f, 0xbf7fdaaf
.long 0x3cfb49ba, 0xbf7fe129
.long 0x3ce22a7a, 0xbf7fe705
.long 0x3cc90ab0, 0xbf7fec43
.long 0x3cafea69, 0xbf7ff0e3
.long 0x3c96c9b6, 0xbf7ff4e6
.long 0x3c7b514b, 0xbf7ff84a
.long 0x3c490e90, 0xbf7ffb11
.long 0x3c16cb58, 0xbf7ffd39
.long 0x3bc90f88, 0xbf7ffec4
.long 0x3b490fc6, 0xbf7fffb1
.long 0x248d3132, 0xbf800000
.long 0xbb490fc6, 0xbf7fffb1
.long 0xbbc90f88, 0xbf7ffec4
.long 0xbc16cb58, 0xbf7ffd39
.long 0xbc490e90, 0xbf7ffb11
.long 0xbc7b514b, 0xbf7ff84a
.long 0xbc96c9b6, 0xbf7ff4e6
.long 0xbcafea69, 0xbf7ff0e3
.long 0xbcc90ab0, 0xbf7fec43
.long 0xbce22a7a, 0xbf7fe705
.long 0xbcfb49ba, 0xbf7fe129
.long 0xbd0a342f, 0xbf7fdaaf
.long 0xbd16c32c, 0xbf7fd397
.long 0xbd2351cb, 0xbf7fcbe2
.long 0xbd2fe007, 0xbf7fc38f
.long 0xbd3c6dd5, 0xbf7fba9e
.long 0xbd48fb30, 0xbf7fb10f
.long 0xbd55880e, 0xbf7fa6e3
.long 0xbd621469, 0xbf7f9c18
.long 0xbd6ea038, 0xbf7f90b1
.long 0xbd7b2b74, 0xbf7f84ab
.long 0xbd83db0a, 0xbf7f7808
.long 0xbd8a200a, 0xbf7f6ac7
.long 0xbd9064b4, 0xbf7f5ce9
.long 0xbd96a905, 0xbf7f4e6d
.long 0xbd9cecf9, 0xbf7f3f54
.long 0xbda3308c, 0xbf7f2f9d
.long 0xbda973ba, 0xbf7f1f49
.long 0xbdafb680, 0xbf7f0e58
.long 0xbdb5f8da, 0xbf7efcc9
.long 0xbdbc3ac3, 0xbf7eea9d
.long 0xbdc27c39, 0xbf7ed7d4
.long 0xbdc8bd36, 0xbf7ec46d
.long 0xbdcefdb7, 0xbf7eb069
.long 0xbdd53db9, 0xbf7e9bc9
.long 0xbddb7d37, 0xbf7e868b
.long 0xbde1bc2e, 0xbf7e70b0
.long 0xbde7fa9a, 0xbf7e5a38
.long 0xbdee3876, 0xbf7e4323
.long 0xbdf475c0, 0xbf7e2b72
.long 0xbdfab273, 0xbf7e1324
.long 0xbe007745, 0xbf7dfa38
.long 0xbe039502, 0xbf7de0b1
.long 0xbe06b26e, 0xbf7dc68c
.long 0xbe09cf86, 0xbf7dabcc
.long 0xbe0cec4a, 0xbf7d906e
.long 0xbe1008b7, 0xbf7d7474
.long 0xbe1324ca, 0xbf7d57de
.long 0xbe164083, 0xbf7d3aac
.long 0xbe195be0, 0xbf7d1cdd
.long 0xbe1c76de, 0xbf7cfe73
.long 0xbe1f917b, 0xbf7cdf6c
.long 0xbe22abb6, 0xbf7cbfc9
.long 0xbe25c58c, 0xbf7c9f8a
.long 0xbe28defc, 0xbf7c7eb0
.long 0xbe2bf804, 0xbf7c5d3a
.long 0xbe2f10a2, 0xbf7c3b28
.long 0xbe3228d4, 0xbf7c187a
.long 0xbe354098, 0xbf7bf531
.long 0xbe3857ec, 0xbf7bd14d
.long 0xbe3b6ecf, 0xbf7baccd
.long 0xbe3e853e, 0xbf7b87b2
.long 0xbe419b37, 0xbf7b61fc
.long 0xbe44b0b9, 0xbf7b3bab
.long 0xbe47c5c2, 0xbf7b14be
.long 0xbe4ada4f, 0xbf7aed37
.long 0xbe4dee60, 0xbf7ac516
.long 0xbe5101f1, 0xbf7a9c59
.long 0xbe541501, 0xbf7a7302
.long 0xbe57278f, 0xbf7a4910
.long 0xbe5a3997, 0xbf7a1e84
.long 0xbe5d4b1a, 0xbf79f35e
.long 0xbe605c13, 0xbf79c79d
.long 0xbe636c83, 0xbf799b43
.long 0xbe667c66, 0xbf796e4e
.long 0xbe698bba, 0xbf7940c0
.long 0xbe6c9a7f, 0xbf791298
.long 0xbe6fa8b2, 0xbf78e3d6
.long 0xbe72b651, 0xbf78b47b
.long 0xbe75c35a, 0xbf788486
.long 0xbe78cfcc, 0xbf7853f8
.long 0xbe7bdba4, 0xbf7822d1
.long 0xbe7ee6e1, 0xbf77f110
.long 0xbe80f8c0, 0xbf77beb7
.long 0xbe827dc0, 0xbf778bc5
.long 0xbe840270, 0xbf77583a
.long 0xbe8586ce, 0xbf772417
.long 0xbe870ada, 0xbf76ef5b
.long 0xbe888e93, 0xbf76ba07
.long 0xbe8a11f7, 0xbf76841b
.long 0xbe8b9507, 0xbf764d97
.long 0xbe8d17c0, 0xbf76167a
.long 0xbe8e9a22, 0xbf75dec6
.long 0xbe901c2c, 0xbf75a67b
.long 0xbe919ddd, 0xbf756d97
.long 0xbe931f35, 0xbf75341d
.long 0xbe94a031, 0xbf74fa0b
.long 0xbe9620d2, 0xbf74bf62
.long 0xbe97a117, 0xbf748422
.long 0xbe9920fe, 0xbf74484b
.long 0xbe9aa086, 0xbf740bdd
.long 0xbe9c1faf, 0xbf73ced9
.long 0xbe9d9e78, 0xbf73913f
.long 0xbe9f1cdf, 0xbf73530e
.long 0xbea09ae5, 0xbf731447
.long 0xbea21887, 0xbf72d4eb
.long 0xbea395c5, 0xbf7294f8
.long 0xbea5129f, 0xbf725470
.long 0xbea68f12, 0xbf721352
.long 0xbea80b1f, 0xbf71d19f
.long 0xbea986c4, 0xbf718f57
.long 0xbeab0201, 0xbf714c7a
.long 0xbeac7cd4, 0xbf710908
.long 0xbeadf73c, 0xbf70c501
.long 0xbeaf713a, 0xbf708066
.long 0xbeb0eacb, 0xbf703b37
.long 0xbeb263ef, 0xbf6ff573
.long 0xbeb3dca5, 0xbf6faf1b
.long 0xbeb554ec, 0xbf6f6830
.long 0xbeb6ccc3, 0xbf6f20b0
.long 0xbeb8442a, 0xbf6ed89e
.long 0xbeb9bb1e, 0xbf6e8ff8
.long 0xbebb31a0, 0xbf6e46be
.long 0xbebca7af, 0xbf6dfcf2
.long 0xbebe1d4a, 0xbf6db293
.long 0xbebf926f, 0xbf6d67a1
.long 0xbec1071e, 0xbf6d1c1d
.long 0xbec27b55, 0xbf6cd007
.long 0xbec3ef15, 0xbf6c835e
.long 0xbec5625c, 0xbf6c3624
.long 0xbec6d529, 0xbf6be858
.long 0xbec8477c, 0xbf6b99fb
.long 0xbec9b953, 0xbf6b4b0c
.long 0xbecb2aae, 0xbf6afb8c
.long 0xbecc9b8b, 0xbf6aab7b
.long 0xbece0bea, 0xbf6a5ad9
.long 0xbecf7bca, 0xbf6a09a7
.long 0xbed0eb2a, 0xbf69b7e4
.long 0xbed25a09, 0xbf696591
.long 0xbed3c867, 0xbf6912ae
.long 0xbed53641, 0xbf68bf3c
.long 0xbed6a399, 0xbf686b39
.long 0xbed8106b, 0xbf6816a8
.long 0xbed97cb9, 0xbf67c187
.long 0xbedae880, 0xbf676bd8
.long 0xbedc53c1, 0xbf671599
.long 0xbeddbe79, 0xbf66becc
.long 0xbedf28a9, 0xbf666771
.long 0xbee0924f, 0xbf660f88
.long 0xbee1fb6a, 0xbf65b710
.long 0xbee363fa, 0xbf655e0b
.long 0xbee4cbfe, 0xbf650479
.long 0xbee63375, 0xbf64aa59
.long 0xbee79a5d, 0xbf644fac
.long 0xbee900b7, 0xbf63f473
.long 0xbeea6681, 0xbf6398ac
.long 0xbeebcbbb, 0xbf633c5a
.long 0xbeed3063, 0xbf62df7b
.long 0xbeee9479, 0xbf628210
.long 0xbeeff7fb, 0xbf62241a
.long 0xbef15aea, 0xbf61c598
.long 0xbef2bd43, 0xbf61668a
.long 0xbef41f07, 0xbf6106f2
.long 0xbef58035, 0xbf60a6cf
.long 0xbef6e0cb, 0xbf604621
.long 0xbef840c8, 0xbf5fe4e9
.long 0xbef9a02d, 0xbf5f8327
.long 0xbefafef7, 0xbf5f20db
.long 0xbefc5d27, 0xbf5ebe05
.long 0xbefdbabb, 0xbf5e5aa6
.long 0xbeff17b2, 0xbf5df6be
.long 0xbf003a06, 0xbf5d924d
.long 0xbf00e7e4, 0xbf5d2d53
.long 0xbf019573, 0xbf5cc7d1
.long 0xbf0242b1, 0xbf5c61c7
.long 0xbf02ef9f, 0xbf5bfb34
.long 0xbf039c3d, 0xbf5b941a
.long 0xbf044889, 0xbf5b2c79
.long 0xbf04f484, 0xbf5ac450
.long 0xbf05a02c, 0xbf5a5ba0
.long 0xbf064b82, 0xbf59f26a
.long 0xbf06f686, 0xbf5988ad
.long 0xbf07a136, 0xbf591e6a
.long 0xbf084b92, 0xbf58b3a1
.long 0xbf08f59b, 0xbf584853
.long 0xbf099f4e, 0xbf57dc7f
.long 0xbf0a48ad, 0xbf577026
.long 0xbf0af1b7, 0xbf570348
.long 0xbf0b9a6b, 0xbf5695e5
.long 0xbf0c42c9, 0xbf5627fe
.long 0xbf0cead0, 0xbf55b993
.long 0xbf0d9281, 0xbf554aa4
.long 0xbf0e39da, 0xbf54db31
.long 0xbf0ee0db, 0xbf546b3b
.long 0xbf0f8784, 0xbf53fac3
.long 0xbf102dd5, 0xbf5389c7
.long 0xbf10d3cd, 0xbf531849
.long 0xbf11796b, 0xbf52a649
.long 0xbf121eb0, 0xbf5233c6
.long 0xbf12c39a, 0xbf51c0c2
.long 0xbf13682a, 0xbf514d3d
.long 0xbf140c5f, 0xbf50d937
.long 0xbf14b039, 0xbf5064af
.long 0xbf1553b7, 0xbf4fefa8
.long 0xbf15f6d9, 0xbf4f7a1f
.long 0xbf16999f, 0xbf4f0417
.long 0xbf173c07, 0xbf4e8d90
.long 0xbf17de12, 0xbf4e1689
.long 0xbf187fc0, 0xbf4d9f02
.long 0xbf19210f, 0xbf4d26fd
.long 0xbf19c200, 0xbf4cae79
.long 0xbf1a6293, 0xbf4c3578
.long 0xbf1b02c6, 0xbf4bbbf8
.long 0xbf1ba299, 0xbf4b41fa
.long 0xbf1c420c, 0xbf4ac77f
.long 0xbf1ce11f, 0xbf4a4c87
.long 0xbf1d7fd1, 0xbf49d112
.long 0xbf1e1e22, 0xbf495521
.long 0xbf1ebc12, 0xbf48d8b3
.long 0xbf1f599f, 0xbf485bca
.long 0xbf1ff6cb, 0xbf47de65
.long 0xbf209393, 0xbf476085
.long 0xbf212ff9, 0xbf46e22a
.long 0xbf21cbfb, 0xbf466354
.long 0xbf226799, 0xbf45e403
.long 0xbf2302d3, 0xbf456439
.long 0xbf239da9, 0xbf44e3f5
.long 0xbf24381a, 0xbf446337
.long 0xbf24d225, 0xbf43e200
.long 0xbf256bcb, 0xbf436051
.long 0xbf26050a, 0xbf42de29
.long 0xbf269de3, 0xbf425b89
.long 0xbf273656, 0xbf41d870
.long 0xbf27ce61, 0xbf4154e1
.long 0xbf286605, 0xbf40d0da
.long 0xbf28fd41, 0xbf404c5c
.long 0xbf299415, 0xbf3fc767
.long 0xbf2a2a80, 0xbf3f41fc
.long 0xbf2ac082, 0xbf3ebc1b
.long 0xbf2b561b, 0xbf3e35c5
.long 0xbf2beb4a, 0xbf3daef9
.long 0xbf2c800f, 0xbf3d27b8
.long 0xbf2d1469, 0xbf3ca003
.long 0xbf2da859, 0xbf3c17d9
.long 0xbf2e3bde, 0xbf3b8f3b
.long 0xbf2ecef7, 0xbf3b0629
.long 0xbf2f61a5, 0xbf3a7ca4
.long 0xbf2ff3e6, 0xbf39f2ac
.long 0xbf3085bb, 0xbf396842
.long 0xbf311722, 0xbf38dd65
.long 0xbf31a81d, 0xbf385216
.long 0xbf3238aa, 0xbf37c655
.long 0xbf32c8c9, 0xbf373a23
.long 0xbf33587a, 0xbf36ad7f
.long 0xbf33e7bc, 0xbf36206c
.long 0xbf34768f, 0xbf3592e7
.long 0xbf3504f3, 0xbf3504f3
.long 0xbf3592e7, 0xbf34768f
.long 0xbf36206c, 0xbf33e7bc
.long 0xbf36ad7f, 0xbf33587a
.long 0xbf373a23, 0xbf32c8c9
.long 0xbf37c655, 0xbf3238aa
.long 0xbf385216, 0xbf31a81d
.long 0xbf38dd65, 0xbf311722
.long 0xbf396842, 0xbf3085bb
.long 0xbf39f2ac, 0xbf2ff3e6
.long 0xbf3a7ca4, 0xbf2f61a5
.long 0xbf3b0629, 0xbf2ecef7
.long 0xbf3b8f3b, 0xbf2e3bde
.long 0xbf3c17d9, 0xbf2da859
.long 0xbf3ca003, 0xbf2d1469
.long 0xbf3d27b8, 0xbf2c800f
.long 0xbf3daef9, 0xbf2beb4a
.long 0xbf3e35c5, 0xbf2b561b
.long 0xbf3ebc1b, 0xbf2ac082
.long 0xbf3f41fc, 0xbf2a2a80
.long 0xbf3fc767, 0xbf299415
.long 0xbf404c5c, 0xbf28fd41
.long 0xbf40d0da, 0xbf286605
.long 0xbf4154e1, 0xbf27ce61
.long 0xbf41d870, 0xbf273656
.long 0xbf425b89, 0xbf269de3
.long 0xbf42de29, 0xbf26050a
.long 0xbf436051, 0xbf256bcb
.long 0xbf43e200, 0xbf24d225
.long 0xbf446337, 0xbf24381a
.long 0xbf44e3f5, 0xbf239da9
.long 0xbf456439, 0xbf2302d3
.long 0xbf45e403, 0xbf226799
.long 0xbf466354, 0xbf21cbfb
.long 0xbf46e22a, 0xbf212ff9
.long 0xbf476085, 0xbf209393
.long 0xbf47de65, 0xbf1ff6cb
.long 0xbf485bca, 0xbf1f599f
.long 0xbf48d8b3, 0xbf1ebc12
.long 0xbf495521, 0xbf1e1e22
.long 0xbf49d112, 0xbf1d7fd1
.long 0xbf4a4c87, 0xbf1ce11f
.long 0xbf4ac77f, 0xbf1c420c
.long 0xbf4b41fa, 0xbf1ba299
.long 0xbf4bbbf8, 0xbf1b02c6
.long 0xbf4c3578, 0xbf1a6293
.long 0xbf4cae79, 0xbf19c200
.long 0xbf4d26fd, 0xbf19210f
.long 0xbf4d9f02, 0xbf187fc0
.long 0xbf4e1689, 0xbf17de12
.long 0xbf4e8d90, 0xbf173c07
.long 0xbf4f0417, 0xbf16999f
.long 0xbf4f7a1f, 0xbf15f6d9
.long 0xbf4fefa8, 0xbf1553b7
.long 0xbf5064af, 0xbf14b039
.long 0xbf50d937, 0xbf140c5f
.long 0xbf514d3d, 0xbf13682a
.long 0xbf51c0c2, 0xbf12c39a
.long 0xbf5233c6, 0xbf121eb0
.long 0xbf52a649, 0xbf11796b
.long 0xbf531849, 0xbf10d3cd
.long 0xbf5389c7, 0xbf102dd5
.long 0xbf53fac3, 0xbf0f8784
.long 0xbf546b3b, 0xbf0ee0db
.long 0xbf54db31, 0xbf0e39da
.long 0xbf554aa4, 0xbf0d9281
.long 0xbf55b993, 0xbf0cead0
.long 0xbf5627fe, 0xbf0c42c9
.long 0xbf5695e5, 0xbf0b9a6b
.long 0xbf570348, 0xbf0af1b7
.long 0xbf577026, 0xbf0a48ad
.long 0xbf57dc7f, 0xbf099f4e
.long 0xbf584853, 0xbf08f59b
.long 0xbf58b3a1, 0xbf084b92
.long 0xbf591e6a, 0xbf07a136
.long 0xbf5988ad, 0xbf06f686
.long 0xbf59f26a, 0xbf064b82
.long 0xbf5a5ba0, 0xbf05a02c
.long 0xbf5ac450, 0xbf04f484
.long 0xbf5b2c79, 0xbf044889
.long 0xbf5b941a, 0xbf039c3d
.long 0xbf5bfb34, 0xbf02ef9f
.long 0xbf5c61c7, 0xbf0242b1
.long 0xbf5cc7d1, 0xbf019573
.long 0xbf5d2d53, 0xbf00e7e4
.long 0xbf5d924d, 0xbf003a06
.long 0xbf5df6be, 0xbeff17b2
.long 0xbf5e5aa6, 0xbefdbabb
.long 0xbf5ebe05, 0xbefc5d27
.long 0xbf5f20db, 0xbefafef7
.long 0xbf5f8327, 0xbef9a02d
.long 0xbf5fe4e9, 0xbef840c8
.long 0xbf604621, 0xbef6e0cb
.long 0xbf60a6cf, 0xbef58035
.long 0xbf6106f2, 0xbef41f07
.long 0xbf61668a, 0xbef2bd43
.long 0xbf61c598, 0xbef15aea
.long 0xbf62241a, 0xbeeff7fb
.long 0xbf628210, 0xbeee9479
.long 0xbf62df7b, 0xbeed3063
.long 0xbf633c5a, 0xbeebcbbb
.long 0xbf6398ac, 0xbeea6681
.long 0xbf63f473, 0xbee900b7
.long 0xbf644fac, 0xbee79a5d
.long 0xbf64aa59, 0xbee63375
.long 0xbf650479, 0xbee4cbfe
.long 0xbf655e0b, 0xbee363fa
.long 0xbf65b710, 0xbee1fb6a
.long 0xbf660f88, 0xbee0924f
.long 0xbf666771, 0xbedf28a9
.long 0xbf66becc, 0xbeddbe79
.long 0xbf671599, 0xbedc53c1
.long 0xbf676bd8, 0xbedae880
.long 0xbf67c187, 0xbed97cb9
.long 0xbf6816a8, 0xbed8106b
.long 0xbf686b39, 0xbed6a399
.long 0xbf68bf3c, 0xbed53641
.long 0xbf6912ae, 0xbed3c867
.long 0xbf696591, 0xbed25a09
.long 0xbf69b7e4, 0xbed0eb2a
.long 0xbf6a09a7, 0xbecf7bca
.long 0xbf6a5ad9, 0xbece0bea
.long 0xbf6aab7b, 0xbecc9b8b
.long 0xbf6afb8c, 0xbecb2aae
.long 0xbf6b4b0c, 0xbec9b953
.long 0xbf6b99fb, 0xbec8477c
.long 0xbf6be858, 0xbec6d529
.long 0xbf6c3624, 0xbec5625c
.long 0xbf6c835e, 0xbec3ef15
.long 0xbf6cd007, 0xbec27b55
.long 0xbf6d1c1d, 0xbec1071e
.long 0xbf6d67a1, 0xbebf926f
.long 0xbf6db293, 0xbebe1d4a
.long 0xbf6dfcf2, 0xbebca7af
.long 0xbf6e46be, 0xbebb31a0
.long 0xbf6e8ff8, 0xbeb9bb1e
.long 0xbf6ed89e, 0xbeb8442a
.long 0xbf6f20b0, 0xbeb6ccc3
.long 0xbf6f6830, 0xbeb554ec
.long 0xbf6faf1b, 0xbeb3dca5
.long 0xbf6ff573, 0xbeb263ef
.long 0xbf703b37, 0xbeb0eacb
.long 0xbf708066, 0xbeaf713a
.long 0xbf70c501, 0xbeadf73c
.long 0xbf710908, 0xbeac7cd4
.long 0xbf714c7a, 0xbeab0201
.long 0xbf718f57, 0xbea986c4
.long 0xbf71d19f, 0xbea80b1f
.long 0xbf721352, 0xbea68f12
.long 0xbf725470, 0xbea5129f
.long 0xbf7294f8, 0xbea395c5
.long 0xbf72d4eb, 0xbea21887
.long 0xbf731447, 0xbea09ae5
.long 0xbf73530e, 0xbe9f1cdf
.long 0xbf73913f, 0xbe9d9e78
.long 0xbf73ced9, 0xbe9c1faf
.long 0xbf740bdd, 0xbe9aa086
.long 0xbf74484b, 0xbe9920fe
.long 0xbf748422, 0xbe97a117
.long 0xbf74bf62, 0xbe9620d2
.long 0xbf74fa0b, 0xbe94a031
.long 0xbf75341d, 0xbe931f35
.long 0xbf756d97, 0xbe919ddd
.long 0xbf75a67b, 0xbe901c2c
.long 0xbf75dec6, 0xbe8e9a22
.long 0xbf76167a, 0xbe8d17c0
.long 0xbf764d97, 0xbe8b9507
.long 0xbf76841b, 0xbe8a11f7
.long 0xbf76ba07, 0xbe888e93
.long 0xbf76ef5b, 0xbe870ada
.long 0xbf772417, 0xbe8586ce
.long 0xbf77583a, 0xbe840270
.long 0xbf778bc5, 0xbe827dc0
.long 0xbf77beb7, 0xbe80f8c0
.long 0xbf77f110, 0xbe7ee6e1
.long 0xbf7822d1, 0xbe7bdba4
.long 0xbf7853f8, 0xbe78cfcc
.long 0xbf788486, 0xbe75c35a
.long 0xbf78b47b, 0xbe72b651
.long 0xbf78e3d6, 0xbe6fa8b2
.long 0xbf791298, 0xbe6c9a7f
.long 0xbf7940c0, 0xbe698bba
.long 0xbf796e4e, 0xbe667c66
.long 0xbf799b43, 0xbe636c83
.long 0xbf79c79d, 0xbe605c13
.long 0xbf79f35e, 0xbe5d4b1a
.long 0xbf7a1e84, 0xbe5a3997
.long 0xbf7a4910, 0xbe57278f
.long 0xbf7a7302, 0xbe541501
.long 0xbf7a9c59, 0xbe5101f1
.long 0xbf7ac516, 0xbe4dee60
.long 0xbf7aed37, 0xbe4ada4f
.long 0xbf7b14be, 0xbe47c5c2
.long 0xbf7b3bab, 0xbe44b0b9
.long 0xbf7b61fc, 0xbe419b37
.long 0xbf7b87b2, 0xbe3e853e
.long 0xbf7baccd, 0xbe3b6ecf
.long 0xbf7bd14d, 0xbe3857ec
.long 0xbf7bf531, 0xbe354098
.long 0xbf7c187a, 0xbe3228d4
.long 0xbf7c3b28, 0xbe2f10a2
.long 0xbf7c5d3a, 0xbe2bf804
.long 0xbf7c7eb0, 0xbe28defc
.long 0xbf7c9f8a, 0xbe25c58c
.long 0xbf7cbfc9, 0xbe22abb6
.long 0xbf7cdf6c, 0xbe1f917b
.long 0xbf7cfe73, 0xbe1c76de
.long 0xbf7d1cdd, 0xbe195be0
.long 0xbf7d3aac, 0xbe164083
.long 0xbf7d57de, 0xbe1324ca
.long 0xbf7d7474, 0xbe1008b7
.long 0xbf7d906e, 0xbe0cec4a
.long 0xbf7dabcc, 0xbe09cf86
.long 0xbf7dc68c, 0xbe06b26e
.long 0xbf7de0b1, 0xbe039502
.long 0xbf7dfa38, 0xbe007745
.long 0xbf7e1324, 0xbdfab273
.long 0xbf7e2b72, 0xbdf475c0
.long 0xbf7e4323, 0xbdee3876
.long 0xbf7e5a38, 0xbde7fa9a
.long 0xbf7e70b0, 0xbde1bc2e
.long 0xbf7e868b, 0xbddb7d37
.long 0xbf7e9bc9, 0xbdd53db9
.long 0xbf7eb069, 0xbdcefdb7
.long 0xbf7ec46d, 0xbdc8bd36
.long 0xbf7ed7d4, 0xbdc27c39
.long 0xbf7eea9d, 0xbdbc3ac3
.long 0xbf7efcc9, 0xbdb5f8da
.long 0xbf7f0e58, 0xbdafb680
.long 0xbf7f1f49, 0xbda973ba
.long 0xbf7f2f9d, 0xbda3308c
.long 0xbf7f3f54, 0xbd9cecf9
.long 0xbf7f4e6d, 0xbd96a905
.long 0xbf7f5ce9, 0xbd9064b4
.long 0xbf7f6ac7, 0xbd8a200a
.long 0xbf7f7808, 0xbd83db0a
.long 0xbf7f84ab, 0xbd7b2b74
.long 0xbf7f90b1, 0xbd6ea038
.long 0xbf7f9c18, 0xbd621469
.long 0xbf7fa6e3, 0xbd55880e
.long 0xbf7fb10f, 0xbd48fb30
.long 0xbf7fba9e, 0xbd3c6dd5
.long 0xbf7fc38f, 0xbd2fe007
.long 0xbf7fcbe2, 0xbd2351cb
.long 0xbf7fd397, 0xbd16c32c
.long 0xbf7fdaaf, 0xbd0a342f
.long 0xbf7fe129, 0xbcfb49ba
.long 0xbf7fe705, 0xbce22a7a
.long 0xbf7fec43, 0xbcc90ab0
.long 0xbf7ff0e3, 0xbcafea69
.long 0xbf7ff4e6, 0xbc96c9b6
.long 0xbf7ff84a, 0xbc7b514b
.long 0xbf7ffb11, 0xbc490e90
.long 0xbf7ffd39, 0xbc16cb58
.long 0xbf7ffec4, 0xbbc90f88
.long 0xbf7fffb1, 0xbb490fc6
.long 0xbf800000, 0xa50d3132
.long 0xbf7fffb1, 0x3b490fc6
.long 0xbf7ffec4, 0x3bc90f88
.long 0xbf7ffd39, 0x3c16cb58
.long 0xbf7ffb11, 0x3c490e90
.long 0xbf7ff84a, 0x3c7b514b
.long 0xbf7ff4e6, 0x3c96c9b6
.long 0xbf7ff0e3, 0x3cafea69
.long 0xbf7fec43, 0x3cc90ab0
.long 0xbf7fe705, 0x3ce22a7a
.long 0xbf7fe129, 0x3cfb49ba
.long 0xbf7fdaaf, 0x3d0a342f
.long 0xbf7fd397, 0x3d16c32c
.long 0xbf7fcbe2, 0x3d2351cb
.long 0xbf7fc38f, 0x3d2fe007
.long 0xbf7fba9e, 0x3d3c6dd5
.long 0xbf7fb10f, 0x3d48fb30
.long 0xbf7fa6e3, 0x3d55880e
.long 0xbf7f9c18, 0x3d621469
.long 0xbf7f90b1, 0x3d6ea038
.long 0xbf7f84ab, 0x3d7b2b74
.long 0xbf7f7808, 0x3d83db0a
.long 0xbf7f6ac7, 0x3d8a200a
.long 0xbf7f5ce9, 0x3d9064b4
.long 0xbf7f4e6d, 0x3d96a905
.long 0xbf7f3f54, 0x3d9cecf9
.long 0xbf7f2f9d, 0x3da3308c
.long 0xbf7f1f49, 0x3da973ba
.long 0xbf7f0e58, 0x3dafb680
.long 0xbf7efcc9, 0x3db5f8da
.long 0xbf7eea9d, 0x3dbc3ac3
.long 0xbf7ed7d4, 0x3dc27c39
.long 0xbf7ec46d, 0x3dc8bd36
.long 0xbf7eb069, 0x3dcefdb7
.long 0xbf7e9bc9, 0x3dd53db9
.long 0xbf7e868b, 0x3ddb7d37
.long 0xbf7e70b0, 0x3de1bc2e
.long 0xbf7e5a38, 0x3de7fa9a
.long 0xbf7e4323, 0x3dee3876
.long 0xbf7e2b72, 0x3df475c0
.long 0xbf7e1324, 0x3dfab273
.long 0xbf7dfa38, 0x3e007745
.long 0xbf7de0b1, 0x3e039502
.long 0xbf7dc68c, 0x3e06b26e
.long 0xbf7dabcc, 0x3e09cf86
.long 0xbf7d906e, 0x3e0cec4a
.long 0xbf7d7474, 0x3e1008b7
.long 0xbf7d57de, 0x3e1324ca
.long 0xbf7d3aac, 0x3e164083
.long 0xbf7d1cdd, 0x3e195be0
.long 0xbf7cfe73, 0x3e1c76de
.long 0xbf7cdf6c, 0x3e1f917b
.long 0xbf7cbfc9, 0x3e22abb6
.long 0xbf7c9f8a, 0x3e25c58c
.long 0xbf7c7eb0, 0x3e28defc
.long 0xbf7c5d3a, 0x3e2bf804
.long 0xbf7c3b28, 0x3e2f10a2
.long 0xbf7c187a, 0x3e3228d4
.long 0xbf7bf531, 0x3e354098
.long 0xbf7bd14d, 0x3e3857ec
.long 0xbf7baccd, 0x3e3b6ecf
.long 0xbf7b87b2, 0x3e3e853e
.long 0xbf7b61fc, 0x3e419b37
.long 0xbf7b3bab, 0x3e44b0b9
.long 0xbf7b14be, 0x3e47c5c2
.long 0xbf7aed37, 0x3e4ada4f
.long 0xbf7ac516, 0x3e4dee60
.long 0xbf7a9c59, 0x3e5101f1
.long 0xbf7a7302, 0x3e541501
.long 0xbf7a4910, 0x3e57278f
.long 0xbf7a1e84, 0x3e5a3997
.long 0xbf79f35e, 0x3e5d4b1a
.long 0xbf79c79d, 0x3e605c13
.long 0xbf799b43, 0x3e636c83
.long 0xbf796e4e, 0x3e667c66
.long 0xbf7940c0, 0x3e698bba
.long 0xbf791298, 0x3e6c9a7f
.long 0xbf78e3d6, 0x3e6fa8b2
.long 0xbf78b47b, 0x3e72b651
.long 0xbf788486, 0x3e75c35a
.long 0xbf7853f8, 0x3e78cfcc
.long 0xbf7822d1, 0x3e7bdba4
.long 0xbf77f110, 0x3e7ee6e1
.long 0xbf77beb7, 0x3e80f8c0
.long 0xbf778bc5, 0x3e827dc0
.long 0xbf77583a, 0x3e840270
.long 0xbf772417, 0x3e8586ce
.long 0xbf76ef5b, 0x3e870ada
.long 0xbf76ba07, 0x3e888e93
.long 0xbf76841b, 0x3e8a11f7
.long 0xbf764d97, 0x3e8b9507
.long 0xbf76167a, 0x3e8d17c0
.long 0xbf75dec6, 0x3e8e9a22
.long 0xbf75a67b, 0x3e901c2c
.long 0xbf756d97, 0x3e919ddd
.long 0xbf75341d, 0x3e931f35
.long 0xbf74fa0b, 0x3e94a031
.long 0xbf74bf62, 0x3e9620d2
.long 0xbf748422, 0x3e97a117
.long 0xbf74484b, 0x3e9920fe
.long 0xbf740bdd, 0x3e9aa086
.long 0xbf73ced9, 0x3e9c1faf
.long 0xbf73913f, 0x3e9d9e78
.long 0xbf73530e, 0x3e9f1cdf
.long 0xbf731447, 0x3ea09ae5
.long 0xbf72d4eb, 0x3ea21887
.long 0xbf7294f8, 0x3ea395c5
.long 0xbf725470, 0x3ea5129f
.long 0xbf721352, 0x3ea68f12
.long 0xbf71d19f, 0x3ea80b1f
.long 0xbf718f57, 0x3ea986c4
.long 0xbf714c7a, 0x3eab0201
.long 0xbf710908, 0x3eac7cd4
.long 0xbf70c501, 0x3eadf73c
.long 0xbf708066, 0x3eaf713a
.long 0xbf703b37, 0x3eb0eacb
.long 0xbf6ff573, 0x3eb263ef
.long 0xbf6faf1b, 0x3eb3dca5
.long 0xbf6f6830, 0x3eb554ec
.long 0xbf6f20b0, 0x3eb6ccc3
.long 0xbf6ed89e, 0x3eb8442a
.long 0xbf6e8ff8, 0x3eb9bb1e
.long 0xbf6e46be, 0x3ebb31a0
.long 0xbf6dfcf2, 0x3ebca7af
.long 0xbf6db293, 0x3ebe1d4a
.long 0xbf6d67a1, 0x3ebf926f
.long 0xbf6d1c1d, 0x3ec1071e
.long 0xbf6cd007, 0x3ec27b55
.long 0xbf6c835e, 0x3ec3ef15
.long 0xbf6c3624, 0x3ec5625c
.long 0xbf6be858, 0x3ec6d529
.long 0xbf6b99fb, 0x3ec8477c
.long 0xbf6b4b0c, 0x3ec9b953
.long 0xbf6afb8c, 0x3ecb2aae
.long 0xbf6aab7b, 0x3ecc9b8b
.long 0xbf6a5ad9, 0x3ece0bea
.long 0xbf6a09a7, 0x3ecf7bca
.long 0xbf69b7e4, 0x3ed0eb2a
.long 0xbf696591, 0x3ed25a09
.long 0xbf6912ae, 0x3ed3c867
.long 0xbf68bf3c, 0x3ed53641
.long 0xbf686b39, 0x3ed6a399
.long 0xbf6816a8, 0x3ed8106b
.long 0xbf67c187, 0x3ed97cb9
.long 0xbf676bd8, 0x3edae880
.long 0xbf671599, 0x3edc53c1
.long 0xbf66becc, 0x3eddbe79
.long 0xbf666771, 0x3edf28a9
.long 0xbf660f88, 0x3ee0924f
.long 0xbf65b710, 0x3ee1fb6a
.long 0xbf655e0b, 0x3ee363fa
.long 0xbf650479, 0x3ee4cbfe
.long 0xbf64aa59, 0x3ee63375
.long 0xbf644fac, 0x3ee79a5d
.long 0xbf63f473, 0x3ee900b7
.long 0xbf6398ac, 0x3eea6681
.long 0xbf633c5a, 0x3eebcbbb
.long 0xbf62df7b, 0x3eed3063
.long 0xbf628210, 0x3eee9479
.long 0xbf62241a, 0x3eeff7fb
.long 0xbf61c598, 0x3ef15aea
.long 0xbf61668a, 0x3ef2bd43
.long 0xbf6106f2, 0x3ef41f07
.long 0xbf60a6cf, 0x3ef58035
.long 0xbf604621, 0x3ef6e0cb
.long 0xbf5fe4e9, 0x3ef840c8
.long 0xbf5f8327, 0x3ef9a02d
.long 0xbf5f20db, 0x3efafef7
.long 0xbf5ebe05, 0x3efc5d27
.long 0xbf5e5aa6, 0x3efdbabb
.long 0xbf5df6be, 0x3eff17b2
.long 0xbf5d924d, 0x3f003a06
.long 0xbf5d2d53, 0x3f00e7e4
.long 0xbf5cc7d1, 0x3f019573
.long 0xbf5c61c7, 0x3f0242b1
.long 0xbf5bfb34, 0x3f02ef9f
.long 0xbf5b941a, 0x3f039c3d
.long 0xbf5b2c79, 0x3f044889
.long 0xbf5ac450, 0x3f04f484
.long 0xbf5a5ba0, 0x3f05a02c
.long 0xbf59f26a, 0x3f064b82
.long 0xbf5988ad, 0x3f06f686
.long 0xbf591e6a, 0x3f07a136
.long 0xbf58b3a1, 0x3f084b92
.long 0xbf584853, 0x3f08f59b
.long 0xbf57dc7f, 0x3f099f4e
.long 0xbf577026, 0x3f0a48ad
.long 0xbf570348, 0x3f0af1b7
.long 0xbf5695e5, 0x3f0b9a6b
.long 0xbf5627fe, 0x3f0c42c9
.long 0xbf55b993, 0x3f0cead0
.long 0xbf554aa4, 0x3f0d9281
.long 0xbf54db31, 0x3f0e39da
.long 0xbf546b3b, 0x3f0ee0db
.long 0xbf53fac3, 0x3f0f8784
.long 0xbf5389c7, 0x3f102dd5
.long 0xbf531849, 0x3f10d3cd
.long 0xbf52a649, 0x3f11796b
.long 0xbf5233c6, 0x3f121eb0
.long 0xbf51c0c2, 0x3f12c39a
.long 0xbf514d3d, 0x3f13682a
.long 0xbf50d937, 0x3f140c5f
.long 0xbf5064af, 0x3f14b039
.long 0xbf4fefa8, 0x3f1553b7
.long 0xbf4f7a1f, 0x3f15f6d9
.long 0xbf4f0417, 0x3f16999f
.long 0xbf4e8d90, 0x3f173c07
.long 0xbf4e1689, 0x3f17de12
.long 0xbf4d9f02, 0x3f187fc0
.long 0xbf4d26fd, 0x3f19210f
.long 0xbf4cae79, 0x3f19c200
.long 0xbf4c3578, 0x3f1a6293
.long 0xbf4bbbf8, 0x3f1b02c6
.long 0xbf4b41fa, 0x3f1ba299
.long 0xbf4ac77f, 0x3f1c420c
.long 0xbf4a4c87, 0x3f1ce11f
.long 0xbf49d112, 0x3f1d7fd1
.long 0xbf495521, 0x3f1e1e22
.long 0xbf48d8b3, 0x3f1ebc12
.long 0xbf485bca, 0x3f1f599f
.long 0xbf47de65, 0x3f1ff6cb
.long 0xbf476085, 0x3f209393
.long 0xbf46e22a, 0x3f212ff9
.long 0xbf466354, 0x3f21cbfb
.long 0xbf45e403, 0x3f226799
.long 0xbf456439, 0x3f2302d3
.long 0xbf44e3f5, 0x3f239da9
.long 0xbf446337, 0x3f24381a
.long 0xbf43e200, 0x3f24d225
.long 0xbf436051, 0x3f256bcb
.long 0xbf42de29, 0x3f26050a
.long 0xbf425b89, 0x3f269de3
.long 0xbf41d870, 0x3f273656
.long 0xbf4154e1, 0x3f27ce61
.long 0xbf40d0da, 0x3f286605
.long 0xbf404c5c, 0x3f28fd41
.long 0xbf3fc767, 0x3f299415
.long 0xbf3f41fc, 0x3f2a2a80
.long 0xbf3ebc1b, 0x3f2ac082
.long 0xbf3e35c5, 0x3f2b561b
.long 0xbf3daef9, 0x3f2beb4a
.long 0xbf3d27b8, 0x3f2c800f
.long 0xbf3ca003, 0x3f2d1469
.long 0xbf3c17d9, 0x3f2da859
.long 0xbf3b8f3b, 0x3f2e3bde
.long 0xbf3b0629, 0x3f2ecef7
.long 0xbf3a7ca4, 0x3f2f61a5
.long 0xbf39f2ac, 0x3f2ff3e6
.long 0xbf396842, 0x3f3085bb
.long 0xbf38dd65, 0x3f311722
.long 0xbf385216, 0x3f31a81d
.long 0xbf37c655, 0x3f3238aa
.long 0xbf373a23, 0x3f32c8c9
.long 0xbf36ad7f, 0x3f33587a
.long 0xbf36206c, 0x3f33e7bc
.long 0xbf3592e7, 0x3f34768f
.long 0xbf3504f3, 0x3f3504f3
.long 0xbf34768f, 0x3f3592e7
.long 0xbf33e7bc, 0x3f36206c
.long 0xbf33587a, 0x3f36ad7f
.long 0xbf32c8c9, 0x3f373a23
.long 0xbf3238aa, 0x3f37c655
.long 0xbf31a81d, 0x3f385216
.long 0xbf311722, 0x3f38dd65
.long 0xbf3085bb, 0x3f396842
.long 0xbf2ff3e6, 0x3f39f2ac
.long 0xbf2f61a5, 0x3f3a7ca4
.long 0xbf2ecef7, 0x3f3b0629
.long 0xbf2e3bde, 0x3f3b8f3b
.long 0xbf2da859, 0x3f3c17d9
.long 0xbf2d1469, 0x3f3ca003
.long 0xbf2c800f, 0x3f3d27b8
.long 0xbf2beb4a, 0x3f3daef9
.long 0xbf2b561b, 0x3f3e35c5
.long 0xbf2ac082, 0x3f3ebc1b
.long 0xbf2a2a80, 0x3f3f41fc
.long 0xbf299415, 0x3f3fc767
.long 0xbf28fd41, 0x3f404c5c
.long 0xbf286605, 0x3f40d0da
.long 0xbf27ce61, 0x3f4154e1
.long 0xbf273656, 0x3f41d870
.long 0xbf269de3, 0x3f425b89
.long 0xbf26050a, 0x3f42de29
.long 0xbf256bcb, 0x3f436051
.long 0xbf24d225, 0x3f43e200
.long 0xbf24381a, 0x3f446337
.long 0xbf239da9, 0x3f44e3f5
.long 0xbf2302d3, 0x3f456439
.long 0xbf226799, 0x3f45e403
.long 0xbf21cbfb, 0x3f466354
.long 0xbf212ff9, 0x3f46e22a
.long 0xbf209393, 0x3f476085
.long 0xbf1ff6cb, 0x3f47de65
.long 0xbf1f599f, 0x3f485bca
.long 0xbf1ebc12, 0x3f48d8b3
.long 0xbf1e1e22, 0x3f495521
.long 0xbf1d7fd1, 0x3f49d112
.long 0xbf1ce11f, 0x3f4a4c87
.long 0xbf1c420c, 0x3f4ac77f
.long 0xbf1ba299, 0x3f4b41fa
.long 0xbf1b02c6, 0x3f4bbbf8
.long 0xbf1a6293, 0x3f4c3578
.long 0xbf19c200, 0x3f4cae79
.long 0xbf19210f, 0x3f4d26fd
.long 0xbf187fc0, 0x3f4d9f02
.long 0xbf17de12, 0x3f4e1689
.long 0xbf173c07, 0x3f4e8d90
.long 0xbf16999f, 0x3f4f0417
.long 0xbf15f6d9, 0x3f4f7a1f
.long 0xbf1553b7, 0x3f4fefa8
.long 0xbf14b039, 0x3f5064af
.long 0xbf140c5f, 0x3f50d937
.long 0xbf13682a, 0x3f514d3d
.long 0xbf12c39a, 0x3f51c0c2
.long 0xbf121eb0, 0x3f5233c6
.long 0xbf11796b, 0x3f52a649
.long 0xbf10d3cd, 0x3f531849
.long 0xbf102dd5, 0x3f5389c7
.long 0xbf0f8784, 0x3f53fac3
.long 0xbf0ee0db, 0x3f546b3b
.long 0xbf0e39da, 0x3f54db31
.long 0xbf0d9281, 0x3f554aa4
.long 0xbf0cead0, 0x3f55b993
.long 0xbf0c42c9, 0x3f5627fe
.long 0xbf0b9a6b, 0x3f5695e5
.long 0xbf0af1b7, 0x3f570348
.long 0xbf0a48ad, 0x3f577026
.long 0xbf099f4e, 0x3f57dc7f
.long 0xbf08f59b, 0x3f584853
.long 0xbf084b92, 0x3f58b3a1
.long 0xbf07a136, 0x3f591e6a
.long 0xbf06f686, 0x3f5988ad
.long 0xbf064b82, 0x3f59f26a
.long 0xbf05a02c, 0x3f5a5ba0
.long 0xbf04f484, 0x3f5ac450
.long 0xbf044889, 0x3f5b2c79
.long 0xbf039c3d, 0x3f5b941a
.long 0xbf02ef9f, 0x3f5bfb34
.long 0xbf0242b1, 0x3f5c61c7
.long 0xbf019573, 0x3f5cc7d1
.long 0xbf00e7e4, 0x3f5d2d53
.long 0xbf003a06, 0x3f5d924d
.long 0xbeff17b2, 0x3f5df6be
.long 0xbefdbabb, 0x3f5e5aa6
.long 0xbefc5d27, 0x3f5ebe05
.long 0xbefafef7, 0x3f5f20db
.long 0xbef9a02d, 0x3f5f8327
.long 0xbef840c8, 0x3f5fe4e9
.long 0xbef6e0cb, 0x3f604621
.long 0xbef58035, 0x3f60a6cf
.long 0xbef41f07, 0x3f6106f2
.long 0xbef2bd43, 0x3f61668a
.long 0xbef15aea, 0x3f61c598
.long 0xbeeff7fb, 0x3f62241a
.long 0xbeee9479, 0x3f628210
.long 0xbeed3063, 0x3f62df7b
.long 0xbeebcbbb, 0x3f633c5a
.long 0xbeea6681, 0x3f6398ac
.long 0xbee900b7, 0x3f63f473
.long 0xbee79a5d, 0x3f644fac
.long 0xbee63375, 0x3f64aa59
.long 0xbee4cbfe, 0x3f650479
.long 0xbee363fa, 0x3f655e0b
.long 0xbee1fb6a, 0x3f65b710
.long 0xbee0924f, 0x3f660f88
.long 0xbedf28a9, 0x3f666771
.long 0xbeddbe79, 0x3f66becc
.long 0xbedc53c1, 0x3f671599
.long 0xbedae880, 0x3f676bd8
.long 0xbed97cb9, 0x3f67c187
.long 0xbed8106b, 0x3f6816a8
.long 0xbed6a399, 0x3f686b39
.long 0xbed53641, 0x3f68bf3c
.long 0xbed3c867, 0x3f6912ae
.long 0xbed25a09, 0x3f696591
.long 0xbed0eb2a, 0x3f69b7e4
.long 0xbecf7bca, 0x3f6a09a7
.long 0xbece0bea, 0x3f6a5ad9
.long 0xbecc9b8b, 0x3f6aab7b
.long 0xbecb2aae, 0x3f6afb8c
.long 0xbec9b953, 0x3f6b4b0c
.long 0xbec8477c, 0x3f6b99fb
.long 0xbec6d529, 0x3f6be858
.long 0xbec5625c, 0x3f6c3624
.long 0xbec3ef15, 0x3f6c835e
.long 0xbec27b55, 0x3f6cd007
.long 0xbec1071e, 0x3f6d1c1d
.long 0xbebf926f, 0x3f6d67a1
.long 0xbebe1d4a, 0x3f6db293
.long 0xbebca7af, 0x3f6dfcf2
.long 0xbebb31a0, 0x3f6e46be
.long 0xbeb9bb1e, 0x3f6e8ff8
.long 0xbeb8442a, 0x3f6ed89e
.long 0xbeb6ccc3, 0x3f6f20b0
.long 0xbeb554ec, 0x3f6f6830
.long 0xbeb3dca5, 0x3f6faf1b
.long 0xbeb263ef, 0x3f6ff573
.long 0xbeb0eacb, 0x3f703b37
.long 0xbeaf713a, 0x3f708066
.long 0xbeadf73c, 0x3f70c501
.long 0xbeac7cd4, 0x3f710908
.long 0xbeab0201, 0x3f714c7a
.long 0xbea986c4, 0x3f718f57
.long 0xbea80b1f, 0x3f71d19f
.long 0xbea68f12, 0x3f721352
.long 0xbea5129f, 0x3f725470
.long 0xbea395c5, 0x3f7294f8
.long 0xbea21887, 0x3f72d4eb
.long 0xbea09ae5, 0x3f731447
.long 0xbe9f1cdf, 0x3f73530e
.long 0xbe9d9e78, 0x3f73913f
.long 0xbe9c1faf, 0x3f73ced9
.long 0xbe9aa086, 0x3f740bdd
.long 0xbe9920fe, 0x3f74484b
.long 0xbe97a117, 0x3f748422
.long 0xbe9620d2, 0x3f74bf62
.long 0xbe94a031, 0x3f74fa0b
.long 0xbe931f35, 0x3f75341d
.long 0xbe919ddd, 0x3f756d97
.long 0xbe901c2c, 0x3f75a67b
.long 0xbe8e9a22, 0x3f75dec6
.long 0xbe8d17c0, 0x3f76167a
.long 0xbe8b9507, 0x3f764d97
.long 0xbe8a11f7, 0x3f76841b
.long 0xbe888e93, 0x3f76ba07
.long 0xbe870ada, 0x3f76ef5b
.long 0xbe8586ce, 0x3f772417
.long 0xbe840270, 0x3f77583a
.long 0xbe827dc0, 0x3f778bc5
.long 0xbe80f8c0, 0x3f77beb7
.long 0xbe7ee6e1, 0x3f77f110
.long 0xbe7bdba4, 0x3f7822d1
.long 0xbe78cfcc, 0x3f7853f8
.long 0xbe75c35a, 0x3f788486
.long 0xbe72b651, 0x3f78b47b
.long 0xbe6fa8b2, 0x3f78e3d6
.long 0xbe6c9a7f, 0x3f791298
.long 0xbe698bba, 0x3f7940c0
.long 0xbe667c66, 0x3f796e4e
.long 0xbe636c83, 0x3f799b43
.long 0xbe605c13, 0x3f79c79d
.long 0xbe5d4b1a, 0x3f79f35e
.long 0xbe5a3997, 0x3f7a1e84
.long 0xbe57278f, 0x3f7a4910
.long 0xbe541501, 0x3f7a7302
.long 0xbe5101f1, 0x3f7a9c59
.long 0xbe4dee60, 0x3f7ac516
.long 0xbe4ada4f, 0x3f7aed37
.long 0xbe47c5c2, 0x3f7b14be
.long 0xbe44b0b9, 0x3f7b3bab
.long 0xbe419b37, 0x3f7b61fc
.long 0xbe3e853e, 0x3f7b87b2
.long 0xbe3b6ecf, 0x3f7baccd
.long 0xbe3857ec, 0x3f7bd14d
.long 0xbe354098, 0x3f7bf531
.long 0xbe3228d4, 0x3f7c187a
.long 0xbe2f10a2, 0x3f7c3b28
.long 0xbe2bf804, 0x3f7c5d3a
.long 0xbe28defc, 0x3f7c7eb0
.long 0xbe25c58c, 0x3f7c9f8a
.long 0xbe22abb6, 0x3f7cbfc9
.long 0xbe1f917b, 0x3f7cdf6c
.long 0xbe1c76de, 0x3f7cfe73
.long 0xbe195be0, 0x3f7d1cdd
.long 0xbe164083, 0x3f7d3aac
.long 0xbe1324ca, 0x3f7d57de
.long 0xbe1008b7, 0x3f7d7474
.long 0xbe0cec4a, 0x3f7d906e
.long 0xbe09cf86, 0x3f7dabcc
.long 0xbe06b26e, 0x3f7dc68c
.long 0xbe039502, 0x3f7de0b1
.long 0xbe007745, 0x3f7dfa38
.long 0xbdfab273, 0x3f7e1324
.long 0xbdf475c0, 0x3f7e2b72
.long 0xbdee3876, 0x3f7e4323
.long 0xbde7fa9a, 0x3f7e5a38
.long 0xbde1bc2e, 0x3f7e70b0
.long 0xbddb7d37, 0x3f7e868b
.long 0xbdd53db9, 0x3f7e9bc9
.long 0xbdcefdb7, 0x3f7eb069
.long 0xbdc8bd36, 0x3f7ec46d
.long 0xbdc27c39, 0x3f7ed7d4
.long 0xbdbc3ac3, 0x3f7eea9d
.long 0xbdb5f8da, 0x3f7efcc9
.long 0xbdafb680, 0x3f7f0e58
.long 0xbda973ba, 0x3f7f1f49
.long 0xbda3308c, 0x3f7f2f9d
.long 0xbd9cecf9, 0x3f7f3f54
.long 0xbd96a905, 0x3f7f4e6d
.long 0xbd9064b4, 0x3f7f5ce9
.long 0xbd8a200a, 0x3f7f6ac7
.long 0xbd83db0a, 0x3f7f7808
.long 0xbd7b2b74, 0x3f7f84ab
.long 0xbd6ea038, 0x3f7f90b1
.long 0xbd621469, 0x3f7f9c18
.long 0xbd55880e, 0x3f7fa6e3
.long 0xbd48fb30, 0x3f7fb10f
.long 0xbd3c6dd5, 0x3f7fba9e
.long 0xbd2fe007, 0x3f7fc38f
.long 0xbd2351cb, 0x3f7fcbe2
.long 0xbd16c32c, 0x3f7fd397
.long 0xbd0a342f, 0x3f7fdaaf
.long 0xbcfb49ba, 0x3f7fe129
.long 0xbce22a7a, 0x3f7fe705
.long 0xbcc90ab0, 0x3f7fec43
.long 0xbcafea69, 0x3f7ff0e3
.long 0xbc96c9b6, 0x3f7ff4e6
.long 0xbc7b514b, 0x3f7ff84a
.long 0xbc490e90, 0x3f7ffb11
.long 0xbc16cb58, 0x3f7ffd39
.long 0xbbc90f88, 0x3f7ffec4
.long 0xbb490fc6, 0x3f7fffb1
.long 0xa553c9ca, 0x3f800000
.long 0x3b490fc6, 0x3f7fffb1
.long 0x3bc90f88, 0x3f7ffec4
.long 0x3c16cb58, 0x3f7ffd39
.long 0x3c490e90, 0x3f7ffb11
.long 0x3c7b514b, 0x3f7ff84a
.long 0x3c96c9b6, 0x3f7ff4e6
.long 0x3cafea69, 0x3f7ff0e3
.long 0x3cc90ab0, 0x3f7fec43
.long 0x3ce22a7a, 0x3f7fe705
.long 0x3cfb49ba, 0x3f7fe129
.long 0x3d0a342f, 0x3f7fdaaf
.long 0x3d16c32c, 0x3f7fd397
.long 0x3d2351cb, 0x3f7fcbe2
.long 0x3d2fe007, 0x3f7fc38f
.long 0x3d3c6dd5, 0x3f7fba9e
.long 0x3d48fb30, 0x3f7fb10f
.long 0x3d55880e, 0x3f7fa6e3
.long 0x3d621469, 0x3f7f9c18
.long 0x3d6ea038, 0x3f7f90b1
.long 0x3d7b2b74, 0x3f7f84ab
.long 0x3d83db0a, 0x3f7f7808
.long 0x3d8a200a, 0x3f7f6ac7
.long 0x3d9064b4, 0x3f7f5ce9
.long 0x3d96a905, 0x3f7f4e6d
.long 0x3d9cecf9, 0x3f7f3f54
.long 0x3da3308c, 0x3f7f2f9d
.long 0x3da973ba, 0x3f7f1f49
.long 0x3dafb680, 0x3f7f0e58
.long 0x3db5f8da, 0x3f7efcc9
.long 0x3dbc3ac3, 0x3f7eea9d
.long 0x3dc27c39, 0x3f7ed7d4
.long 0x3dc8bd36, 0x3f7ec46d
.long 0x3dcefdb7, 0x3f7eb069
.long 0x3dd53db9, 0x3f7e9bc9
.long 0x3ddb7d37, 0x3f7e868b
.long 0x3de1bc2e, 0x3f7e70b0
.long 0x3de7fa9a, 0x3f7e5a38
.long 0x3dee3876, 0x3f7e4323
.long 0x3df475c0, 0x3f7e2b72
.long 0x3dfab273, 0x3f7e1324
.long 0x3e007745, 0x3f7dfa38
.long 0x3e039502, 0x3f7de0b1
.long 0x3e06b26e, 0x3f7dc68c
.long 0x3e09cf86, 0x3f7dabcc
.long 0x3e0cec4a, 0x3f7d906e
.long 0x3e1008b7, 0x3f7d7474
.long 0x3e1324ca, 0x3f7d57de
.long 0x3e164083, 0x3f7d3aac
.long 0x3e195be0, 0x3f7d1cdd
.long 0x3e1c76de, 0x3f7cfe73
.long 0x3e1f917b, 0x3f7cdf6c
.long 0x3e22abb6, 0x3f7cbfc9
.long 0x3e25c58c, 0x3f7c9f8a
.long 0x3e28defc, 0x3f7c7eb0
.long 0x3e2bf804, 0x3f7c5d3a
.long 0x3e2f10a2, 0x3f7c3b28
.long 0x3e3228d4, 0x3f7c187a
.long 0x3e354098, 0x3f7bf531
.long 0x3e3857ec, 0x3f7bd14d
.long 0x3e3b6ecf, 0x3f7baccd
.long 0x3e3e853e, 0x3f7b87b2
.long 0x3e419b37, 0x3f7b61fc
.long 0x3e44b0b9, 0x3f7b3bab
.long 0x3e47c5c2, 0x3f7b14be
.long 0x3e4ada4f, 0x3f7aed37
.long 0x3e4dee60, 0x3f7ac516
.long 0x3e5101f1, 0x3f7a9c59
.long 0x3e541501, 0x3f7a7302
.long 0x3e57278f, 0x3f7a4910
.long 0x3e5a3997, 0x3f7a1e84
.long 0x3e5d4b1a, 0x3f79f35e
.long 0x3e605c13, 0x3f79c79d
.long 0x3e636c83, 0x3f799b43
.long 0x3e667c66, 0x3f796e4e
.long 0x3e698bba, 0x3f7940c0
.long 0x3e6c9a7f, 0x3f791298
.long 0x3e6fa8b2, 0x3f78e3d6
.long 0x3e72b651, 0x3f78b47b
.long 0x3e75c35a, 0x3f788486
.long 0x3e78cfcc, 0x3f7853f8
.long 0x3e7bdba4, 0x3f7822d1
.long 0x3e7ee6e1, 0x3f77f110
.long 0x3e80f8c0, 0x3f77beb7
.long 0x3e827dc0, 0x3f778bc5
.long 0x3e840270, 0x3f77583a
.long 0x3e8586ce, 0x3f772417
.long 0x3e870ada, 0x3f76ef5b
.long 0x3e888e93, 0x3f76ba07
.long 0x3e8a11f7, 0x3f76841b
.long 0x3e8b9507, 0x3f764d97
.long 0x3e8d17c0, 0x3f76167a
.long 0x3e8e9a22, 0x3f75dec6
.long 0x3e901c2c, 0x3f75a67b
.long 0x3e919ddd, 0x3f756d97
.long 0x3e931f35, 0x3f75341d
.long 0x3e94a031, 0x3f74fa0b
.long 0x3e9620d2, 0x3f74bf62
.long 0x3e97a117, 0x3f748422
.long 0x3e9920fe, 0x3f74484b
.long 0x3e9aa086, 0x3f740bdd
.long 0x3e9c1faf, 0x3f73ced9
.long 0x3e9d9e78, 0x3f73913f
.long 0x3e9f1cdf, 0x3f73530e
.long 0x3ea09ae5, 0x3f731447
.long 0x3ea21887, 0x3f72d4eb
.long 0x3ea395c5, 0x3f7294f8
.long 0x3ea5129f, 0x3f725470
.long 0x3ea68f12, 0x3f721352
.long 0x3ea80b1f, 0x3f71d19f
.long 0x3ea986c4, 0x3f718f57
.long 0x3eab0201, 0x3f714c7a
.long 0x3eac7cd4, 0x3f710908
.long 0x3eadf73c, 0x3f70c501
.long 0x3eaf713a, 0x3f708066
.long 0x3eb0eacb, 0x3f703b37
.long 0x3eb263ef, 0x3f6ff573
.long 0x3eb3dca5, 0x3f6faf1b
.long 0x3eb554ec, 0x3f6f6830
.long 0x3eb6ccc3, 0x3f6f20b0
.long 0x3eb8442a, 0x3f6ed89e
.long 0x3eb9bb1e, 0x3f6e8ff8
.long 0x3ebb31a0, 0x3f6e46be
.long 0x3ebca7af, 0x3f6dfcf2
.long 0x3ebe1d4a, 0x3f6db293
.long 0x3ebf926f, 0x3f6d67a1
.long 0x3ec1071e, 0x3f6d1c1d
.long 0x3ec27b55, 0x3f6cd007
.long 0x3ec3ef15, 0x3f6c835e
.long 0x3ec5625c, 0x3f6c3624
.long 0x3ec6d529, 0x3f6be858
.long 0x3ec8477c, 0x3f6b99fb
.long 0x3ec9b953, 0x3f6b4b0c
.long 0x3ecb2aae, 0x3f6afb8c
.long 0x3ecc9b8b, 0x3f6aab7b
.long 0x3ece0bea, 0x3f6a5ad9
.long 0x3ecf7bca, 0x3f6a09a7
.long 0x3ed0eb2a, 0x3f69b7e4
.long 0x3ed25a09, 0x3f696591
.long 0x3ed3c867, 0x3f6912ae
.long 0x3ed53641, 0x3f68bf3c
.long 0x3ed6a399, 0x3f686b39
.long 0x3ed8106b, 0x3f6816a8
.long 0x3ed97cb9, 0x3f67c187
.long 0x3edae880, 0x3f676bd8
.long 0x3edc53c1, 0x3f671599
.long 0x3eddbe79, 0x3f66becc
.long 0x3edf28a9, 0x3f666771
.long 0x3ee0924f, 0x3f660f88
.long 0x3ee1fb6a, 0x3f65b710
.long 0x3ee363fa, 0x3f655e0b
.long 0x3ee4cbfe, 0x3f650479
.long 0x3ee63375, 0x3f64aa59
.long 0x3ee79a5d, 0x3f644fac
.long 0x3ee900b7, 0x3f63f473
.long 0x3eea6681, 0x3f6398ac
.long 0x3eebcbbb, 0x3f633c5a
.long 0x3eed3063, 0x3f62df7b
.long 0x3eee9479, 0x3f628210
.long 0x3eeff7fb, 0x3f62241a
.long 0x3ef15aea, 0x3f61c598
.long 0x3ef2bd43, 0x3f61668a
.long 0x3ef41f07, 0x3f6106f2
.long 0x3ef58035, 0x3f60a6cf
.long 0x3ef6e0cb, 0x3f604621
.long 0x3ef840c8, 0x3f5fe4e9
.long 0x3ef9a02d, 0x3f5f8327
.long 0x3efafef7, 0x3f5f20db
.long 0x3efc5d27, 0x3f5ebe05
.long 0x3efdbabb, 0x3f5e5aa6
.long 0x3eff17b2, 0x3f5df6be
.long 0x3f003a06, 0x3f5d924d
.long 0x3f00e7e4, 0x3f5d2d53
.long 0x3f019573, 0x3f5cc7d1
.long 0x3f0242b1, 0x3f5c61c7
.long 0x3f02ef9f, 0x3f5bfb34
.long 0x3f039c3d, 0x3f5b941a
.long 0x3f044889, 0x3f5b2c79
.long 0x3f04f484, 0x3f5ac450
.long 0x3f05a02c, 0x3f5a5ba0
.long 0x3f064b82, 0x3f59f26a
.long 0x3f06f686, 0x3f5988ad
.long 0x3f07a136, 0x3f591e6a
.long 0x3f084b92, 0x3f58b3a1
.long 0x3f08f59b, 0x3f584853
.long 0x3f099f4e, 0x3f57dc7f
.long 0x3f0a48ad, 0x3f577026
.long 0x3f0af1b7, 0x3f570348
.long 0x3f0b9a6b, 0x3f5695e5
.long 0x3f0c42c9, 0x3f5627fe
.long 0x3f0cead0, 0x3f55b993
.long 0x3f0d9281, 0x3f554aa4
.long 0x3f0e39da, 0x3f54db31
.long 0x3f0ee0db, 0x3f546b3b
.long 0x3f0f8784, 0x3f53fac3
.long 0x3f102dd5, 0x3f5389c7
.long 0x3f10d3cd, 0x3f531849
.long 0x3f11796b, 0x3f52a649
.long 0x3f121eb0, 0x3f5233c6
.long 0x3f12c39a, 0x3f51c0c2
.long 0x3f13682a, 0x3f514d3d
.long 0x3f140c5f, 0x3f50d937
.long 0x3f14b039, 0x3f5064af
.long 0x3f1553b7, 0x3f4fefa8
.long 0x3f15f6d9, 0x3f4f7a1f
.long 0x3f16999f, 0x3f4f0417
.long 0x3f173c07, 0x3f4e8d90
.long 0x3f17de12, 0x3f4e1689
.long 0x3f187fc0, 0x3f4d9f02
.long 0x3f19210f, 0x3f4d26fd
.long 0x3f19c200, 0x3f4cae79
.long 0x3f1a6293, 0x3f4c3578
.long 0x3f1b02c6, 0x3f4bbbf8
.long 0x3f1ba299, 0x3f4b41fa
.long 0x3f1c420c, 0x3f4ac77f
.long 0x3f1ce11f, 0x3f4a4c87
.long 0x3f1d7fd1, 0x3f49d112
.long 0x3f1e1e22, 0x3f495521
.long 0x3f1ebc12, 0x3f48d8b3
.long 0x3f1f599f, 0x3f485bca
.long 0x3f1ff6cb, 0x3f47de65
.long 0x3f209393, 0x3f476085
.long 0x3f212ff9, 0x3f46e22a
.long 0x3f21cbfb, 0x3f466354
.long 0x3f226799, 0x3f45e403
.long 0x3f2302d3, 0x3f456439
.long 0x3f239da9, 0x3f44e3f5
.long 0x3f24381a, 0x3f446337
.long 0x3f24d225, 0x3f43e200
.long 0x3f256bcb, 0x3f436051
.long 0x3f26050a, 0x3f42de29
.long 0x3f269de3, 0x3f425b89
.long 0x3f273656, 0x3f41d870
.long 0x3f27ce61, 0x3f4154e1
.long 0x3f286605, 0x3f40d0da
.long 0x3f28fd41, 0x3f404c5c
.long 0x3f299415, 0x3f3fc767
.long 0x3f2a2a80, 0x3f3f41fc
.long 0x3f2ac082, 0x3f3ebc1b
.long 0x3f2b561b, 0x3f3e35c5
.long 0x3f2beb4a, 0x3f3daef9
.long 0x3f2c800f, 0x3f3d27b8
.long 0x3f2d1469, 0x3f3ca003
.long 0x3f2da859, 0x3f3c17d9
.long 0x3f2e3bde, 0x3f3b8f3b
.long 0x3f2ecef7, 0x3f3b0629
.long 0x3f2f61a5, 0x3f3a7ca4
.long 0x3f2ff3e6, 0x3f39f2ac
.long 0x3f3085bb, 0x3f396842
.long 0x3f311722, 0x3f38dd65
.long 0x3f31a81d, 0x3f385216
.long 0x3f3238aa, 0x3f37c655
.long 0x3f32c8c9, 0x3f373a23
.long 0x3f33587a, 0x3f36ad7f
.long 0x3f33e7bc, 0x3f36206c
.long 0x3f34768f, 0x3f3592e7
.long 0x3f3504f3, 0x3f3504f3
.long 0x3f3592e7, 0x3f34768f
.long 0x3f36206c, 0x3f33e7bc
.long 0x3f36ad7f, 0x3f33587a
.long 0x3f373a23, 0x3f32c8c9
.long 0x3f37c655, 0x3f3238aa
.long 0x3f385216, 0x3f31a81d
.long 0x3f38dd65, 0x3f311722
.long 0x3f396842, 0x3f3085bb
.long 0x3f39f2ac, 0x3f2ff3e6
.long 0x3f3a7ca4, 0x3f2f61a5
.long 0x3f3b0629, 0x3f2ecef7
.long 0x3f3b8f3b, 0x3f2e3bde
.long 0x3f3c17d9, 0x3f2da859
.long 0x3f3ca003, 0x3f2d1469
.long 0x3f3d27b8, 0x3f2c800f
.long 0x3f3daef9, 0x3f2beb4a
.long 0x3f3e35c5, 0x3f2b561b
.long 0x3f3ebc1b, 0x3f2ac082
.long 0x3f3f41fc, 0x3f2a2a80
.long 0x3f3fc767, 0x3f299415
.long 0x3f404c5c, 0x3f28fd41
.long 0x3f40d0da, 0x3f286605
.long 0x3f4154e1, 0x3f27ce61
.long 0x3f41d870, 0x3f273656
.long 0x3f425b89, 0x3f269de3
.long 0x3f42de29, 0x3f26050a
.long 0x3f436051, 0x3f256bcb
.long 0x3f43e200, 0x3f24d225
.long 0x3f446337, 0x3f24381a
.long 0x3f44e3f5, 0x3f239da9
.long 0x3f456439, 0x3f2302d3
.long 0x3f45e403, 0x3f226799
.long 0x3f466354, 0x3f21cbfb
.long 0x3f46e22a, 0x3f212ff9
.long 0x3f476085, 0x3f209393
.long 0x3f47de65, 0x3f1ff6cb
.long 0x3f485bca, 0x3f1f599f
.long 0x3f48d8b3, 0x3f1ebc12
.long 0x3f495521, 0x3f1e1e22
.long 0x3f49d112, 0x3f1d7fd1
.long 0x3f4a4c87, 0x3f1ce11f
.long 0x3f4ac77f, 0x3f1c420c
.long 0x3f4b41fa, 0x3f1ba299
.long 0x3f4bbbf8, 0x3f1b02c6
.long 0x3f4c3578, 0x3f1a6293
.long 0x3f4cae79, 0x3f19c200
.long 0x3f4d26fd, 0x3f19210f
.long 0x3f4d9f02, 0x3f187fc0
.long 0x3f4e1689, 0x3f17de12
.long 0x3f4e8d90, 0x3f173c07
.long 0x3f4f0417, 0x3f16999f
.long 0x3f4f7a1f, 0x3f15f6d9
.long 0x3f4fefa8, 0x3f1553b7
.long 0x3f5064af, 0x3f14b039
.long 0x3f50d937, 0x3f140c5f
.long 0x3f514d3d, 0x3f13682a
.long 0x3f51c0c2, 0x3f12c39a
.long 0x3f5233c6, 0x3f121eb0
.long 0x3f52a649, 0x3f11796b
.long 0x3f531849, 0x3f10d3cd
.long 0x3f5389c7, 0x3f102dd5
.long 0x3f53fac3, 0x3f0f8784
.long 0x3f546b3b, 0x3f0ee0db
.long 0x3f54db31, 0x3f0e39da
.long 0x3f554aa4, 0x3f0d9281
.long 0x3f55b993, 0x3f0cead0
.long 0x3f5627fe, 0x3f0c42c9
.long 0x3f5695e5, 0x3f0b9a6b
.long 0x3f570348, 0x3f0af1b7
.long 0x3f577026, 0x3f0a48ad
.long 0x3f57dc7f, 0x3f099f4e
.long 0x3f584853, 0x3f08f59b
.long 0x3f58b3a1, 0x3f084b92
.long 0x3f591e6a, 0x3f07a136
.long 0x3f5988ad, 0x3f06f686
.long 0x3f59f26a, 0x3f064b82
.long 0x3f5a5ba0, 0x3f05a02c
.long 0x3f5ac450, 0x3f04f484
.long 0x3f5b2c79, 0x3f044889
.long 0x3f5b941a, 0x3f039c3d
.long 0x3f5bfb34, 0x3f02ef9f
.long 0x3f5c61c7, 0x3f0242b1
.long 0x3f5cc7d1, 0x3f019573
.long 0x3f5d2d53, 0x3f00e7e4
.long 0x3f5d924d, 0x3f003a06
.long 0x3f5df6be, 0x3eff17b2
.long 0x3f5e5aa6, 0x3efdbabb
.long 0x3f5ebe05, 0x3efc5d27
.long 0x3f5f20db, 0x3efafef7
.long 0x3f5f8327, 0x3ef9a02d
.long 0x3f5fe4e9, 0x3ef840c8
.long 0x3f604621, 0x3ef6e0cb
.long 0x3f60a6cf, 0x3ef58035
.long 0x3f6106f2, 0x3ef41f07
.long 0x3f61668a, 0x3ef2bd43
.long 0x3f61c598, 0x3ef15aea
.long 0x3f62241a, 0x3eeff7fb
.long 0x3f628210, 0x3eee9479
.long 0x3f62df7b, 0x3eed3063
.long 0x3f633c5a, 0x3eebcbbb
.long 0x3f6398ac, 0x3eea6681
.long 0x3f63f473, 0x3ee900b7
.long 0x3f644fac, 0x3ee79a5d
.long 0x3f64aa59, 0x3ee63375
.long 0x3f650479, 0x3ee4cbfe
.long 0x3f655e0b, 0x3ee363fa
.long 0x3f65b710, 0x3ee1fb6a
.long 0x3f660f88, 0x3ee0924f
.long 0x3f666771, 0x3edf28a9
.long 0x3f66becc, 0x3eddbe79
.long 0x3f671599, 0x3edc53c1
.long 0x3f676bd8, 0x3edae880
.long 0x3f67c187, 0x3ed97cb9
.long 0x3f6816a8, 0x3ed8106b
.long 0x3f686b39, 0x3ed6a399
.long 0x3f68bf3c, 0x3ed53641
.long 0x3f6912ae, 0x3ed3c867
.long 0x3f696591, 0x3ed25a09
.long 0x3f69b7e4, 0x3ed0eb2a
.long 0x3f6a09a7, 0x3ecf7bca
.long 0x3f6a5ad9, 0x3ece0bea
.long 0x3f6aab7b, 0x3ecc9b8b
.long 0x3f6afb8c, 0x3ecb2aae
.long 0x3f6b4b0c, 0x3ec9b953
.long 0x3f6b99fb, 0x3ec8477c
.long 0x3f6be858, 0x3ec6d529
.long 0x3f6c3624, 0x3ec5625c
.long 0x3f6c835e, 0x3ec3ef15
.long 0x3f6cd007, 0x3ec27b55
.long 0x3f6d1c1d, 0x3ec1071e
.long 0x3f6d67a1, 0x3ebf926f
.long 0x3f6db293, 0x3ebe1d4a
.long 0x3f6dfcf2, 0x3ebca7af
.long 0x3f6e46be, 0x3ebb31a0
.long 0x3f6e8ff8, 0x3eb9bb1e
.long 0x3f6ed89e, 0x3eb8442a
.long 0x3f6f20b0, 0x3eb6ccc3
.long 0x3f6f6830, 0x3eb554ec
.long 0x3f6faf1b, 0x3eb3dca5
.long 0x3f6ff573, 0x3eb263ef
.long 0x3f703b37, 0x3eb0eacb
.long 0x3f708066, 0x3eaf713a
.long 0x3f70c501, 0x3eadf73c
.long 0x3f710908, 0x3eac7cd4
.long 0x3f714c7a, 0x3eab0201
.long 0x3f718f57, 0x3ea986c4
.long 0x3f71d19f, 0x3ea80b1f
.long 0x3f721352, 0x3ea68f12
.long 0x3f725470, 0x3ea5129f
.long 0x3f7294f8, 0x3ea395c5
.long 0x3f72d4eb, 0x3ea21887
.long 0x3f731447, 0x3ea09ae5
.long 0x3f73530e, 0x3e9f1cdf
.long 0x3f73913f, 0x3e9d9e78
.long 0x3f73ced9, 0x3e9c1faf
.long 0x3f740bdd, 0x3e9aa086
.long 0x3f74484b, 0x3e9920fe
.long 0x3f748422, 0x3e97a117
.long 0x3f74bf62, 0x3e9620d2
.long 0x3f74fa0b, 0x3e94a031
.long 0x3f75341d, 0x3e931f35
.long 0x3f756d97, 0x3e919ddd
.long 0x3f75a67b, 0x3e901c2c
.long 0x3f75dec6, 0x3e8e9a22
.long 0x3f76167a, 0x3e8d17c0
.long 0x3f764d97, 0x3e8b9507
.long 0x3f76841b, 0x3e8a11f7
.long 0x3f76ba07, 0x3e888e93
.long 0x3f76ef5b, 0x3e870ada
.long 0x3f772417, 0x3e8586ce
.long 0x3f77583a, 0x3e840270
.long 0x3f778bc5, 0x3e827dc0
.long 0x3f77beb7, 0x3e80f8c0
.long 0x3f77f110, 0x3e7ee6e1
.long 0x3f7822d1, 0x3e7bdba4
.long 0x3f7853f8, 0x3e78cfcc
.long 0x3f788486, 0x3e75c35a
.long 0x3f78b47b, 0x3e72b651
.long 0x3f78e3d6, 0x3e6fa8b2
.long 0x3f791298, 0x3e6c9a7f
.long 0x3f7940c0, 0x3e698bba
.long 0x3f796e4e, 0x3e667c66
.long 0x3f799b43, 0x3e636c83
.long 0x3f79c79d, 0x3e605c13
.long 0x3f79f35e, 0x3e5d4b1a
.long 0x3f7a1e84, 0x3e5a3997
.long 0x3f7a4910, 0x3e57278f
.long 0x3f7a7302, 0x3e541501
.long 0x3f7a9c59, 0x3e5101f1
.long 0x3f7ac516, 0x3e4dee60
.long 0x3f7aed37, 0x3e4ada4f
.long 0x3f7b14be, 0x3e47c5c2
.long 0x3f7b3bab, 0x3e44b0b9
.long 0x3f7b61fc, 0x3e419b37
.long 0x3f7b87b2, 0x3e3e853e
.long 0x3f7baccd, 0x3e3b6ecf
.long 0x3f7bd14d, 0x3e3857ec
.long 0x3f7bf531, 0x3e354098
.long 0x3f7c187a, 0x3e3228d4
.long 0x3f7c3b28, 0x3e2f10a2
.long 0x3f7c5d3a, 0x3e2bf804
.long 0x3f7c7eb0, 0x3e28defc
.long 0x3f7c9f8a, 0x3e25c58c
.long 0x3f7cbfc9, 0x3e22abb6
.long 0x3f7cdf6c, 0x3e1f917b
.long 0x3f7cfe73, 0x3e1c76de
.long 0x3f7d1cdd, 0x3e195be0
.long 0x3f7d3aac, 0x3e164083
.long 0x3f7d57de, 0x3e1324ca
.long 0x3f7d7474, 0x3e1008b7
.long 0x3f7d906e, 0x3e0cec4a
.long 0x3f7dabcc, 0x3e09cf86
.long 0x3f7dc68c, 0x3e06b26e
.long 0x3f7de0b1, 0x3e039502
.long 0x3f7dfa38, 0x3e007745
.long 0x3f7e1324, 0x3dfab273
.long 0x3f7e2b72, 0x3df475c0
.long 0x3f7e4323, 0x3dee3876
.long 0x3f7e5a38, 0x3de7fa9a
.long 0x3f7e70b0, 0x3de1bc2e
.long 0x3f7e868b, 0x3ddb7d37
.long 0x3f7e9bc9, 0x3dd53db9
.long 0x3f7eb069, 0x3dcefdb7
.long 0x3f7ec46d, 0x3dc8bd36
.long 0x3f7ed7d4, 0x3dc27c39
.long 0x3f7eea9d, 0x3dbc3ac3
.long 0x3f7efcc9, 0x3db5f8da
.long 0x3f7f0e58, 0x3dafb680
.long 0x3f7f1f49, 0x3da973ba
.long 0x3f7f2f9d, 0x3da3308c
.long 0x3f7f3f54, 0x3d9cecf9
.long 0x3f7f4e6d, 0x3d96a905
.long 0x3f7f5ce9, 0x3d9064b4
.long 0x3f7f6ac7, 0x3d8a200a
.long 0x3f7f7808, 0x3d83db0a
.long 0x3f7f84ab, 0x3d7b2b74
.long 0x3f7f90b1, 0x3d6ea038
.long 0x3f7f9c18, 0x3d621469
.long 0x3f7fa6e3, 0x3d55880e
.long 0x3f7fb10f, 0x3d48fb30
.long 0x3f7fba9e, 0x3d3c6dd5
.long 0x3f7fc38f, 0x3d2fe007
.long 0x3f7fcbe2, 0x3d2351cb
.long 0x3f7fd397, 0x3d16c32c
.long 0x3f7fdaaf, 0x3d0a342f
.long 0x3f7fe129, 0x3cfb49ba
.long 0x3f7fe705, 0x3ce22a7a
.long 0x3f7fec43, 0x3cc90ab0
.long 0x3f7ff0e3, 0x3cafea69
.long 0x3f7ff4e6, 0x3c96c9b6
.long 0x3f7ff84a, 0x3c7b514b
.long 0x3f7ffb11, 0x3c490e90
.long 0x3f7ffd39, 0x3c16cb58
.long 0x3f7ffec4, 0x3bc90f88
.long 0x3f7fffb1, 0x3b490fc6
```
